```python
import torch

def _softmax(x, axis=-1):
    return torch.softmax(x, dim=axis)
def _gelu(x):
    return torch.nn.functional.gelu(x, approximate="tanh")
def _silu(x):
    return torch.nn.functional.silu(x)
def _sigmoid(x):
    return torch.sigmoid(x)
def _layernorm(x, axis=-1, eps=1e-5):
    m = x.mean(dim=axis, keepdim=True)
    v = x.var(dim=axis, keepdim=True, unbiased=False)
    return (x - m) / torch.sqrt(v + eps)
def _scatter_add(tgt, idx, src, axis=0):
    return tgt.clone().index_add_(axis, idx, src)
def _segment_sum(src, seg, n):
    out = torch.zeros((n,) + src.shape[1:], dtype=src.dtype)
    return out.index_add_(0, seg, src)
def _pad(x, pw):
    flat = tuple(v for pair in reversed(pw) for v in pair)
    return torch.nn.functional.pad(x, flat)

kernel_name = 'recurrent_scan__gqa_block_cached__glu_gated_bilinear__prompt'

def setup_inputs():

    _w = (lambda a: (lambda t: t.to(torch.bfloat16) if t.is_floating_point() else t)(torch.as_tensor(a)))
    def _A_setup():
        B, Sq, D = 1, 2048, 512
        Hq, Hkv, Sk, Dh = 32, 8, 2048, 128
        assert Hq % Hkv == 0, (Hq, Hkv)
        return {
            "x": _w((lambda *s: torch.randn(*s, dtype=torch.bfloat16) * 0.05)(B, Sq, D)),
            "k_cache": _w((lambda *s: torch.randn(*s, dtype=torch.bfloat16) * 1.6)(B, Hkv, Sk, Dh)),
            "v_cache": _w((lambda *s: torch.randn(*s, dtype=torch.bfloat16) * 1.6)(B, Hkv, Sk, Dh)),
            "wq": _w((lambda *s: torch.randn(*s, dtype=torch.bfloat16) * 1.6)(D, Hq * Dh) * (D ** -0.5)),
            "wo": _w((lambda *s: torch.randn(*s, dtype=torch.bfloat16) * 1.6)(Hq * Dh, D) * ((Hq * Dh) ** -0.5)),
        }
    _A_in = _A_setup()

    def _B_setup():
        B, S, D, F = 1, 2048, 512, 1792
        return {
            "x": _w((lambda *s: torch.randn(*s, dtype=torch.bfloat16) * 0.05)(B, S, D)),
            "w_gate": _w((lambda *s: torch.randn(*s, dtype=torch.bfloat16) * 0.2)(D, F) * (D ** -0.5)),
            "w_up": _w((lambda *s: torch.randn(*s, dtype=torch.bfloat16) * 0.2)(D, F) * (D ** -0.5)),
            "w_down": _w((lambda *s: torch.randn(*s, dtype=torch.bfloat16) * 0.2)(F, D) * (F ** -0.5)),
        }
    _B_in = _B_setup()

    return {
        "A_x": _A_in["x"],
        "A_k_cache": _A_in["k_cache"],
        "A_v_cache": _A_in["v_cache"],
        "A_wq": _A_in["wq"],
        "A_wo": _A_in["wo"],
        "B_x": _B_in["x"],
        "B_w_gate": _B_in["w_gate"],
        "B_w_up": _B_in["w_up"],
        "B_w_down": _B_in["w_down"],
    }

def reference(A_x, A_k_cache, A_v_cache, A_wq, A_wo, B_x, B_w_gate, B_w_up, B_w_down):
    def _A_ref(x, k_cache, v_cache, wq, wo):
        B, Sq, D = x.shape
        Hq, Dh = 32, 128
        Hkv = k_cache.shape[1]
        rep = Hq // Hkv
        q = (lambda x, *d: x.permute(*d))((x @ wq).reshape(B, Sq, Hq, Dh), 0, 2, 1, 3)
        k = (lambda x, n, axis: torch.repeat_interleave(x, n, dim=axis))(k_cache, rep, axis=1)
        v = (lambda x, n, axis: torch.repeat_interleave(x, n, dim=axis))(v_cache, rep, axis=1)
        scores = torch.einsum("bhqd,bhkd->bhqk", q, k) * (Dh ** -0.5)
        p = _softmax(scores, axis=-1)
        o = torch.einsum("bhqk,bhkd->bhqd", p, v)
        return (lambda x, *d: x.permute(*d))(o, 0, 2, 1, 3).reshape(B, Sq, Hq * Dh) @ wo

    def _B_ref(x, w_gate, w_up, w_down):
        g = torch.einsum("bsd,df->bsf", x, w_gate)
        u = torch.einsum("bsd,df->bsf", x, w_up)
        h = g * u
        return torch.einsum("bsf,fd->bsd", h, w_down)

    x = A_x
    xn = _layernorm(x, axis=-1)
    s = _A_ref(xn, A_k_cache, A_v_cache, A_wq, A_wo)
    g = _silu(_B_ref(xn, B_w_gate, B_w_up, B_w_down))
    return x + s * g
```

```asm
; @launch grid=(256,1,1) block=(256,1,1) lds=163840
.amdgcn_target "amdgcn-amd-amdhsa--gfx950"
.text
.p2align 8
.globl recurrent_scan__gqa_block_cached__glu_gated_bilinear__prompt_kernel
.type recurrent_scan__gqa_block_cached__glu_gated_bilinear__prompt_kernel,@function
recurrent_scan__gqa_block_cached__glu_gated_bilinear__prompt_kernel:
    s_cmp_ge_u32 s2, 256
    s_cbranch_scc1 M_END
    s_load_dwordx16 s[4:19], s[0:1], 0
    s_load_dwordx8 s[20:27], s[0:1], 64
    v_lshrrev_b32 v192, 6, v0
    v_and_b32 v246, 63, v0
    s_bfe_u32 s53, s2, 0x20000
    v_readfirstlane_b32 s52, v192
    s_lshr_b32 s63, s2, 4
    s_mov_b32 s54, s63
    s_and_b32 s91, s63, 15
    s_lshl_b32 s53, s53, 1
    s_bfe_u32 s64, s2, 0x10003
    s_add_u32 s53, s53, s64
    s_bfe_u32 s64, s2, 0x10002
    s_lshl_b32 s64, s64, 4
    s_add_u32 s54, s54, s64
    v_lshlrev_b32 v245, 4, v246
    s_lshr_b32 s64, s2, 3
    s_lshl_b32 s64, s64, 11
    v_lshrrev_b32 v253, 4, v0
    v_lshl_add_u32 v253, v253, 7, s64
    s_getpc_b64 s[78:79]
M_PC:
    v_min_u32 v253, M_SLOW-M_PC, v253
    global_load_dword v251, v253, s[78:79]
    s_mul_i32 s55, s52, 24576
    s_add_u32 s55, s55, 65536
    v_and_b32 v192, 15, v246
    v_lshrrev_b32 v193, 4, v246
    s_lshl_b32 s64, s52, 4
    v_lshrrev_b32 v206, 2, v246
    v_and_b32 v194, 3, v246
    v_add_u32 v206, s64, v206
    v_lshlrev_b32 v206, 10, v206
    v_lshl_add_u32 v206, v194, 4, v206
    s_lshl_b32 s70, s54, 16
    s_add_u32 s71, s70, 512
    s_waitcnt lgkmcnt(0)
    s_mov_b32 s28, s4
    s_mov_b32 s29, s5
    s_mov_b32 s30, 2097152
    s_mov_b32 s31, 0x20000
    buffer_load_dwordx4 v[128:131], v206, s[28:31], s70 offen offset:0
    buffer_load_dwordx4 v[132:135], v206, s[28:31], s70 offen offset:64
    buffer_load_dwordx4 v[136:139], v206, s[28:31], s70 offen offset:128
    buffer_load_dwordx4 v[140:143], v206, s[28:31], s70 offen offset:192
    buffer_load_dwordx4 v[144:147], v206, s[28:31], s70 offen offset:256
    buffer_load_dwordx4 v[148:151], v206, s[28:31], s70 offen offset:320
    buffer_load_dwordx4 v[152:155], v206, s[28:31], s70 offen offset:384
    buffer_load_dwordx4 v[156:159], v206, s[28:31], s70 offen offset:448
    buffer_load_dwordx4 v[160:163], v206, s[28:31], s71 offen offset:0
    buffer_load_dwordx4 v[164:167], v206, s[28:31], s71 offen offset:64
    buffer_load_dwordx4 v[168:171], v206, s[28:31], s71 offen offset:128
    buffer_load_dwordx4 v[172:175], v206, s[28:31], s71 offen offset:192
    v_lshrrev_b32 v195, 3, v246
    v_and_b32 v196, 7, v246
    v_lshlrev_b32 v197, 1, v193
    v_xor_b32 v196, v196, v197
    v_lshlrev_b32 v196, 4, v196
    v_xor_b32 v197, 64, v196
    v_mul_u32_u24 v198, 3584, v195
    v_add_u32 v228, v198, v196
    v_add_u32 v229, v198, v197
    v_add_u32 v229, 27648, v229
    v_lshl_add_u32 v230, v195, 13, v196
    v_lshl_add_u32 v231, v195, 13, v197
    v_add_u32 v231, 64512, v231
    v_lshl_add_u32 v232, v195, 10, v196
    v_lshl_add_u32 v233, v195, 10, v197
    v_add_u32 v233, 7168, v233
    s_lshl_b32 s63, s63, 2
    s_add_u32 s63, s63, s52
    s_and_b32 s64, s54, 1
    s_lshl_b32 s64, s64, 2
    s_or_b32 s64, s64, 3
    s_cmp_gt_u32 s53, s64
    s_subb_u32 s62, s53, 0
    s_cmp_eq_u32 s53, s64
    s_cselect_b32 s62, 7, s62
    s_cmp_eq_u32 s62, 7
    s_cbranch_scc1 M_PRE_Q
    s_mov_b32 s32, s16
    s_mov_b32 s33, s17
    s_mov_b32 s34, 1835008
    s_mov_b32 s35, 0x20000
    s_mov_b32 s36, s18
    s_mov_b32 s37, s19
    s_mov_b32 s38, 1835008
    s_mov_b32 s39, 0x20000
    s_lshl_b32 s56, s62, 9
    s_lshl_b32 s64, s52, 7
    s_add_u32 s56, s56, s64
    s_mul_i32 s64, s91, 114688
    s_add_u32 s56, s56, s64
    s_mov_b32 s92, s91
    s_add_u32 s57, s56, 55296
    s_mov_b32 s58, 114688
    s_mov_b32 s93, -1720320
    s_branch M_PRE_DONE
M_PRE_Q:
    s_mov_b32 s32, s20
    s_mov_b32 s33, s21
    s_mov_b32 s34, 1835008
    s_mov_b32 s35, 0x20000
    s_add_u32 s36, s20, 128
    s_addc_u32 s37, s21, 0
    s_mov_b32 s38, 1834880
    s_mov_b32 s39, 0x20000
    s_lshl_b32 s56, s54, 16
    s_lshl_b32 s64, s52, 8
    s_add_u32 s56, s56, s64
    s_mov_b32 s92, 0
    s_add_u32 s57, s56, 14336
    s_mov_b32 s58, 32768
    s_mov_b32 s93, -491520
    v_mov_b32 v228, v232
    v_mov_b32 v229, v233
M_PRE_DONE:
    buffer_load_dwordx4 v[176:179], v206, s[28:31], s71 offen offset:256
    s_mov_b32 s48, s26
    s_mov_b32 s49, s27
    s_mov_b32 s50, 268435456
    s_mov_b32 s51, 0x20000
    s_mov_b32 s80, s24
    s_mov_b32 s81, s25
    s_mov_b32 s82, 256
    s_mov_b32 s83, 0x20000
    s_and_b32 s84, s2, 7
    s_lshl_b32 s84, s84, 2
    s_lshr_b32 s66, s2, 6
    s_add_u32 s84, s84, s66
    s_bfe_u32 s85, s2, 0x30003
    s_lshl_b32 s90, s54, 3
    s_add_u32 s90, s90, s53
    s_lshl_b32 s90, s90, 2
    s_add_u32 s90, s90, s52
    s_lshl_b32 s90, s90, 2
    s_add_u32 s90, s90, 50331648
    v_bfe_u32 v195, v246, 3, 3
    v_and_b32 v196, 7, v246
    v_lshlrev_b32 v196, 7, v196
    v_lshl_add_u32 v252, v195, 10, v196
    buffer_load_dwordx4 v[180:183], v206, s[28:31], s71 offen offset:320
    v_lshrrev_b32 v194, 2, v192
    v_and_b32 v195, 3, v192
    v_lshlrev_b32 v195, 3, v195
    v_lshrrev_b32 v196, 3, v192
    v_lshl_add_u32 v197, v193, 3, v194
    v_lshl_add_u32 v197, v197, 7, s55
    v_and_b32 v198, 1, v193
    v_lshl_add_u32 v198, v198, 1, v196
    v_add_u32 v199, v197, v195
    v_xor_b32 v200, 0, v198
    v_lshl_add_u32 v234, v200, 5, v199
    v_xor_b32 v200, 1, v198
    v_lshl_add_u32 v235, v200, 5, v199
    v_xor_b32 v200, 2, v198
    v_lshl_add_u32 v236, v200, 5, v199
    v_xor_b32 v200, 3, v198
    v_lshl_add_u32 v237, v200, 5, v199
    v_bfe_u32 v199, v192, 1, 1
    v_xor_b32 v198, v198, v199
    v_and_b32 v199, 1, v192
    v_lshl_add_u32 v199, v199, 4, v197
    v_xor_b32 v200, 0, v198
    v_lshl_add_u32 v238, v200, 5, v199
    v_xor_b32 v200, 2, v198
    v_lshl_add_u32 v239, v200, 5, v199
    v_lshl_add_u32 v197, v193, 2, v194
    v_lshl_add_u32 v197, v197, 7, s55
    v_add_u32 v197, v197, v195
    v_lshrrev_b32 v198, 1, v193
    v_xor_b32 v198, v198, v193
    v_and_b32 v198, 1, v198
    v_lshl_add_u32 v198, v198, 1, v196
    v_xor_b32 v200, 0, v198
    v_lshl_add_u32 v240, v200, 5, v197
    v_xor_b32 v200, 1, v198
    v_lshl_add_u32 v241, v200, 5, v197
    v_xor_b32 v200, 2, v198
    v_lshl_add_u32 v242, v200, 5, v197
    v_xor_b32 v200, 3, v198
    v_lshl_add_u32 v243, v200, 5, v197
    v_lshrrev_b32 v197, 1, v193
    v_mul_u32_u24 v197, 24576, v197
    v_and_b32 v198, 1, v193
    buffer_load_dwordx4 v[184:187], v206, s[28:31], s71 offen offset:384
    v_lshl_add_u32 v198, v198, 2, v194
    v_lshl_add_u32 v197, v198, 8, v197
    v_add_u32 v197, v197, v195
    v_add_u32 v197, 73728, v197
    v_xor_b32 v199, 0, v198
    v_lshl_add_u32 v216, v199, 5, v197
    v_xor_b32 v199, 1, v198
    v_lshl_add_u32 v217, v199, 5, v197
    v_xor_b32 v199, 2, v198
    v_lshl_add_u32 v218, v199, 5, v197
    v_xor_b32 v199, 3, v198
    v_lshl_add_u32 v219, v199, 5, v197
    v_xor_b32 v199, 4, v198
    v_lshl_add_u32 v220, v199, 5, v197
    v_xor_b32 v199, 5, v198
    v_lshl_add_u32 v221, v199, 5, v197
    v_xor_b32 v199, 6, v198
    v_lshl_add_u32 v222, v199, 5, v197
    v_xor_b32 v199, 7, v198
    v_lshl_add_u32 v223, v199, 5, v197
    v_mul_u32_u24 v197, 24576, v196
    v_and_b32 v198, 7, v192
    v_lshl_add_u32 v197, v198, 8, v197
    v_add_u32 v197, 73728, v197
    v_xor_b32 v198, v193, v192
    v_xor_b32 v199, 0, v198
    v_lshl_add_u32 v212, v199, 4, v197
    v_xor_b32 v199, 4, v198
    v_lshl_add_u32 v213, v199, 4, v197
    v_xor_b32 v199, 8, v198
    v_lshl_add_u32 v214, v199, 4, v197
    v_xor_b32 v199, 12, v198
    v_lshl_add_u32 v215, v199, 4, v197
    s_lshl_b32 s64, s52, 11
    v_lshl_add_u32 v198, v193, 8, s64
    v_lshlrev_b32 v199, 1, v193
    v_xor_b32 v199, v199, v192
    v_lshl_add_u32 v226, v199, 4, v198
    v_xor_b32 v199, 8, v199
    v_lshl_add_u32 v227, v199, 4, v198
    s_and_b32 s64, s52, 1
    s_lshl_b32 s64, s64, 3
    v_or_b32 v199, s64, v193
    buffer_load_dwordx4 v[188:191], v206, s[28:31], s71 offen offset:448
    v_xor_b32 v199, v199, v192
    v_lshl_add_u32 v224, v199, 4, v198
    v_xor_b32 v199, 4, v199
    v_lshl_add_u32 v225, v199, 4, v198
    s_lshl_b32 s64, s53, 19
    s_add_u32 s40, s6, s64
    s_addc_u32 s41, s7, 0
    s_mov_b32 s42, 524288
    s_mov_b32 s43, 0x20000
    s_add_u32 s44, s8, s64
    s_addc_u32 s45, s9, 0
    s_sub_u32 s44, s44, 10240
    s_subb_u32 s45, s45, 0
    s_mov_b32 s46, 534528
    s_mov_b32 s47, 0x20000
    s_mov_b32 s60, 0
    s_mov_b32 s61, 8192
    s_lshl_b32 s64, s52, 10
    v_and_b32 v197, 3, v246
    v_lshrrev_b32 v198, 2, v246
    v_lshlrev_b32 v199, 1, v197
    v_xor_b32 v198, v198, v199
    v_lshl_add_u32 v198, v197, 4, v198
    v_lshl_add_u32 v200, v198, 4, s64
    v_add_u32 v201, 0x8000, v200
    v_lshlrev_b32 v199, 1, v193
    v_xor_b32 v199, v199, v246
    v_lshlrev_b32 v250, 4, v199
    s_lshl_b32 s76, s91, 12
    v_add_u32 v244, s76, v250
    v_lshrrev_b32 v197, 1, v192
    v_lshrrev_b32 v198, 1, v193
    v_cmp_eq_u32 vcc, v197, v198
    v_mov_b32 v197, 0x3f803f80
    v_and_b32 v198, 1, v192
    v_cndmask_b32 v208, 0, v197, vcc
    v_mul_u32_u24 v198, 0xaaaa, v198
    v_mov_b32 v209, v208
    v_mov_b32 v210, v208
    v_mov_b32 v211, v208
    v_add_u32 v207, 0x4444, v198
    v_lshl_or_b32 v207, v207, 16, v207
    s_mov_b32 s69, 0xffff0000
    s_waitcnt vmcnt(15)
    v_lshlrev_b32 v0, 16, v128
    v_and_b32 v1, s69, v128
    v_lshlrev_b32 v2, 16, v129
    v_and_b32 v3, s69, v129
    v_lshlrev_b32 v4, 16, v130
    v_and_b32 v5, s69, v130
    v_lshlrev_b32 v6, 16, v131
    v_and_b32 v7, s69, v131
    v_pk_mul_f32 v[204:205], v[0:1], v[0:1]
    v_mov_b32 v202, v0
    v_mov_b32 v203, v1
    v_pk_fma_f32 v[204:205], v[2:3], v[2:3], v[204:205]
    v_pk_add_f32 v[202:203], v[2:3], v[202:203]
    v_pk_fma_f32 v[204:205], v[4:5], v[4:5], v[204:205]
    v_pk_add_f32 v[202:203], v[4:5], v[202:203]
    v_pk_fma_f32 v[204:205], v[6:7], v[6:7], v[204:205]
    v_pk_add_f32 v[202:203], v[6:7], v[202:203]
    s_waitcnt vmcnt(14)
    v_lshlrev_b32 v8, 16, v132
    v_and_b32 v9, s69, v132
    v_lshlrev_b32 v10, 16, v133
    v_and_b32 v11, s69, v133
    v_lshlrev_b32 v12, 16, v134
    v_and_b32 v13, s69, v134
    v_lshlrev_b32 v14, 16, v135
    v_and_b32 v15, s69, v135
    v_pk_fma_f32 v[204:205], v[8:9], v[8:9], v[204:205]
    v_pk_add_f32 v[202:203], v[8:9], v[202:203]
    v_pk_fma_f32 v[204:205], v[10:11], v[10:11], v[204:205]
    v_pk_add_f32 v[202:203], v[10:11], v[202:203]
    v_pk_fma_f32 v[204:205], v[12:13], v[12:13], v[204:205]
    v_pk_add_f32 v[202:203], v[12:13], v[202:203]
    v_pk_fma_f32 v[204:205], v[14:15], v[14:15], v[204:205]
    v_pk_add_f32 v[202:203], v[14:15], v[202:203]
    s_waitcnt vmcnt(13)
    v_lshlrev_b32 v16, 16, v136
    v_and_b32 v17, s69, v136
    v_lshlrev_b32 v18, 16, v137
    v_and_b32 v19, s69, v137
    v_lshlrev_b32 v20, 16, v138
    v_and_b32 v21, s69, v138
    v_lshlrev_b32 v22, 16, v139
    v_and_b32 v23, s69, v139
    v_pk_fma_f32 v[204:205], v[16:17], v[16:17], v[204:205]
    v_pk_add_f32 v[202:203], v[16:17], v[202:203]
    v_pk_fma_f32 v[204:205], v[18:19], v[18:19], v[204:205]
    v_pk_add_f32 v[202:203], v[18:19], v[202:203]
    v_pk_fma_f32 v[204:205], v[20:21], v[20:21], v[204:205]
    v_pk_add_f32 v[202:203], v[20:21], v[202:203]
    v_pk_fma_f32 v[204:205], v[22:23], v[22:23], v[204:205]
    v_pk_add_f32 v[202:203], v[22:23], v[202:203]
    s_waitcnt vmcnt(12)
    v_lshlrev_b32 v24, 16, v140
    v_and_b32 v25, s69, v140
    v_lshlrev_b32 v26, 16, v141
    v_and_b32 v27, s69, v141
    v_lshlrev_b32 v28, 16, v142
    v_and_b32 v29, s69, v142
    v_lshlrev_b32 v30, 16, v143
    v_and_b32 v31, s69, v143
    v_pk_fma_f32 v[204:205], v[24:25], v[24:25], v[204:205]
    v_pk_add_f32 v[202:203], v[24:25], v[202:203]
    v_pk_fma_f32 v[204:205], v[26:27], v[26:27], v[204:205]
    v_pk_add_f32 v[202:203], v[26:27], v[202:203]
    v_pk_fma_f32 v[204:205], v[28:29], v[28:29], v[204:205]
    v_pk_add_f32 v[202:203], v[28:29], v[202:203]
    v_pk_fma_f32 v[204:205], v[30:31], v[30:31], v[204:205]
    v_pk_add_f32 v[202:203], v[30:31], v[202:203]
    s_waitcnt vmcnt(11)
    v_lshlrev_b32 v32, 16, v144
    v_and_b32 v33, s69, v144
    v_lshlrev_b32 v34, 16, v145
    v_and_b32 v35, s69, v145
    v_lshlrev_b32 v36, 16, v146
    v_and_b32 v37, s69, v146
    v_lshlrev_b32 v38, 16, v147
    v_and_b32 v39, s69, v147
    v_pk_fma_f32 v[204:205], v[32:33], v[32:33], v[204:205]
    v_pk_add_f32 v[202:203], v[32:33], v[202:203]
    v_pk_fma_f32 v[204:205], v[34:35], v[34:35], v[204:205]
    v_pk_add_f32 v[202:203], v[34:35], v[202:203]
    v_pk_fma_f32 v[204:205], v[36:37], v[36:37], v[204:205]
    v_pk_add_f32 v[202:203], v[36:37], v[202:203]
    v_pk_fma_f32 v[204:205], v[38:39], v[38:39], v[204:205]
    v_pk_add_f32 v[202:203], v[38:39], v[202:203]
    s_add_u32 m0, s55, 4096
    s_nop 0
    buffer_load_dwordx4 v228, s[32:35], s56 offen lds
    buffer_load_dwordx4 v229, s[32:35], s56 offen offset:1024 lds
    s_waitcnt vmcnt(12)
    v_lshlrev_b32 v40, 16, v148
    v_and_b32 v41, s69, v148
    v_lshlrev_b32 v42, 16, v149
    v_and_b32 v43, s69, v149
    v_lshlrev_b32 v44, 16, v150
    v_and_b32 v45, s69, v150
    v_lshlrev_b32 v46, 16, v151
    v_and_b32 v47, s69, v151
    v_pk_fma_f32 v[204:205], v[40:41], v[40:41], v[204:205]
    v_pk_add_f32 v[202:203], v[40:41], v[202:203]
    v_pk_fma_f32 v[204:205], v[42:43], v[42:43], v[204:205]
    v_pk_add_f32 v[202:203], v[42:43], v[202:203]
    v_pk_fma_f32 v[204:205], v[44:45], v[44:45], v[204:205]
    v_pk_add_f32 v[202:203], v[44:45], v[202:203]
    v_pk_fma_f32 v[204:205], v[46:47], v[46:47], v[204:205]
    v_pk_add_f32 v[202:203], v[46:47], v[202:203]
    buffer_load_dwordx4 v228, s[32:35], s57 offen offset:2048 lds
    buffer_load_dwordx4 v229, s[32:35], s57 offen offset:3072 lds
    s_waitcnt vmcnt(13)
    v_lshlrev_b32 v48, 16, v152
    v_and_b32 v49, s69, v152
    v_lshlrev_b32 v50, 16, v153
    v_and_b32 v51, s69, v153
    v_lshlrev_b32 v52, 16, v154
    v_and_b32 v53, s69, v154
    v_lshlrev_b32 v54, 16, v155
    v_and_b32 v55, s69, v155
    v_pk_fma_f32 v[204:205], v[48:49], v[48:49], v[204:205]
    v_pk_add_f32 v[202:203], v[48:49], v[202:203]
    v_pk_fma_f32 v[204:205], v[50:51], v[50:51], v[204:205]
    v_pk_add_f32 v[202:203], v[50:51], v[202:203]
    v_pk_fma_f32 v[204:205], v[52:53], v[52:53], v[204:205]
    v_pk_add_f32 v[202:203], v[52:53], v[202:203]
    v_pk_fma_f32 v[204:205], v[54:55], v[54:55], v[204:205]
    v_pk_add_f32 v[202:203], v[54:55], v[202:203]
    s_add_u32 m0, s55, 8192
    s_nop 0
    buffer_load_dwordx4 v228, s[36:39], s56 offen lds
    buffer_load_dwordx4 v229, s[36:39], s56 offen offset:1024 lds
    s_waitcnt vmcnt(14)
    v_lshlrev_b32 v56, 16, v156
    v_and_b32 v57, s69, v156
    v_lshlrev_b32 v58, 16, v157
    v_and_b32 v59, s69, v157
    v_lshlrev_b32 v60, 16, v158
    v_and_b32 v61, s69, v158
    v_lshlrev_b32 v62, 16, v159
    v_and_b32 v63, s69, v159
    v_pk_fma_f32 v[204:205], v[56:57], v[56:57], v[204:205]
    v_pk_add_f32 v[202:203], v[56:57], v[202:203]
    v_pk_fma_f32 v[204:205], v[58:59], v[58:59], v[204:205]
    v_pk_add_f32 v[202:203], v[58:59], v[202:203]
    v_pk_fma_f32 v[204:205], v[60:61], v[60:61], v[204:205]
    v_pk_add_f32 v[202:203], v[60:61], v[202:203]
    v_pk_fma_f32 v[204:205], v[62:63], v[62:63], v[204:205]
    v_pk_add_f32 v[202:203], v[62:63], v[202:203]
    buffer_load_dwordx4 v228, s[36:39], s57 offen offset:2048 lds
    buffer_load_dwordx4 v229, s[36:39], s57 offen offset:3072 lds
    s_add_u32 s92, s92, 1
    s_cmp_eq_u32 s92, 16
    s_cselect_b32 s64, s93, s58
    s_add_u32 s56, s56, s64
    s_add_u32 s57, s57, s64
    s_waitcnt vmcnt(15)
    v_lshlrev_b32 v64, 16, v160
    v_and_b32 v65, s69, v160
    v_lshlrev_b32 v66, 16, v161
    v_and_b32 v67, s69, v161
    v_lshlrev_b32 v68, 16, v162
    v_and_b32 v69, s69, v162
    v_lshlrev_b32 v70, 16, v163
    v_and_b32 v71, s69, v163
    v_pk_fma_f32 v[204:205], v[64:65], v[64:65], v[204:205]
    v_pk_add_f32 v[202:203], v[64:65], v[202:203]
    v_pk_fma_f32 v[204:205], v[66:67], v[66:67], v[204:205]
    v_pk_add_f32 v[202:203], v[66:67], v[202:203]
    v_pk_fma_f32 v[204:205], v[68:69], v[68:69], v[204:205]
    v_pk_add_f32 v[202:203], v[68:69], v[202:203]
    v_pk_fma_f32 v[204:205], v[70:71], v[70:71], v[204:205]
    v_pk_add_f32 v[202:203], v[70:71], v[202:203]
    s_waitcnt vmcnt(14)
    v_lshlrev_b32 v72, 16, v164
    v_and_b32 v73, s69, v164
    v_lshlrev_b32 v74, 16, v165
    v_and_b32 v75, s69, v165
    v_lshlrev_b32 v76, 16, v166
    v_and_b32 v77, s69, v166
    v_lshlrev_b32 v78, 16, v167
    v_and_b32 v79, s69, v167
    v_pk_fma_f32 v[204:205], v[72:73], v[72:73], v[204:205]
    v_pk_add_f32 v[202:203], v[72:73], v[202:203]
    v_pk_fma_f32 v[204:205], v[74:75], v[74:75], v[204:205]
    v_pk_add_f32 v[202:203], v[74:75], v[202:203]
    v_pk_fma_f32 v[204:205], v[76:77], v[76:77], v[204:205]
    v_pk_add_f32 v[202:203], v[76:77], v[202:203]
    v_pk_fma_f32 v[204:205], v[78:79], v[78:79], v[204:205]
    v_pk_add_f32 v[202:203], v[78:79], v[202:203]
    s_waitcnt vmcnt(13)
    v_lshlrev_b32 v80, 16, v168
    v_and_b32 v81, s69, v168
    v_lshlrev_b32 v82, 16, v169
    v_and_b32 v83, s69, v169
    v_lshlrev_b32 v84, 16, v170
    v_and_b32 v85, s69, v170
    v_lshlrev_b32 v86, 16, v171
    v_and_b32 v87, s69, v171
    v_pk_fma_f32 v[204:205], v[80:81], v[80:81], v[204:205]
    v_pk_add_f32 v[202:203], v[80:81], v[202:203]
    v_pk_fma_f32 v[204:205], v[82:83], v[82:83], v[204:205]
    v_pk_add_f32 v[202:203], v[82:83], v[202:203]
    v_pk_fma_f32 v[204:205], v[84:85], v[84:85], v[204:205]
    v_pk_add_f32 v[202:203], v[84:85], v[202:203]
    v_pk_fma_f32 v[204:205], v[86:87], v[86:87], v[204:205]
    v_pk_add_f32 v[202:203], v[86:87], v[202:203]
    s_waitcnt vmcnt(12)
    v_lshlrev_b32 v88, 16, v172
    v_and_b32 v89, s69, v172
    v_lshlrev_b32 v90, 16, v173
    v_and_b32 v91, s69, v173
    v_lshlrev_b32 v92, 16, v174
    v_and_b32 v93, s69, v174
    v_lshlrev_b32 v94, 16, v175
    v_and_b32 v95, s69, v175
    v_pk_fma_f32 v[204:205], v[88:89], v[88:89], v[204:205]
    v_pk_add_f32 v[202:203], v[88:89], v[202:203]
    v_pk_fma_f32 v[204:205], v[90:91], v[90:91], v[204:205]
    v_pk_add_f32 v[202:203], v[90:91], v[202:203]
    v_pk_fma_f32 v[204:205], v[92:93], v[92:93], v[204:205]
    v_pk_add_f32 v[202:203], v[92:93], v[202:203]
    v_pk_fma_f32 v[204:205], v[94:95], v[94:95], v[204:205]
    v_pk_add_f32 v[202:203], v[94:95], v[202:203]
    s_waitcnt vmcnt(11)
    v_lshlrev_b32 v96, 16, v176
    v_and_b32 v97, s69, v176
    v_lshlrev_b32 v98, 16, v177
    v_and_b32 v99, s69, v177
    v_lshlrev_b32 v100, 16, v178
    v_and_b32 v101, s69, v178
    v_lshlrev_b32 v102, 16, v179
    v_and_b32 v103, s69, v179
    v_pk_fma_f32 v[204:205], v[96:97], v[96:97], v[204:205]
    v_pk_add_f32 v[202:203], v[96:97], v[202:203]
    v_pk_fma_f32 v[204:205], v[98:99], v[98:99], v[204:205]
    v_pk_add_f32 v[202:203], v[98:99], v[202:203]
    v_pk_fma_f32 v[204:205], v[100:101], v[100:101], v[204:205]
    v_pk_add_f32 v[202:203], v[100:101], v[202:203]
    v_pk_fma_f32 v[204:205], v[102:103], v[102:103], v[204:205]
    v_pk_add_f32 v[202:203], v[102:103], v[202:203]
    s_waitcnt vmcnt(10)
    v_lshlrev_b32 v104, 16, v180
    v_and_b32 v105, s69, v180
    v_lshlrev_b32 v106, 16, v181
    v_and_b32 v107, s69, v181
    v_lshlrev_b32 v108, 16, v182
    v_and_b32 v109, s69, v182
    v_lshlrev_b32 v110, 16, v183
    v_and_b32 v111, s69, v183
    v_pk_fma_f32 v[204:205], v[104:105], v[104:105], v[204:205]
    v_pk_add_f32 v[202:203], v[104:105], v[202:203]
    v_pk_fma_f32 v[204:205], v[106:107], v[106:107], v[204:205]
    v_pk_add_f32 v[202:203], v[106:107], v[202:203]
    v_pk_fma_f32 v[204:205], v[108:109], v[108:109], v[204:205]
    v_pk_add_f32 v[202:203], v[108:109], v[202:203]
    v_pk_fma_f32 v[204:205], v[110:111], v[110:111], v[204:205]
    v_pk_add_f32 v[202:203], v[110:111], v[202:203]
    s_waitcnt vmcnt(9)
    v_lshlrev_b32 v112, 16, v184
    v_and_b32 v113, s69, v184
    v_lshlrev_b32 v114, 16, v185
    v_and_b32 v115, s69, v185
    v_lshlrev_b32 v116, 16, v186
    v_and_b32 v117, s69, v186
    v_lshlrev_b32 v118, 16, v187
    v_and_b32 v119, s69, v187
    v_pk_fma_f32 v[204:205], v[112:113], v[112:113], v[204:205]
    v_pk_add_f32 v[202:203], v[112:113], v[202:203]
    v_pk_fma_f32 v[204:205], v[114:115], v[114:115], v[204:205]
    v_pk_add_f32 v[202:203], v[114:115], v[202:203]
    v_pk_fma_f32 v[204:205], v[116:117], v[116:117], v[204:205]
    v_pk_add_f32 v[202:203], v[116:117], v[202:203]
    v_pk_fma_f32 v[204:205], v[118:119], v[118:119], v[204:205]
    v_pk_add_f32 v[202:203], v[118:119], v[202:203]
    s_waitcnt vmcnt(8)
    v_lshlrev_b32 v120, 16, v188
    v_and_b32 v121, s69, v188
    v_lshlrev_b32 v122, 16, v189
    v_and_b32 v123, s69, v189
    v_lshlrev_b32 v124, 16, v190
    v_and_b32 v125, s69, v190
    v_lshlrev_b32 v126, 16, v191
    v_and_b32 v127, s69, v191
    v_pk_fma_f32 v[204:205], v[120:121], v[120:121], v[204:205]
    v_pk_add_f32 v[202:203], v[120:121], v[202:203]
    v_pk_fma_f32 v[204:205], v[122:123], v[122:123], v[204:205]
    v_pk_add_f32 v[202:203], v[122:123], v[202:203]
    v_pk_fma_f32 v[204:205], v[124:125], v[124:125], v[204:205]
    v_pk_add_f32 v[202:203], v[124:125], v[202:203]
    v_pk_fma_f32 v[204:205], v[126:127], v[126:127], v[204:205]
    v_pk_add_f32 v[202:203], v[126:127], v[202:203]
    v_mov_b32 v206, 0
    s_mov_b64 exec, 1
    buffer_store_dword v206, off, s[48:51], s90 sc1
    s_mov_b64 exec, -1
    v_add_f32 v202, v202, v203
    v_add_f32 v204, v204, v205
    s_nop 1
    v_add_f32_dpp v202, v202, v202 quad_perm:[1,0,3,2] row_mask:0xf bank_mask:0xf
    v_add_f32_dpp v204, v204, v204 quad_perm:[1,0,3,2] row_mask:0xf bank_mask:0xf
    s_nop 1
    v_add_f32_dpp v202, v202, v202 quad_perm:[2,3,0,1] row_mask:0xf bank_mask:0xf
    v_add_f32_dpp v204, v204, v204 quad_perm:[2,3,0,1] row_mask:0xf bank_mask:0xf
    v_mul_f32 v202, 0x3b000000, v202
    v_mul_f32 v204, 0x3b000000, v204
    v_fma_f32 v204, -v202, v202, v204
    v_max_f32 v204, 0, v204
    v_add_f32 v204, 0x3727c5ac, v204
    v_rsq_f32 v204, v204
    s_nop 0
    v_mul_f32 v204, 0x3e0293ee, v204
    v_mul_f32 v202, v202, v204
    v_sub_f32 v202, 0, v202
    v_pk_fma_f32 v[0:1], v[0:1], v[204:205], v[202:203] op_sel_hi:[1,0,0]
    v_pk_fma_f32 v[2:3], v[2:3], v[204:205], v[202:203] op_sel_hi:[1,0,0]
    v_pk_fma_f32 v[4:5], v[4:5], v[204:205], v[202:203] op_sel_hi:[1,0,0]
    v_pk_fma_f32 v[6:7], v[6:7], v[204:205], v[202:203] op_sel_hi:[1,0,0]
    v_cvt_pk_bf16_f32 v0, v0, v1
    v_cvt_pk_bf16_f32 v1, v2, v3
    v_cvt_pk_bf16_f32 v2, v4, v5
    v_cvt_pk_bf16_f32 v3, v6, v7
    ds_write_b128 v200, v[0:3] offset:0
    s_add_u32 m0, s55, 12288
    s_nop 0
    buffer_load_dwordx4 v228, s[32:35], s56 offen lds
    v_pk_fma_f32 v[8:9], v[8:9], v[204:205], v[202:203] op_sel_hi:[1,0,0]
    v_pk_fma_f32 v[10:11], v[10:11], v[204:205], v[202:203] op_sel_hi:[1,0,0]
    v_pk_fma_f32 v[12:13], v[12:13], v[204:205], v[202:203] op_sel_hi:[1,0,0]
    v_pk_fma_f32 v[14:15], v[14:15], v[204:205], v[202:203] op_sel_hi:[1,0,0]
    v_cvt_pk_bf16_f32 v8, v8, v9
    v_cvt_pk_bf16_f32 v9, v10, v11
    v_cvt_pk_bf16_f32 v10, v12, v13
    v_cvt_pk_bf16_f32 v11, v14, v15
    ds_write_b128 v200, v[8:11] offset:4096
    v_pk_fma_f32 v[16:17], v[16:17], v[204:205], v[202:203] op_sel_hi:[1,0,0]
    v_pk_fma_f32 v[18:19], v[18:19], v[204:205], v[202:203] op_sel_hi:[1,0,0]
    v_pk_fma_f32 v[20:21], v[20:21], v[204:205], v[202:203] op_sel_hi:[1,0,0]
    v_pk_fma_f32 v[22:23], v[22:23], v[204:205], v[202:203] op_sel_hi:[1,0,0]
    v_cvt_pk_bf16_f32 v16, v16, v17
    v_cvt_pk_bf16_f32 v17, v18, v19
    v_cvt_pk_bf16_f32 v18, v20, v21
    v_cvt_pk_bf16_f32 v19, v22, v23
    ds_write_b128 v200, v[16:19] offset:8192
    buffer_load_dwordx4 v229, s[32:35], s56 offen offset:1024 lds
    v_pk_fma_f32 v[24:25], v[24:25], v[204:205], v[202:203] op_sel_hi:[1,0,0]
    v_pk_fma_f32 v[26:27], v[26:27], v[204:205], v[202:203] op_sel_hi:[1,0,0]
    v_pk_fma_f32 v[28:29], v[28:29], v[204:205], v[202:203] op_sel_hi:[1,0,0]
    v_pk_fma_f32 v[30:31], v[30:31], v[204:205], v[202:203] op_sel_hi:[1,0,0]
    v_cvt_pk_bf16_f32 v24, v24, v25
    v_cvt_pk_bf16_f32 v25, v26, v27
    v_cvt_pk_bf16_f32 v26, v28, v29
    v_cvt_pk_bf16_f32 v27, v30, v31
    ds_write_b128 v200, v[24:27] offset:12288
    v_pk_fma_f32 v[32:33], v[32:33], v[204:205], v[202:203] op_sel_hi:[1,0,0]
    v_pk_fma_f32 v[34:35], v[34:35], v[204:205], v[202:203] op_sel_hi:[1,0,0]
    v_pk_fma_f32 v[36:37], v[36:37], v[204:205], v[202:203] op_sel_hi:[1,0,0]
    v_pk_fma_f32 v[38:39], v[38:39], v[204:205], v[202:203] op_sel_hi:[1,0,0]
    v_cvt_pk_bf16_f32 v32, v32, v33
    v_cvt_pk_bf16_f32 v33, v34, v35
    v_cvt_pk_bf16_f32 v34, v36, v37
    v_cvt_pk_bf16_f32 v35, v38, v39
    ds_write_b128 v200, v[32:35] offset:16384
    buffer_load_dwordx4 v228, s[32:35], s57 offen offset:2048 lds
    v_pk_fma_f32 v[40:41], v[40:41], v[204:205], v[202:203] op_sel_hi:[1,0,0]
    v_pk_fma_f32 v[42:43], v[42:43], v[204:205], v[202:203] op_sel_hi:[1,0,0]
    v_pk_fma_f32 v[44:45], v[44:45], v[204:205], v[202:203] op_sel_hi:[1,0,0]
    v_pk_fma_f32 v[46:47], v[46:47], v[204:205], v[202:203] op_sel_hi:[1,0,0]
    v_cvt_pk_bf16_f32 v40, v40, v41
    v_cvt_pk_bf16_f32 v41, v42, v43
    v_cvt_pk_bf16_f32 v42, v44, v45
    v_cvt_pk_bf16_f32 v43, v46, v47
    ds_write_b128 v200, v[40:43] offset:20480
    v_pk_fma_f32 v[48:49], v[48:49], v[204:205], v[202:203] op_sel_hi:[1,0,0]
    v_pk_fma_f32 v[50:51], v[50:51], v[204:205], v[202:203] op_sel_hi:[1,0,0]
    v_pk_fma_f32 v[52:53], v[52:53], v[204:205], v[202:203] op_sel_hi:[1,0,0]
    v_pk_fma_f32 v[54:55], v[54:55], v[204:205], v[202:203] op_sel_hi:[1,0,0]
    v_cvt_pk_bf16_f32 v48, v48, v49
    v_cvt_pk_bf16_f32 v49, v50, v51
    v_cvt_pk_bf16_f32 v50, v52, v53
    v_cvt_pk_bf16_f32 v51, v54, v55
    ds_write_b128 v200, v[48:51] offset:24576
    buffer_load_dwordx4 v229, s[32:35], s57 offen offset:3072 lds
    v_pk_fma_f32 v[56:57], v[56:57], v[204:205], v[202:203] op_sel_hi:[1,0,0]
    v_pk_fma_f32 v[58:59], v[58:59], v[204:205], v[202:203] op_sel_hi:[1,0,0]
    v_pk_fma_f32 v[60:61], v[60:61], v[204:205], v[202:203] op_sel_hi:[1,0,0]
    v_pk_fma_f32 v[62:63], v[62:63], v[204:205], v[202:203] op_sel_hi:[1,0,0]
    v_cvt_pk_bf16_f32 v56, v56, v57
    v_cvt_pk_bf16_f32 v57, v58, v59
    v_cvt_pk_bf16_f32 v58, v60, v61
    v_cvt_pk_bf16_f32 v59, v62, v63
    ds_write_b128 v200, v[56:59] offset:28672
    v_pk_fma_f32 v[64:65], v[64:65], v[204:205], v[202:203] op_sel_hi:[1,0,0]
    v_pk_fma_f32 v[66:67], v[66:67], v[204:205], v[202:203] op_sel_hi:[1,0,0]
    v_pk_fma_f32 v[68:69], v[68:69], v[204:205], v[202:203] op_sel_hi:[1,0,0]
    v_pk_fma_f32 v[70:71], v[70:71], v[204:205], v[202:203] op_sel_hi:[1,0,0]
    v_cvt_pk_bf16_f32 v64, v64, v65
    v_cvt_pk_bf16_f32 v65, v66, v67
    v_cvt_pk_bf16_f32 v66, v68, v69
    v_cvt_pk_bf16_f32 v67, v70, v71
    ds_write_b128 v201, v[64:67] offset:0
    s_add_u32 m0, s55, 16384
    s_nop 0
    buffer_load_dwordx4 v228, s[36:39], s56 offen lds
    v_pk_fma_f32 v[72:73], v[72:73], v[204:205], v[202:203] op_sel_hi:[1,0,0]
    v_pk_fma_f32 v[74:75], v[74:75], v[204:205], v[202:203] op_sel_hi:[1,0,0]
    v_pk_fma_f32 v[76:77], v[76:77], v[204:205], v[202:203] op_sel_hi:[1,0,0]
    v_pk_fma_f32 v[78:79], v[78:79], v[204:205], v[202:203] op_sel_hi:[1,0,0]
    v_cvt_pk_bf16_f32 v72, v72, v73
    v_cvt_pk_bf16_f32 v73, v74, v75
    v_cvt_pk_bf16_f32 v74, v76, v77
    v_cvt_pk_bf16_f32 v75, v78, v79
    ds_write_b128 v201, v[72:75] offset:4096
    v_pk_fma_f32 v[80:81], v[80:81], v[204:205], v[202:203] op_sel_hi:[1,0,0]
    v_pk_fma_f32 v[82:83], v[82:83], v[204:205], v[202:203] op_sel_hi:[1,0,0]
    v_pk_fma_f32 v[84:85], v[84:85], v[204:205], v[202:203] op_sel_hi:[1,0,0]
    v_pk_fma_f32 v[86:87], v[86:87], v[204:205], v[202:203] op_sel_hi:[1,0,0]
    v_cvt_pk_bf16_f32 v80, v80, v81
    v_cvt_pk_bf16_f32 v81, v82, v83
    v_cvt_pk_bf16_f32 v82, v84, v85
    v_cvt_pk_bf16_f32 v83, v86, v87
    ds_write_b128 v201, v[80:83] offset:8192
    buffer_load_dwordx4 v229, s[36:39], s56 offen offset:1024 lds
    v_pk_fma_f32 v[88:89], v[88:89], v[204:205], v[202:203] op_sel_hi:[1,0,0]
    v_pk_fma_f32 v[90:91], v[90:91], v[204:205], v[202:203] op_sel_hi:[1,0,0]
    v_pk_fma_f32 v[92:93], v[92:93], v[204:205], v[202:203] op_sel_hi:[1,0,0]
    v_pk_fma_f32 v[94:95], v[94:95], v[204:205], v[202:203] op_sel_hi:[1,0,0]
    v_cvt_pk_bf16_f32 v88, v88, v89
    v_cvt_pk_bf16_f32 v89, v90, v91
    v_cvt_pk_bf16_f32 v90, v92, v93
    v_cvt_pk_bf16_f32 v91, v94, v95
    ds_write_b128 v201, v[88:91] offset:12288
    v_pk_fma_f32 v[96:97], v[96:97], v[204:205], v[202:203] op_sel_hi:[1,0,0]
    v_pk_fma_f32 v[98:99], v[98:99], v[204:205], v[202:203] op_sel_hi:[1,0,0]
    v_pk_fma_f32 v[100:101], v[100:101], v[204:205], v[202:203] op_sel_hi:[1,0,0]
    v_pk_fma_f32 v[102:103], v[102:103], v[204:205], v[202:203] op_sel_hi:[1,0,0]
    v_cvt_pk_bf16_f32 v96, v96, v97
    v_cvt_pk_bf16_f32 v97, v98, v99
    v_cvt_pk_bf16_f32 v98, v100, v101
    v_cvt_pk_bf16_f32 v99, v102, v103
    ds_write_b128 v201, v[96:99] offset:16384
    buffer_load_dwordx4 v228, s[36:39], s57 offen offset:2048 lds
    v_pk_fma_f32 v[104:105], v[104:105], v[204:205], v[202:203] op_sel_hi:[1,0,0]
    v_pk_fma_f32 v[106:107], v[106:107], v[204:205], v[202:203] op_sel_hi:[1,0,0]
    v_pk_fma_f32 v[108:109], v[108:109], v[204:205], v[202:203] op_sel_hi:[1,0,0]
    v_pk_fma_f32 v[110:111], v[110:111], v[204:205], v[202:203] op_sel_hi:[1,0,0]
    v_cvt_pk_bf16_f32 v104, v104, v105
    v_cvt_pk_bf16_f32 v105, v106, v107
    v_cvt_pk_bf16_f32 v106, v108, v109
    v_cvt_pk_bf16_f32 v107, v110, v111
    ds_write_b128 v201, v[104:107] offset:20480
    v_pk_fma_f32 v[112:113], v[112:113], v[204:205], v[202:203] op_sel_hi:[1,0,0]
    v_pk_fma_f32 v[114:115], v[114:115], v[204:205], v[202:203] op_sel_hi:[1,0,0]
    v_pk_fma_f32 v[116:117], v[116:117], v[204:205], v[202:203] op_sel_hi:[1,0,0]
    v_pk_fma_f32 v[118:119], v[118:119], v[204:205], v[202:203] op_sel_hi:[1,0,0]
    v_cvt_pk_bf16_f32 v112, v112, v113
    v_cvt_pk_bf16_f32 v113, v114, v115
    v_cvt_pk_bf16_f32 v114, v116, v117
    v_cvt_pk_bf16_f32 v115, v118, v119
    ds_write_b128 v201, v[112:115] offset:24576
    buffer_load_dwordx4 v229, s[36:39], s57 offen offset:3072 lds
    s_add_u32 s92, s92, 1
    s_cmp_eq_u32 s92, 16
    s_cselect_b32 s64, s93, s58
    s_add_u32 s56, s56, s64
    s_add_u32 s57, s57, s64
    v_pk_fma_f32 v[120:121], v[120:121], v[204:205], v[202:203] op_sel_hi:[1,0,0]
    v_pk_fma_f32 v[122:123], v[122:123], v[204:205], v[202:203] op_sel_hi:[1,0,0]
    v_pk_fma_f32 v[124:125], v[124:125], v[204:205], v[202:203] op_sel_hi:[1,0,0]
    v_pk_fma_f32 v[126:127], v[126:127], v[204:205], v[202:203] op_sel_hi:[1,0,0]
    v_cvt_pk_bf16_f32 v120, v120, v121
    v_cvt_pk_bf16_f32 v121, v122, v123
    v_cvt_pk_bf16_f32 v122, v124, v125
    v_cvt_pk_bf16_f32 v123, v126, v127
    ds_write_b128 v201, v[120:123] offset:28672
    s_cmp_eq_u32 s62, 7
    s_cbranch_scc1 M_WD
    s_waitcnt vmcnt(13) lgkmcnt(0)
    s_barrier
    ds_read_b128 a[160:163], v244 offset:0
    ds_read_b128 a[164:167], v244 offset:1024
    ds_read_b128 a[168:171], v244 offset:2048
    ds_read_b128 a[172:175], v244 offset:3072
    ds_read_b64_tr_b16 a[128:129], v234 offset:4096
    ds_read_b64_tr_b16 a[130:131], v236 offset:4608
    ds_read_b64_tr_b16 a[132:133], v235 offset:4096
    ds_read_b64_tr_b16 a[134:135], v237 offset:4608
    ds_read_b64_tr_b16 a[136:137], v236 offset:4096
    ds_read_b64_tr_b16 a[138:139], v234 offset:4608
    ds_read_b64_tr_b16 a[140:141], v237 offset:4096
    ds_read_b64_tr_b16 a[142:143], v235 offset:4608
    s_waitcnt vmcnt(8) lgkmcnt(0)
    v_mfma_f32_16x16x32_bf16 v[0:3], a[128:131], a[160:163], 0
    ds_read_b64_tr_b16 a[144:145], v234 offset:8192
    v_mfma_f32_16x16x32_bf16 v[4:7], a[128:131], a[164:167], 0
    ds_read_b64_tr_b16 a[146:147], v236 offset:8704
    v_mfma_f32_16x16x32_bf16 v[16:19], a[132:135], a[160:163], 0
    ds_read_b64_tr_b16 a[148:149], v235 offset:8192
    v_mfma_f32_16x16x32_bf16 v[20:23], a[132:135], a[164:167], 0
    ds_read_b64_tr_b16 a[150:151], v237 offset:8704
    v_mfma_f32_16x16x32_bf16 v[32:35], a[136:139], a[160:163], 0
    ds_read_b64_tr_b16 a[152:153], v236 offset:8192
    v_mfma_f32_16x16x32_bf16 v[36:39], a[136:139], a[164:167], 0
    s_add_u32 s76, s76, 4096
    ds_read_b64_tr_b16 a[154:155], v234 offset:8704
    v_mfma_f32_16x16x32_bf16 v[48:51], a[140:143], a[160:163], 0
    s_and_b32 s76, s76, 0xffff
    s_add_u32 m0, s55, 20480
    ds_read_b64_tr_b16 a[156:157], v237 offset:8192
    v_mfma_f32_16x16x32_bf16 v[52:55], a[140:143], a[164:167], 0
    ds_read_b64_tr_b16 a[158:159], v235 offset:8704
    buffer_load_dwordx4 v228, s[32:35], s56 offen lds
    v_add_u32 v244, s76, v250
    v_mfma_f32_16x16x32_bf16 v[8:11], a[128:131], a[168:171], 0
    ds_read_b128 a[176:179], v244 offset:0
    buffer_load_dwordx4 v229, s[32:35], s56 offen offset:1024 lds
    v_mfma_f32_16x16x32_bf16 v[12:15], a[128:131], a[172:175], 0
    ds_read_b128 a[180:183], v244 offset:1024
    buffer_load_dwordx4 v228, s[32:35], s57 offen offset:2048 lds
    v_mfma_f32_16x16x32_bf16 v[24:27], a[132:135], a[168:171], 0
    buffer_load_dwordx4 v229, s[32:35], s57 offen offset:3072 lds
    v_mfma_f32_16x16x32_bf16 v[28:31], a[132:135], a[172:175], 0
    s_add_u32 m0, s55, 0
    v_mfma_f32_16x16x32_bf16 v[40:43], a[136:139], a[168:171], 0
    s_add_u32 s92, s92, 1
    buffer_load_dwordx4 v228, s[36:39], s56 offen lds
    v_mfma_f32_16x16x32_bf16 v[44:47], a[136:139], a[172:175], 0
    s_cmp_eq_u32 s92, 16
    buffer_load_dwordx4 v229, s[36:39], s56 offen offset:1024 lds
    v_mfma_f32_16x16x32_bf16 v[56:59], a[140:143], a[168:171], 0
    s_cselect_b32 s64, s93, s58
    buffer_load_dwordx4 v228, s[36:39], s57 offen offset:2048 lds
    v_mfma_f32_16x16x32_bf16 v[60:63], a[140:143], a[172:175], 0
    buffer_load_dwordx4 v229, s[36:39], s57 offen offset:3072 lds
    s_waitcnt vmcnt(12) lgkmcnt(0)
    v_mfma_f32_16x16x32_bf16 v[64:67], a[144:147], a[160:163], 0
    s_add_u32 s56, s56, s64
    ds_read_b64_tr_b16 a[128:129], v234 offset:12288
    v_mfma_f32_16x16x32_bf16 v[68:71], a[144:147], a[164:167], 0
    s_add_u32 s57, s57, s64
    ds_read_b64_tr_b16 a[130:131], v236 offset:12800
    v_mfma_f32_16x16x32_bf16 v[80:83], a[148:151], a[160:163], 0
    ds_read_b64_tr_b16 a[132:133], v235 offset:12288
    v_mfma_f32_16x16x32_bf16 v[84:87], a[148:151], a[164:167], 0
    ds_read_b64_tr_b16 a[134:135], v237 offset:12800
    v_mfma_f32_16x16x32_bf16 v[96:99], a[152:155], a[160:163], 0
    ds_read_b64_tr_b16 a[136:137], v236 offset:12288
    v_mfma_f32_16x16x32_bf16 v[100:103], a[152:155], a[164:167], 0
    ds_read_b64_tr_b16 a[138:139], v234 offset:12800
    v_mfma_f32_16x16x32_bf16 v[112:115], a[156:159], a[160:163], 0
    s_add_u32 m0, s55, 4096
    ds_read_b64_tr_b16 a[140:141], v237 offset:12288
    v_mfma_f32_16x16x32_bf16 v[116:119], a[156:159], a[164:167], 0
    ds_read_b64_tr_b16 a[142:143], v235 offset:12800
    buffer_load_dwordx4 v228, s[32:35], s56 offen lds
    v_mfma_f32_16x16x32_bf16 v[72:75], a[144:147], a[168:171], 0
    ds_read_b128 a[184:187], v244 offset:2048
    buffer_load_dwordx4 v229, s[32:35], s56 offen offset:1024 lds
    v_mfma_f32_16x16x32_bf16 v[76:79], a[144:147], a[172:175], 0
    ds_read_b128 a[188:191], v244 offset:3072
    buffer_load_dwordx4 v228, s[32:35], s57 offen offset:2048 lds
    v_mfma_f32_16x16x32_bf16 v[88:91], a[148:151], a[168:171], 0
    buffer_load_dwordx4 v229, s[32:35], s57 offen offset:3072 lds
    v_mfma_f32_16x16x32_bf16 v[92:95], a[148:151], a[172:175], 0
    s_add_u32 m0, s55, 8192
    v_mfma_f32_16x16x32_bf16 v[104:107], a[152:155], a[168:171], 0
    s_add_u32 s92, s92, 1
    buffer_load_dwordx4 v228, s[36:39], s56 offen lds
    v_mfma_f32_16x16x32_bf16 v[108:111], a[152:155], a[172:175], 0
    s_cmp_eq_u32 s92, 16
    buffer_load_dwordx4 v229, s[36:39], s56 offen offset:1024 lds
    v_mfma_f32_16x16x32_bf16 v[120:123], a[156:159], a[168:171], 0
    s_cselect_b32 s64, s93, s58
    buffer_load_dwordx4 v228, s[36:39], s57 offen offset:2048 lds
    v_mfma_f32_16x16x32_bf16 v[124:127], a[156:159], a[172:175], 0
    buffer_load_dwordx4 v229, s[36:39], s57 offen offset:3072 lds
    s_mov_b32 s59, 4
L_gu:
    s_waitcnt vmcnt(16) lgkmcnt(0)
    v_mfma_f32_16x16x32_bf16 v[0:3], a[128:131], a[176:179], v[0:3]
    s_add_u32 s56, s56, s64
    ds_read_b64_tr_b16 a[144:145], v234 offset:16384
    v_mfma_f32_16x16x32_bf16 v[4:7], a[128:131], a[180:183], v[4:7]
    s_add_u32 s57, s57, s64
    ds_read_b64_tr_b16 a[146:147], v236 offset:16896
    v_mfma_f32_16x16x32_bf16 v[16:19], a[132:135], a[176:179], v[16:19]
    ds_read_b64_tr_b16 a[148:149], v235 offset:16384
    v_mfma_f32_16x16x32_bf16 v[20:23], a[132:135], a[180:183], v[20:23]
    ds_read_b64_tr_b16 a[150:151], v237 offset:16896
    v_mfma_f32_16x16x32_bf16 v[32:35], a[136:139], a[176:179], v[32:35]
    ds_read_b64_tr_b16 a[152:153], v236 offset:16384
    v_mfma_f32_16x16x32_bf16 v[36:39], a[136:139], a[180:183], v[36:39]
    s_add_u32 s76, s76, 4096
    ds_read_b64_tr_b16 a[154:155], v234 offset:16896
    v_mfma_f32_16x16x32_bf16 v[48:51], a[140:143], a[176:179], v[48:51]
    s_and_b32 s76, s76, 0xffff
    ds_read_b64_tr_b16 a[156:157], v237 offset:16384
    v_mfma_f32_16x16x32_bf16 v[52:55], a[140:143], a[180:183], v[52:55]
    ds_read_b64_tr_b16 a[158:159], v235 offset:16896
    v_add_u32 v244, s76, v250
    v_mfma_f32_16x16x32_bf16 v[8:11], a[128:131], a[184:187], v[8:11]
    ds_read_b128 a[192:195], v244 offset:0
    v_mfma_f32_16x16x32_bf16 v[12:15], a[128:131], a[188:191], v[12:15]
    ds_read_b128 a[196:199], v244 offset:1024
    v_mfma_f32_16x16x32_bf16 v[24:27], a[132:135], a[184:187], v[24:27]
    v_mfma_f32_16x16x32_bf16 v[28:31], a[132:135], a[188:191], v[28:31]
    s_add_u32 m0, s55, 12288
    v_mfma_f32_16x16x32_bf16 v[40:43], a[136:139], a[184:187], v[40:43]
    buffer_load_dwordx4 v228, s[32:35], s56 offen lds
    v_mfma_f32_16x16x32_bf16 v[44:47], a[136:139], a[188:191], v[44:47]
    buffer_load_dwordx4 v229, s[32:35], s56 offen offset:1024 lds
    v_mfma_f32_16x16x32_bf16 v[56:59], a[140:143], a[184:187], v[56:59]
    buffer_load_dwordx4 v228, s[32:35], s57 offen offset:2048 lds
    v_mfma_f32_16x16x32_bf16 v[60:63], a[140:143], a[188:191], v[60:63]
    buffer_load_dwordx4 v229, s[32:35], s57 offen offset:3072 lds
    s_waitcnt vmcnt(16) lgkmcnt(0)
    v_mfma_f32_16x16x32_bf16 v[64:67], a[144:147], a[176:179], v[64:67]
    ds_read_b64_tr_b16 a[128:129], v234 offset:20480
    v_mfma_f32_16x16x32_bf16 v[68:71], a[144:147], a[180:183], v[68:71]
    ds_read_b64_tr_b16 a[130:131], v236 offset:20992
    v_mfma_f32_16x16x32_bf16 v[80:83], a[148:151], a[176:179], v[80:83]
    ds_read_b64_tr_b16 a[132:133], v235 offset:20480
    v_mfma_f32_16x16x32_bf16 v[84:87], a[148:151], a[180:183], v[84:87]
    ds_read_b64_tr_b16 a[134:135], v237 offset:20992
    v_mfma_f32_16x16x32_bf16 v[96:99], a[152:155], a[176:179], v[96:99]
    ds_read_b64_tr_b16 a[136:137], v236 offset:20480
    v_mfma_f32_16x16x32_bf16 v[100:103], a[152:155], a[180:183], v[100:103]
    ds_read_b64_tr_b16 a[138:139], v234 offset:20992
    v_mfma_f32_16x16x32_bf16 v[112:115], a[156:159], a[176:179], v[112:115]
    ds_read_b64_tr_b16 a[140:141], v237 offset:20480
    v_mfma_f32_16x16x32_bf16 v[116:119], a[156:159], a[180:183], v[116:119]
    ds_read_b64_tr_b16 a[142:143], v235 offset:20992
    v_mfma_f32_16x16x32_bf16 v[72:75], a[144:147], a[184:187], v[72:75]
    ds_read_b128 a[200:203], v244 offset:2048
    v_mfma_f32_16x16x32_bf16 v[76:79], a[144:147], a[188:191], v[76:79]
    ds_read_b128 a[204:207], v244 offset:3072
    v_mfma_f32_16x16x32_bf16 v[88:91], a[148:151], a[184:187], v[88:91]
    v_mfma_f32_16x16x32_bf16 v[92:95], a[148:151], a[188:191], v[92:95]
    s_add_u32 m0, s55, 16384
    v_mfma_f32_16x16x32_bf16 v[104:107], a[152:155], a[184:187], v[104:107]
    s_add_u32 s92, s92, 1
    buffer_load_dwordx4 v228, s[36:39], s56 offen lds
    v_mfma_f32_16x16x32_bf16 v[108:111], a[152:155], a[188:191], v[108:111]
    s_cmp_eq_u32 s92, 16
    buffer_load_dwordx4 v229, s[36:39], s56 offen offset:1024 lds
    v_mfma_f32_16x16x32_bf16 v[120:123], a[156:159], a[184:187], v[120:123]
    s_cselect_b32 s64, s93, s58
    buffer_load_dwordx4 v228, s[36:39], s57 offen offset:2048 lds
    v_mfma_f32_16x16x32_bf16 v[124:127], a[156:159], a[188:191], v[124:127]
    buffer_load_dwordx4 v229, s[36:39], s57 offen offset:3072 lds
    s_waitcnt vmcnt(16) lgkmcnt(0)
    v_mfma_f32_16x16x32_bf16 v[0:3], a[128:131], a[192:195], v[0:3]
    s_add_u32 s56, s56, s64
    ds_read_b64_tr_b16 a[144:145], v234 offset:0
    v_mfma_f32_16x16x32_bf16 v[4:7], a[128:131], a[196:199], v[4:7]
    s_add_u32 s57, s57, s64
    ds_read_b64_tr_b16 a[146:147], v236 offset:512
    v_mfma_f32_16x16x32_bf16 v[16:19], a[132:135], a[192:195], v[16:19]
    ds_read_b64_tr_b16 a[148:149], v235 offset:0
    v_mfma_f32_16x16x32_bf16 v[20:23], a[132:135], a[196:199], v[20:23]
    ds_read_b64_tr_b16 a[150:151], v237 offset:512
    v_mfma_f32_16x16x32_bf16 v[32:35], a[136:139], a[192:195], v[32:35]
    ds_read_b64_tr_b16 a[152:153], v236 offset:0
    v_mfma_f32_16x16x32_bf16 v[36:39], a[136:139], a[196:199], v[36:39]
    s_add_u32 s76, s76, 4096
    ds_read_b64_tr_b16 a[154:155], v234 offset:512
    v_mfma_f32_16x16x32_bf16 v[48:51], a[140:143], a[192:195], v[48:51]
    s_and_b32 s76, s76, 0xffff
    ds_read_b64_tr_b16 a[156:157], v237 offset:0
    v_mfma_f32_16x16x32_bf16 v[52:55], a[140:143], a[196:199], v[52:55]
    ds_read_b64_tr_b16 a[158:159], v235 offset:512
    v_add_u32 v244, s76, v250
    v_mfma_f32_16x16x32_bf16 v[8:11], a[128:131], a[200:203], v[8:11]
    ds_read_b128 a[160:163], v244 offset:0
    v_mfma_f32_16x16x32_bf16 v[12:15], a[128:131], a[204:207], v[12:15]
    ds_read_b128 a[164:167], v244 offset:1024
    v_mfma_f32_16x16x32_bf16 v[24:27], a[132:135], a[200:203], v[24:27]
    v_mfma_f32_16x16x32_bf16 v[28:31], a[132:135], a[204:207], v[28:31]
    s_add_u32 m0, s55, 20480
    v_mfma_f32_16x16x32_bf16 v[40:43], a[136:139], a[200:203], v[40:43]
    buffer_load_dwordx4 v228, s[32:35], s56 offen lds
    v_mfma_f32_16x16x32_bf16 v[44:47], a[136:139], a[204:207], v[44:47]
    buffer_load_dwordx4 v229, s[32:35], s56 offen offset:1024 lds
    v_mfma_f32_16x16x32_bf16 v[56:59], a[140:143], a[200:203], v[56:59]
    buffer_load_dwordx4 v228, s[32:35], s57 offen offset:2048 lds
    v_mfma_f32_16x16x32_bf16 v[60:63], a[140:143], a[204:207], v[60:63]
    buffer_load_dwordx4 v229, s[32:35], s57 offen offset:3072 lds
    s_waitcnt vmcnt(16) lgkmcnt(0)
    v_mfma_f32_16x16x32_bf16 v[64:67], a[144:147], a[192:195], v[64:67]
    ds_read_b64_tr_b16 a[128:129], v234 offset:4096
    v_mfma_f32_16x16x32_bf16 v[68:71], a[144:147], a[196:199], v[68:71]
    ds_read_b64_tr_b16 a[130:131], v236 offset:4608
    v_mfma_f32_16x16x32_bf16 v[80:83], a[148:151], a[192:195], v[80:83]
    ds_read_b64_tr_b16 a[132:133], v235 offset:4096
    v_mfma_f32_16x16x32_bf16 v[84:87], a[148:151], a[196:199], v[84:87]
    ds_read_b64_tr_b16 a[134:135], v237 offset:4608
    v_mfma_f32_16x16x32_bf16 v[96:99], a[152:155], a[192:195], v[96:99]
    ds_read_b64_tr_b16 a[136:137], v236 offset:4096
    v_mfma_f32_16x16x32_bf16 v[100:103], a[152:155], a[196:199], v[100:103]
    ds_read_b64_tr_b16 a[138:139], v234 offset:4608
    v_mfma_f32_16x16x32_bf16 v[112:115], a[156:159], a[192:195], v[112:115]
    ds_read_b64_tr_b16 a[140:141], v237 offset:4096
    v_mfma_f32_16x16x32_bf16 v[116:119], a[156:159], a[196:199], v[116:119]
    ds_read_b64_tr_b16 a[142:143], v235 offset:4608
    v_mfma_f32_16x16x32_bf16 v[72:75], a[144:147], a[200:203], v[72:75]
    ds_read_b128 a[168:171], v244 offset:2048
    v_mfma_f32_16x16x32_bf16 v[76:79], a[144:147], a[204:207], v[76:79]
    ds_read_b128 a[172:175], v244 offset:3072
    v_mfma_f32_16x16x32_bf16 v[88:91], a[148:151], a[200:203], v[88:91]
    v_mfma_f32_16x16x32_bf16 v[92:95], a[148:151], a[204:207], v[92:95]
    s_add_u32 m0, s55, 0
    v_mfma_f32_16x16x32_bf16 v[104:107], a[152:155], a[200:203], v[104:107]
    s_add_u32 s92, s92, 1
    buffer_load_dwordx4 v228, s[36:39], s56 offen lds
    v_mfma_f32_16x16x32_bf16 v[108:111], a[152:155], a[204:207], v[108:111]
    s_cmp_eq_u32 s92, 16
    buffer_load_dwordx4 v229, s[36:39], s56 offen offset:1024 lds
    v_mfma_f32_16x16x32_bf16 v[120:123], a[156:159], a[200:203], v[120:123]
    s_cselect_b32 s64, s93, s58
    buffer_load_dwordx4 v228, s[36:39], s57 offen offset:2048 lds
    v_mfma_f32_16x16x32_bf16 v[124:127], a[156:159], a[204:207], v[124:127]
    buffer_load_dwordx4 v229, s[36:39], s57 offen offset:3072 lds
    s_waitcnt vmcnt(16) lgkmcnt(0)
    v_mfma_f32_16x16x32_bf16 v[0:3], a[128:131], a[160:163], v[0:3]
    s_add_u32 s56, s56, s64
    ds_read_b64_tr_b16 a[144:145], v234 offset:8192
    v_mfma_f32_16x16x32_bf16 v[4:7], a[128:131], a[164:167], v[4:7]
    s_add_u32 s57, s57, s64
    ds_read_b64_tr_b16 a[146:147], v236 offset:8704
    v_mfma_f32_16x16x32_bf16 v[16:19], a[132:135], a[160:163], v[16:19]
    ds_read_b64_tr_b16 a[148:149], v235 offset:8192
    v_mfma_f32_16x16x32_bf16 v[20:23], a[132:135], a[164:167], v[20:23]
    ds_read_b64_tr_b16 a[150:151], v237 offset:8704
    v_mfma_f32_16x16x32_bf16 v[32:35], a[136:139], a[160:163], v[32:35]
    ds_read_b64_tr_b16 a[152:153], v236 offset:8192
    v_mfma_f32_16x16x32_bf16 v[36:39], a[136:139], a[164:167], v[36:39]
    s_add_u32 s76, s76, 4096
    ds_read_b64_tr_b16 a[154:155], v234 offset:8704
    v_mfma_f32_16x16x32_bf16 v[48:51], a[140:143], a[160:163], v[48:51]
    s_and_b32 s76, s76, 0xffff
    ds_read_b64_tr_b16 a[156:157], v237 offset:8192
    v_mfma_f32_16x16x32_bf16 v[52:55], a[140:143], a[164:167], v[52:55]
    ds_read_b64_tr_b16 a[158:159], v235 offset:8704
    v_add_u32 v244, s76, v250
    v_mfma_f32_16x16x32_bf16 v[8:11], a[128:131], a[168:171], v[8:11]
    ds_read_b128 a[176:179], v244 offset:0
    v_mfma_f32_16x16x32_bf16 v[12:15], a[128:131], a[172:175], v[12:15]
    ds_read_b128 a[180:183], v244 offset:1024
    v_mfma_f32_16x16x32_bf16 v[24:27], a[132:135], a[168:171], v[24:27]
    v_mfma_f32_16x16x32_bf16 v[28:31], a[132:135], a[172:175], v[28:31]
    s_add_u32 m0, s55, 4096
    v_mfma_f32_16x16x32_bf16 v[40:43], a[136:139], a[168:171], v[40:43]
    buffer_load_dwordx4 v228, s[32:35], s56 offen lds
    v_mfma_f32_16x16x32_bf16 v[44:47], a[136:139], a[172:175], v[44:47]
    buffer_load_dwordx4 v229, s[32:35], s56 offen offset:1024 lds
    v_mfma_f32_16x16x32_bf16 v[56:59], a[140:143], a[168:171], v[56:59]
    buffer_load_dwordx4 v228, s[32:35], s57 offen offset:2048 lds
    v_mfma_f32_16x16x32_bf16 v[60:63], a[140:143], a[172:175], v[60:63]
    buffer_load_dwordx4 v229, s[32:35], s57 offen offset:3072 lds
    s_waitcnt vmcnt(16) lgkmcnt(0)
    v_mfma_f32_16x16x32_bf16 v[64:67], a[144:147], a[160:163], v[64:67]
    ds_read_b64_tr_b16 a[128:129], v234 offset:12288
    v_mfma_f32_16x16x32_bf16 v[68:71], a[144:147], a[164:167], v[68:71]
    ds_read_b64_tr_b16 a[130:131], v236 offset:12800
    v_mfma_f32_16x16x32_bf16 v[80:83], a[148:151], a[160:163], v[80:83]
    ds_read_b64_tr_b16 a[132:133], v235 offset:12288
    v_mfma_f32_16x16x32_bf16 v[84:87], a[148:151], a[164:167], v[84:87]
    s_sub_u32 s59, s59, 1
    ds_read_b64_tr_b16 a[134:135], v237 offset:12800
    v_mfma_f32_16x16x32_bf16 v[96:99], a[152:155], a[160:163], v[96:99]
    ds_read_b64_tr_b16 a[136:137], v236 offset:12288
    v_mfma_f32_16x16x32_bf16 v[100:103], a[152:155], a[164:167], v[100:103]
    ds_read_b64_tr_b16 a[138:139], v234 offset:12800
    v_mfma_f32_16x16x32_bf16 v[112:115], a[156:159], a[160:163], v[112:115]
    ds_read_b64_tr_b16 a[140:141], v237 offset:12288
    v_mfma_f32_16x16x32_bf16 v[116:119], a[156:159], a[164:167], v[116:119]
    ds_read_b64_tr_b16 a[142:143], v235 offset:12800
    v_mfma_f32_16x16x32_bf16 v[72:75], a[144:147], a[168:171], v[72:75]
    ds_read_b128 a[184:187], v244 offset:2048
    v_mfma_f32_16x16x32_bf16 v[76:79], a[144:147], a[172:175], v[76:79]
    ds_read_b128 a[188:191], v244 offset:3072
    v_mfma_f32_16x16x32_bf16 v[88:91], a[148:151], a[168:171], v[88:91]
    v_mfma_f32_16x16x32_bf16 v[92:95], a[148:151], a[172:175], v[92:95]
    s_add_u32 m0, s55, 8192
    v_mfma_f32_16x16x32_bf16 v[104:107], a[152:155], a[168:171], v[104:107]
    s_add_u32 s92, s92, 1
    buffer_load_dwordx4 v228, s[36:39], s56 offen lds
    v_mfma_f32_16x16x32_bf16 v[108:111], a[152:155], a[172:175], v[108:111]
    s_cmp_eq_u32 s92, 16
    buffer_load_dwordx4 v229, s[36:39], s56 offen offset:1024 lds
    v_mfma_f32_16x16x32_bf16 v[120:123], a[156:159], a[168:171], v[120:123]
    s_cselect_b32 s64, s93, s58
    buffer_load_dwordx4 v228, s[36:39], s57 offen offset:2048 lds
    v_mfma_f32_16x16x32_bf16 v[124:127], a[156:159], a[172:175], v[124:127]
    buffer_load_dwordx4 v229, s[36:39], s57 offen offset:3072 lds
    s_cmp_lg_u32 s59, 0
    s_cbranch_scc1 L_gu
    s_mov_b32 s32, s10
    s_mov_b32 s33, s11
    s_mov_b32 s34, 4194304
    s_mov_b32 s35, 0x20000
    s_add_u32 s36, s10, 128
    s_addc_u32 s37, s11, 0
    s_mov_b32 s38, 4194176
    s_mov_b32 s39, 0x20000
    s_lshl_b32 s56, s53, 10
    s_lshl_b32 s64, s52, 8
    s_add_u32 s56, s56, s64
    s_mul_i32 s64, s91, 262144
    s_add_u32 s56, s56, s64
    s_mov_b32 s92, s91
    s_add_u32 s57, s56, 129024
    s_mov_b32 s58, 262144
    s_mov_b32 s93, -3932160
    s_waitcnt vmcnt(16) lgkmcnt(0)
    v_mfma_f32_16x16x32_bf16 v[0:3], a[128:131], a[176:179], v[0:3]
    ds_read_b64_tr_b16 a[144:145], v234 offset:16384
    v_mfma_f32_16x16x32_bf16 v[4:7], a[128:131], a[180:183], v[4:7]
    ds_read_b64_tr_b16 a[146:147], v236 offset:16896
    v_mfma_f32_16x16x32_bf16 v[16:19], a[132:135], a[176:179], v[16:19]
    ds_read_b64_tr_b16 a[148:149], v235 offset:16384
    v_mfma_f32_16x16x32_bf16 v[20:23], a[132:135], a[180:183], v[20:23]
    ds_read_b64_tr_b16 a[150:151], v237 offset:16896
    v_mfma_f32_16x16x32_bf16 v[32:35], a[136:139], a[176:179], v[32:35]
    ds_read_b64_tr_b16 a[152:153], v236 offset:16384
    v_mfma_f32_16x16x32_bf16 v[36:39], a[136:139], a[180:183], v[36:39]
    s_add_u32 s76, s76, 4096
    ds_read_b64_tr_b16 a[154:155], v234 offset:16896
    v_mfma_f32_16x16x32_bf16 v[48:51], a[140:143], a[176:179], v[48:51]
    s_and_b32 s76, s76, 0xffff
    ds_read_b64_tr_b16 a[156:157], v237 offset:16384
    v_mfma_f32_16x16x32_bf16 v[52:55], a[140:143], a[180:183], v[52:55]
    ds_read_b64_tr_b16 a[158:159], v235 offset:16896
    v_add_u32 v244, s76, v250
    v_mfma_f32_16x16x32_bf16 v[8:11], a[128:131], a[184:187], v[8:11]
    ds_read_b128 a[192:195], v244 offset:0
    v_mfma_f32_16x16x32_bf16 v[12:15], a[128:131], a[188:191], v[12:15]
    ds_read_b128 a[196:199], v244 offset:1024
    v_mfma_f32_16x16x32_bf16 v[24:27], a[132:135], a[184:187], v[24:27]
    v_mfma_f32_16x16x32_bf16 v[28:31], a[132:135], a[188:191], v[28:31]
    s_add_u32 m0, s55, 12288
    v_mfma_f32_16x16x32_bf16 v[40:43], a[136:139], a[184:187], v[40:43]
    buffer_load_dwordx4 v230, s[32:35], s56 offen lds
    v_mfma_f32_16x16x32_bf16 v[44:47], a[136:139], a[188:191], v[44:47]
    buffer_load_dwordx4 v231, s[32:35], s56 offen offset:1024 lds
    v_mfma_f32_16x16x32_bf16 v[56:59], a[140:143], a[184:187], v[56:59]
    buffer_load_dwordx4 v230, s[32:35], s57 offen offset:2048 lds
    v_mfma_f32_16x16x32_bf16 v[60:63], a[140:143], a[188:191], v[60:63]
    buffer_load_dwordx4 v231, s[32:35], s57 offen offset:3072 lds
    s_waitcnt vmcnt(16) lgkmcnt(0)
    v_mfma_f32_16x16x32_bf16 v[64:67], a[144:147], a[176:179], v[64:67]
    ds_read_b64_tr_b16 a[128:129], v234 offset:20480
    v_mfma_f32_16x16x32_bf16 v[68:71], a[144:147], a[180:183], v[68:71]
    ds_read_b64_tr_b16 a[130:131], v236 offset:20992
    v_mfma_f32_16x16x32_bf16 v[80:83], a[148:151], a[176:179], v[80:83]
    ds_read_b64_tr_b16 a[132:133], v235 offset:20480
    v_mfma_f32_16x16x32_bf16 v[84:87], a[148:151], a[180:183], v[84:87]
    ds_read_b64_tr_b16 a[134:135], v237 offset:20992
    v_mfma_f32_16x16x32_bf16 v[96:99], a[152:155], a[176:179], v[96:99]
    ds_read_b64_tr_b16 a[136:137], v236 offset:20480
    v_mfma_f32_16x16x32_bf16 v[100:103], a[152:155], a[180:183], v[100:103]
    ds_read_b64_tr_b16 a[138:139], v234 offset:20992
    v_mfma_f32_16x16x32_bf16 v[112:115], a[156:159], a[176:179], v[112:115]
    ds_read_b64_tr_b16 a[140:141], v237 offset:20480
    v_mfma_f32_16x16x32_bf16 v[116:119], a[156:159], a[180:183], v[116:119]
    ds_read_b64_tr_b16 a[142:143], v235 offset:20992
    v_mfma_f32_16x16x32_bf16 v[72:75], a[144:147], a[184:187], v[72:75]
    ds_read_b128 a[200:203], v244 offset:2048
    v_mfma_f32_16x16x32_bf16 v[76:79], a[144:147], a[188:191], v[76:79]
    ds_read_b128 a[204:207], v244 offset:3072
    v_mfma_f32_16x16x32_bf16 v[88:91], a[148:151], a[184:187], v[88:91]
    v_mfma_f32_16x16x32_bf16 v[92:95], a[148:151], a[188:191], v[92:95]
    s_add_u32 m0, s55, 16384
    v_mfma_f32_16x16x32_bf16 v[104:107], a[152:155], a[184:187], v[104:107]
    s_add_u32 s92, s92, 1
    buffer_load_dwordx4 v230, s[36:39], s56 offen lds
    v_mfma_f32_16x16x32_bf16 v[108:111], a[152:155], a[188:191], v[108:111]
    s_cmp_eq_u32 s92, 16
    buffer_load_dwordx4 v231, s[36:39], s56 offen offset:1024 lds
    v_mfma_f32_16x16x32_bf16 v[120:123], a[156:159], a[184:187], v[120:123]
    s_cselect_b32 s64, s93, s58
    buffer_load_dwordx4 v230, s[36:39], s57 offen offset:2048 lds
    v_mfma_f32_16x16x32_bf16 v[124:127], a[156:159], a[188:191], v[124:127]
    buffer_load_dwordx4 v231, s[36:39], s57 offen offset:3072 lds
    s_add_u32 s56, s56, s64
    s_add_u32 s57, s57, s64
    s_waitcnt vmcnt(16) lgkmcnt(0)
    v_mfma_f32_16x16x32_bf16 v[0:3], a[128:131], a[192:195], v[0:3]
    ds_read_b64_tr_b16 a[144:145], v234 offset:0
    v_mfma_f32_16x16x32_bf16 v[4:7], a[128:131], a[196:199], v[4:7]
    ds_read_b64_tr_b16 a[146:147], v236 offset:512
    v_mfma_f32_16x16x32_bf16 v[16:19], a[132:135], a[192:195], v[16:19]
    ds_read_b64_tr_b16 a[148:149], v235 offset:0
    v_mfma_f32_16x16x32_bf16 v[20:23], a[132:135], a[196:199], v[20:23]
    ds_read_b64_tr_b16 a[150:151], v237 offset:512
    v_mfma_f32_16x16x32_bf16 v[32:35], a[136:139], a[192:195], v[32:35]
    ds_read_b64_tr_b16 a[152:153], v236 offset:0
    v_mfma_f32_16x16x32_bf16 v[36:39], a[136:139], a[196:199], v[36:39]
    s_add_u32 s76, s76, 4096
    ds_read_b64_tr_b16 a[154:155], v234 offset:512
    v_mfma_f32_16x16x32_bf16 v[48:51], a[140:143], a[192:195], v[48:51]
    s_and_b32 s76, s76, 0xffff
    ds_read_b64_tr_b16 a[156:157], v237 offset:0
    v_mfma_f32_16x16x32_bf16 v[52:55], a[140:143], a[196:199], v[52:55]
    ds_read_b64_tr_b16 a[158:159], v235 offset:512
    v_add_u32 v244, s76, v250
    v_mfma_f32_16x16x32_bf16 v[8:11], a[128:131], a[200:203], v[8:11]
    ds_read_b128 a[160:163], v244 offset:0
    v_mfma_f32_16x16x32_bf16 v[12:15], a[128:131], a[204:207], v[12:15]
    ds_read_b128 a[164:167], v244 offset:1024
    v_mfma_f32_16x16x32_bf16 v[24:27], a[132:135], a[200:203], v[24:27]
    v_mfma_f32_16x16x32_bf16 v[28:31], a[132:135], a[204:207], v[28:31]
    s_add_u32 m0, s55, 20480
    v_mfma_f32_16x16x32_bf16 v[40:43], a[136:139], a[200:203], v[40:43]
    buffer_load_dwordx4 v230, s[32:35], s56 offen lds
    v_mfma_f32_16x16x32_bf16 v[44:47], a[136:139], a[204:207], v[44:47]
    buffer_load_dwordx4 v231, s[32:35], s56 offen offset:1024 lds
    v_mfma_f32_16x16x32_bf16 v[56:59], a[140:143], a[200:203], v[56:59]
    buffer_load_dwordx4 v230, s[32:35], s57 offen offset:2048 lds
    v_mfma_f32_16x16x32_bf16 v[60:63], a[140:143], a[204:207], v[60:63]
    buffer_load_dwordx4 v231, s[32:35], s57 offen offset:3072 lds
    s_waitcnt vmcnt(16) lgkmcnt(0)
    v_mfma_f32_16x16x32_bf16 v[64:67], a[144:147], a[192:195], v[64:67]
    ds_read_b64_tr_b16 a[128:129], v234 offset:4096
    v_mfma_f32_16x16x32_bf16 v[68:71], a[144:147], a[196:199], v[68:71]
    ds_read_b64_tr_b16 a[130:131], v236 offset:4608
    v_mfma_f32_16x16x32_bf16 v[80:83], a[148:151], a[192:195], v[80:83]
    ds_read_b64_tr_b16 a[132:133], v235 offset:4096
    v_mfma_f32_16x16x32_bf16 v[84:87], a[148:151], a[196:199], v[84:87]
    ds_read_b64_tr_b16 a[134:135], v237 offset:4608
    v_mfma_f32_16x16x32_bf16 v[96:99], a[152:155], a[192:195], v[96:99]
    ds_read_b64_tr_b16 a[136:137], v236 offset:4096
    v_mfma_f32_16x16x32_bf16 v[100:103], a[152:155], a[196:199], v[100:103]
    ds_read_b64_tr_b16 a[138:139], v234 offset:4608
    v_mfma_f32_16x16x32_bf16 v[112:115], a[156:159], a[192:195], v[112:115]
    ds_read_b64_tr_b16 a[140:141], v237 offset:4096
    v_mfma_f32_16x16x32_bf16 v[116:119], a[156:159], a[196:199], v[116:119]
    ds_read_b64_tr_b16 a[142:143], v235 offset:4608
    v_mfma_f32_16x16x32_bf16 v[72:75], a[144:147], a[200:203], v[72:75]
    ds_read_b128 a[168:171], v244 offset:2048
    v_mfma_f32_16x16x32_bf16 v[76:79], a[144:147], a[204:207], v[76:79]
    ds_read_b128 a[172:175], v244 offset:3072
    v_mfma_f32_16x16x32_bf16 v[88:91], a[148:151], a[200:203], v[88:91]
    v_mfma_f32_16x16x32_bf16 v[92:95], a[148:151], a[204:207], v[92:95]
    s_add_u32 m0, s55, 0
    v_mfma_f32_16x16x32_bf16 v[104:107], a[152:155], a[200:203], v[104:107]
    s_add_u32 s92, s92, 1
    buffer_load_dwordx4 v230, s[36:39], s56 offen lds
    v_mfma_f32_16x16x32_bf16 v[108:111], a[152:155], a[204:207], v[108:111]
    s_cmp_eq_u32 s92, 16
    buffer_load_dwordx4 v231, s[36:39], s56 offen offset:1024 lds
    v_mfma_f32_16x16x32_bf16 v[120:123], a[156:159], a[200:203], v[120:123]
    s_cselect_b32 s64, s93, s58
    buffer_load_dwordx4 v230, s[36:39], s57 offen offset:2048 lds
    v_mfma_f32_16x16x32_bf16 v[124:127], a[156:159], a[204:207], v[124:127]
    buffer_load_dwordx4 v231, s[36:39], s57 offen offset:3072 lds
    s_add_u32 s56, s56, s64
    s_add_u32 s57, s57, s64
    s_waitcnt vmcnt(16) lgkmcnt(0)
    v_mfma_f32_16x16x32_bf16 v[0:3], a[128:131], a[160:163], v[0:3]
    ds_read_b64_tr_b16 a[144:145], v234 offset:8192
    v_mfma_f32_16x16x32_bf16 v[4:7], a[128:131], a[164:167], v[4:7]
    ds_read_b64_tr_b16 a[146:147], v236 offset:8704
    v_mfma_f32_16x16x32_bf16 v[16:19], a[132:135], a[160:163], v[16:19]
    ds_read_b64_tr_b16 a[148:149], v235 offset:8192
    v_mfma_f32_16x16x32_bf16 v[20:23], a[132:135], a[164:167], v[20:23]
    ds_read_b64_tr_b16 a[150:151], v237 offset:8704
    v_mfma_f32_16x16x32_bf16 v[32:35], a[136:139], a[160:163], v[32:35]
    ds_read_b64_tr_b16 a[152:153], v236 offset:8192
    v_mfma_f32_16x16x32_bf16 v[36:39], a[136:139], a[164:167], v[36:39]
    ds_read_b64_tr_b16 a[154:155], v234 offset:8704
    v_mfma_f32_16x16x32_bf16 v[48:51], a[140:143], a[160:163], v[48:51]
    ds_read_b64_tr_b16 a[156:157], v237 offset:8192
    v_mfma_f32_16x16x32_bf16 v[52:55], a[140:143], a[164:167], v[52:55]
    ds_read_b64_tr_b16 a[158:159], v235 offset:8704
    v_mfma_f32_16x16x32_bf16 v[8:11], a[128:131], a[168:171], v[8:11]
    v_mfma_f32_16x16x32_bf16 v[12:15], a[128:131], a[172:175], v[12:15]
    v_mfma_f32_16x16x32_bf16 v[24:27], a[132:135], a[168:171], v[24:27]
    v_mfma_f32_16x16x32_bf16 v[28:31], a[132:135], a[172:175], v[28:31]
    s_add_u32 m0, s55, 4096
    v_mfma_f32_16x16x32_bf16 v[40:43], a[136:139], a[168:171], v[40:43]
    buffer_load_dwordx4 v230, s[32:35], s56 offen lds
    v_mfma_f32_16x16x32_bf16 v[44:47], a[136:139], a[172:175], v[44:47]
    buffer_load_dwordx4 v231, s[32:35], s56 offen offset:1024 lds
    v_mfma_f32_16x16x32_bf16 v[56:59], a[140:143], a[168:171], v[56:59]
    buffer_load_dwordx4 v230, s[32:35], s57 offen offset:2048 lds
    v_mfma_f32_16x16x32_bf16 v[60:63], a[140:143], a[172:175], v[60:63]
    buffer_load_dwordx4 v231, s[32:35], s57 offen offset:3072 lds
    s_lshl_b32 s76, s91, 12
    v_add_u32 v244, s76, v250
    s_waitcnt vmcnt(16) lgkmcnt(0)
    v_mfma_f32_16x16x32_bf16 v[64:67], a[144:147], a[160:163], v[64:67]
    ds_read_b128 a[176:179], v244 offset:0
    v_mfma_f32_16x16x32_bf16 v[68:71], a[144:147], a[164:167], v[68:71]
    ds_read_b128 a[180:183], v244 offset:1024
    v_mfma_f32_16x16x32_bf16 v[80:83], a[148:151], a[160:163], v[80:83]
    ds_read_b128 a[184:187], v244 offset:2048
    v_mfma_f32_16x16x32_bf16 v[84:87], a[148:151], a[164:167], v[84:87]
    ds_read_b128 a[188:191], v244 offset:3072
    v_mfma_f32_16x16x32_bf16 v[96:99], a[152:155], a[160:163], v[96:99]
    ds_read_b64_tr_b16 a[128:129], v238 offset:12288
    v_mfma_f32_16x16x32_bf16 v[100:103], a[152:155], a[164:167], v[100:103]
    ds_read_b64_tr_b16 a[130:131], v239 offset:12800
    v_mfma_f32_16x16x32_bf16 v[112:115], a[156:159], a[160:163], v[112:115]
    ds_read_b64_tr_b16 a[132:133], v238 offset:12296
    v_mfma_f32_16x16x32_bf16 v[116:119], a[156:159], a[164:167], v[116:119]
    ds_read_b64_tr_b16 a[134:135], v239 offset:12808
    v_mfma_f32_16x16x32_bf16 v[72:75], a[144:147], a[168:171], v[72:75]
    ds_read_b64_tr_b16 a[136:137], v239 offset:12288
    v_mfma_f32_16x16x32_bf16 v[76:79], a[144:147], a[172:175], v[76:79]
    ds_read_b64_tr_b16 a[138:139], v238 offset:12800
    v_mfma_f32_16x16x32_bf16 v[88:91], a[148:151], a[168:171], v[88:91]
    ds_read_b64_tr_b16 a[140:141], v239 offset:12296
    v_mfma_f32_16x16x32_bf16 v[92:95], a[148:151], a[172:175], v[92:95]
    s_add_u32 m0, s55, 8192
    ds_read_b64_tr_b16 a[142:143], v238 offset:12808
    v_mfma_f32_16x16x32_bf16 v[104:107], a[152:155], a[168:171], v[104:107]
    s_add_u32 s92, s92, 1
    buffer_load_dwordx4 v230, s[36:39], s56 offen lds
    v_mfma_f32_16x16x32_bf16 v[108:111], a[152:155], a[172:175], v[108:111]
    s_cmp_eq_u32 s92, 16
    buffer_load_dwordx4 v231, s[36:39], s56 offen offset:1024 lds
    v_mfma_f32_16x16x32_bf16 v[120:123], a[156:159], a[168:171], v[120:123]
    s_cselect_b32 s64, s93, s58
    buffer_load_dwordx4 v230, s[36:39], s57 offen offset:2048 lds
    v_mfma_f32_16x16x32_bf16 v[124:127], a[156:159], a[172:175], v[124:127]
    buffer_load_dwordx4 v231, s[36:39], s57 offen offset:3072 lds
    s_add_u32 s56, s56, s64
    s_add_u32 s57, s57, s64
    s_mul_i32 s77, s54, 229376
    s_lshl_b32 s65, s62, 15
    s_add_u32 s77, s77, s65
    s_lshl_b32 s65, s52, 13
    s_add_u32 s77, s77, s65
    v_pk_mul_f32 v[128:129], v[0:1], v[64:65]
    v_pk_mul_f32 v[130:131], v[2:3], v[66:67]
    v_pk_mul_f32 v[132:133], v[16:17], v[80:81]
    v_pk_mul_f32 v[134:135], v[18:19], v[82:83]
    v_pk_mul_f32 v[136:137], v[4:5], v[68:69]
    v_pk_mul_f32 v[138:139], v[6:7], v[70:71]
    v_pk_mul_f32 v[140:141], v[20:21], v[84:85]
    v_pk_mul_f32 v[142:143], v[22:23], v[86:87]
    v_pk_mul_f32 v[144:145], v[8:9], v[72:73]
    v_pk_mul_f32 v[146:147], v[10:11], v[74:75]
    v_pk_mul_f32 v[148:149], v[24:25], v[88:89]
    v_pk_mul_f32 v[150:151], v[26:27], v[90:91]
    v_pk_mul_f32 v[152:153], v[12:13], v[76:77]
    v_pk_mul_f32 v[154:155], v[14:15], v[78:79]
    v_pk_mul_f32 v[156:157], v[28:29], v[92:93]
    v_pk_mul_f32 v[158:159], v[30:31], v[94:95]
    v_pk_mul_f32 v[160:161], v[32:33], v[96:97]
    v_pk_mul_f32 v[162:163], v[34:35], v[98:99]
    v_pk_mul_f32 v[164:165], v[48:49], v[112:113]
    v_pk_mul_f32 v[166:167], v[50:51], v[114:115]
    v_pk_mul_f32 v[168:169], v[36:37], v[100:101]
    v_pk_mul_f32 v[170:171], v[38:39], v[102:103]
    v_pk_mul_f32 v[172:173], v[52:53], v[116:117]
    v_pk_mul_f32 v[174:175], v[54:55], v[118:119]
    v_pk_mul_f32 v[176:177], v[40:41], v[104:105]
    v_pk_mul_f32 v[178:179], v[42:43], v[106:107]
    v_pk_mul_f32 v[180:181], v[56:57], v[120:121]
    v_pk_mul_f32 v[182:183], v[58:59], v[122:123]
    v_pk_mul_f32 v[184:185], v[44:45], v[108:109]
    v_pk_mul_f32 v[186:187], v[46:47], v[110:111]
    v_pk_mul_f32 v[188:189], v[60:61], v[124:125]
    v_pk_mul_f32 v[190:191], v[62:63], v[126:127]
    s_branch M_Q
M_WD:
    s_waitcnt vmcnt(0)
    s_cmp_ge_u32 s54, 28
    s_cbranch_scc1 M_WD_DONE
    s_mul_i32 s64, s52, 458752
    s_lshl_b32 s65, s54, 13
    s_add_u32 s64, s64, s65
    s_add_u32 s64, s64, 8388608
    ds_read_b64_tr_b16 v[0:1], v240 offset:4096
    ds_read_b64_tr_b16 v[2:3], v240 offset:6144
    ds_read_b64_tr_b16 v[4:5], v241 offset:4096
    ds_read_b64_tr_b16 v[6:7], v241 offset:6144
    ds_read_b64_tr_b16 v[8:9], v242 offset:4096
    ds_read_b64_tr_b16 v[10:11], v242 offset:6144
    ds_read_b64_tr_b16 v[12:13], v243 offset:4096
    ds_read_b64_tr_b16 v[14:15], v243 offset:6144
    s_add_u32 s65, s64, 0
    s_waitcnt lgkmcnt(0)
    buffer_store_dwordx4 v[0:3], v245, s[48:51], s65 offen offset:0 sc1
    buffer_store_dwordx4 v[4:7], v245, s[48:51], s65 offen offset:1024 sc1
    buffer_store_dwordx4 v[8:11], v245, s[48:51], s65 offen offset:2048 sc1
    buffer_store_dwordx4 v[12:15], v245, s[48:51], s65 offen offset:3072 sc1
    ds_read_b64_tr_b16 v[16:17], v240 offset:8192
    ds_read_b64_tr_b16 v[18:19], v240 offset:10240
    ds_read_b64_tr_b16 v[20:21], v241 offset:8192
    ds_read_b64_tr_b16 v[22:23], v241 offset:10240
    ds_read_b64_tr_b16 v[24:25], v242 offset:8192
    ds_read_b64_tr_b16 v[26:27], v242 offset:10240
    ds_read_b64_tr_b16 v[28:29], v243 offset:8192
    ds_read_b64_tr_b16 v[30:31], v243 offset:10240
    s_add_u32 s65, s64, 229376
    s_waitcnt lgkmcnt(0)
    buffer_store_dwordx4 v[16:19], v245, s[48:51], s65 offen offset:0 sc1
    buffer_store_dwordx4 v[20:23], v245, s[48:51], s65 offen offset:1024 sc1
    buffer_store_dwordx4 v[24:27], v245, s[48:51], s65 offen offset:2048 sc1
    buffer_store_dwordx4 v[28:31], v245, s[48:51], s65 offen offset:3072 sc1
    ds_read_b64_tr_b16 v[32:33], v240 offset:12288
    ds_read_b64_tr_b16 v[34:35], v240 offset:14336
    ds_read_b64_tr_b16 v[36:37], v241 offset:12288
    ds_read_b64_tr_b16 v[38:39], v241 offset:14336
    ds_read_b64_tr_b16 v[40:41], v242 offset:12288
    ds_read_b64_tr_b16 v[42:43], v242 offset:14336
    ds_read_b64_tr_b16 v[44:45], v243 offset:12288
    ds_read_b64_tr_b16 v[46:47], v243 offset:14336
    s_add_u32 s65, s64, 4096
    s_waitcnt lgkmcnt(0)
    buffer_store_dwordx4 v[32:35], v245, s[48:51], s65 offen offset:0 sc1
    buffer_store_dwordx4 v[36:39], v245, s[48:51], s65 offen offset:1024 sc1
    buffer_store_dwordx4 v[40:43], v245, s[48:51], s65 offen offset:2048 sc1
    buffer_store_dwordx4 v[44:47], v245, s[48:51], s65 offen offset:3072 sc1
    ds_read_b64_tr_b16 v[48:49], v240 offset:16384
    ds_read_b64_tr_b16 v[50:51], v240 offset:18432
    ds_read_b64_tr_b16 v[52:53], v241 offset:16384
    ds_read_b64_tr_b16 v[54:55], v241 offset:18432
    ds_read_b64_tr_b16 v[56:57], v242 offset:16384
    ds_read_b64_tr_b16 v[58:59], v242 offset:18432
    ds_read_b64_tr_b16 v[60:61], v243 offset:16384
    ds_read_b64_tr_b16 v[62:63], v243 offset:18432
    s_add_u32 s65, s64, 233472
    s_waitcnt lgkmcnt(0)
    buffer_store_dwordx4 v[48:51], v245, s[48:51], s65 offen offset:0 sc1
    buffer_store_dwordx4 v[52:55], v245, s[48:51], s65 offen offset:1024 sc1
    buffer_store_dwordx4 v[56:59], v245, s[48:51], s65 offen offset:2048 sc1
    buffer_store_dwordx4 v[60:63], v245, s[48:51], s65 offen offset:3072 sc1
M_WD_DONE:
    s_mov_b32 s77, 268435456
    s_mov_b32 s32, s10
    s_mov_b32 s33, s11
    s_mov_b32 s34, 4194304
    s_mov_b32 s35, 0x20000
    s_add_u32 s36, s10, 128
    s_addc_u32 s37, s11, 0
    s_mov_b32 s38, 4194176
    s_mov_b32 s39, 0x20000
    s_lshl_b32 s56, s53, 10
    s_lshl_b32 s64, s52, 8
    s_add_u32 s56, s56, s64
    s_mul_i32 s64, s91, 262144
    s_add_u32 s56, s56, s64
    s_mov_b32 s92, s91
    s_add_u32 s57, s56, 129024
    s_mov_b32 s58, 262144
    s_mov_b32 s93, -3932160
    s_add_u32 m0, s55, 12288
    s_nop 0
    buffer_load_dwordx4 v230, s[32:35], s56 offen lds
    buffer_load_dwordx4 v231, s[32:35], s56 offen offset:1024 lds
    buffer_load_dwordx4 v230, s[32:35], s57 offen offset:2048 lds
    buffer_load_dwordx4 v231, s[32:35], s57 offen offset:3072 lds
    s_add_u32 m0, s55, 16384
    s_nop 0
    buffer_load_dwordx4 v230, s[36:39], s56 offen lds
    buffer_load_dwordx4 v231, s[36:39], s56 offen offset:1024 lds
    buffer_load_dwordx4 v230, s[36:39], s57 offen offset:2048 lds
    buffer_load_dwordx4 v231, s[36:39], s57 offen offset:3072 lds
    s_add_u32 s92, s92, 1
    s_cmp_eq_u32 s92, 16
    s_cselect_b32 s64, s93, s58
    s_add_u32 s56, s56, s64
    s_add_u32 s57, s57, s64
    s_add_u32 m0, s55, 20480
    s_nop 0
    buffer_load_dwordx4 v230, s[32:35], s56 offen lds
    buffer_load_dwordx4 v231, s[32:35], s56 offen offset:1024 lds
    buffer_load_dwordx4 v230, s[32:35], s57 offen offset:2048 lds
    buffer_load_dwordx4 v231, s[32:35], s57 offen offset:3072 lds
    s_add_u32 m0, s55, 0
    s_nop 0
    buffer_load_dwordx4 v230, s[36:39], s56 offen lds
    buffer_load_dwordx4 v231, s[36:39], s56 offen offset:1024 lds
    buffer_load_dwordx4 v230, s[36:39], s57 offen offset:2048 lds
    buffer_load_dwordx4 v231, s[36:39], s57 offen offset:3072 lds
    s_add_u32 s92, s92, 1
    s_cmp_eq_u32 s92, 16
    s_cselect_b32 s64, s93, s58
    s_add_u32 s56, s56, s64
    s_add_u32 s57, s57, s64
    s_add_u32 m0, s55, 4096
    s_nop 0
    buffer_load_dwordx4 v230, s[32:35], s56 offen lds
    buffer_load_dwordx4 v231, s[32:35], s56 offen offset:1024 lds
    buffer_load_dwordx4 v230, s[32:35], s57 offen offset:2048 lds
    buffer_load_dwordx4 v231, s[32:35], s57 offen offset:3072 lds
    s_add_u32 m0, s55, 8192
    s_nop 0
    buffer_load_dwordx4 v230, s[36:39], s56 offen lds
    buffer_load_dwordx4 v231, s[36:39], s56 offen offset:1024 lds
    buffer_load_dwordx4 v230, s[36:39], s57 offen offset:2048 lds
    buffer_load_dwordx4 v231, s[36:39], s57 offen offset:3072 lds
    s_add_u32 s92, s92, 1
    s_cmp_eq_u32 s92, 16
    s_cselect_b32 s64, s93, s58
    s_add_u32 s56, s56, s64
    s_add_u32 s57, s57, s64
    s_waitcnt vmcnt(20) lgkmcnt(0)
    s_barrier
    ds_read_b128 a[176:179], v244 offset:0
    ds_read_b128 a[180:183], v244 offset:1024
    ds_read_b128 a[184:187], v244 offset:2048
    ds_read_b128 a[188:191], v244 offset:3072
    ds_read_b64_tr_b16 a[128:129], v238 offset:12288
    ds_read_b64_tr_b16 a[130:131], v239 offset:12800
    ds_read_b64_tr_b16 a[132:133], v238 offset:12296
    ds_read_b64_tr_b16 a[134:135], v239 offset:12808
    ds_read_b64_tr_b16 a[136:137], v239 offset:12288
    ds_read_b64_tr_b16 a[138:139], v238 offset:12800
    ds_read_b64_tr_b16 a[140:141], v239 offset:12296
    ds_read_b64_tr_b16 a[142:143], v238 offset:12808
M_Q:
    s_waitcnt vmcnt(16) lgkmcnt(0)
    v_mfma_f32_16x16x32_bf16 v[0:3], a[128:131], a[176:179], 0
    ds_read_b64_tr_b16 a[144:145], v238 offset:16384
    v_cvt_pk_bf16_f32 v128, v128, v129
    v_mfma_f32_16x16x32_bf16 v[4:7], a[128:131], a[180:183], 0
    ds_read_b64_tr_b16 a[146:147], v239 offset:16896
    v_cvt_pk_bf16_f32 v129, v130, v131
    v_mfma_f32_16x16x32_bf16 v[16:19], a[132:135], a[176:179], 0
    ds_read_b64_tr_b16 a[148:149], v238 offset:16392
    v_cvt_pk_bf16_f32 v130, v132, v133
    v_mfma_f32_16x16x32_bf16 v[20:23], a[132:135], a[180:183], 0
    ds_read_b64_tr_b16 a[150:151], v239 offset:16904
    v_cvt_pk_bf16_f32 v131, v134, v135
    v_mfma_f32_16x16x32_bf16 v[32:35], a[136:139], a[176:179], 0
    ds_read_b64_tr_b16 a[152:153], v239 offset:16384
    v_cvt_pk_bf16_f32 v132, v136, v137
    v_mfma_f32_16x16x32_bf16 v[36:39], a[136:139], a[180:183], 0
    s_add_u32 s76, s76, 4096
    ds_read_b64_tr_b16 a[154:155], v238 offset:16896
    v_cvt_pk_bf16_f32 v133, v138, v139
    v_mfma_f32_16x16x32_bf16 v[48:51], a[140:143], a[176:179], 0
    s_and_b32 s76, s76, 0xffff
    ds_read_b64_tr_b16 a[156:157], v239 offset:16392
    v_cvt_pk_bf16_f32 v134, v140, v141
    v_mfma_f32_16x16x32_bf16 v[52:55], a[140:143], a[180:183], 0
    ds_read_b64_tr_b16 a[158:159], v238 offset:16904
    v_add_u32 v244, s76, v250
    v_cvt_pk_bf16_f32 v135, v142, v143
    v_mfma_f32_16x16x32_bf16 v[8:11], a[128:131], a[184:187], 0
    ds_read_b128 a[192:195], v244 offset:0
    v_cvt_pk_bf16_f32 v136, v144, v145
    v_mfma_f32_16x16x32_bf16 v[12:15], a[128:131], a[188:191], 0
    ds_read_b128 a[196:199], v244 offset:1024
    v_cvt_pk_bf16_f32 v137, v146, v147
    v_mfma_f32_16x16x32_bf16 v[24:27], a[132:135], a[184:187], 0
    v_cvt_pk_bf16_f32 v138, v148, v149
    v_mfma_f32_16x16x32_bf16 v[28:31], a[132:135], a[188:191], 0
    s_add_u32 m0, s55, 12288
    v_cvt_pk_bf16_f32 v139, v150, v151
    v_mfma_f32_16x16x32_bf16 v[40:43], a[136:139], a[184:187], 0
    buffer_load_dwordx4 v230, s[32:35], s56 offen lds
    v_cvt_pk_bf16_f32 v140, v152, v153
    v_mfma_f32_16x16x32_bf16 v[44:47], a[136:139], a[188:191], 0
    buffer_load_dwordx4 v231, s[32:35], s56 offen offset:1024 lds
    v_cvt_pk_bf16_f32 v141, v154, v155
    v_mfma_f32_16x16x32_bf16 v[56:59], a[140:143], a[184:187], 0
    buffer_load_dwordx4 v230, s[32:35], s57 offen offset:2048 lds
    v_cvt_pk_bf16_f32 v142, v156, v157
    v_mfma_f32_16x16x32_bf16 v[60:63], a[140:143], a[188:191], 0
    buffer_load_dwordx4 v231, s[32:35], s57 offen offset:3072 lds
    v_cvt_pk_bf16_f32 v143, v158, v159
    s_waitcnt vmcnt(16) lgkmcnt(0)
    v_mfma_f32_16x16x32_bf16 v[64:67], a[144:147], a[176:179], 0
    ds_read_b64_tr_b16 a[128:129], v238 offset:20480
    v_cvt_pk_bf16_f32 v144, v160, v161
    v_mfma_f32_16x16x32_bf16 v[68:71], a[144:147], a[180:183], 0
    ds_read_b64_tr_b16 a[130:131], v239 offset:20992
    v_cvt_pk_bf16_f32 v145, v162, v163
    v_mfma_f32_16x16x32_bf16 v[80:83], a[148:151], a[176:179], 0
    ds_read_b64_tr_b16 a[132:133], v238 offset:20488
    v_cvt_pk_bf16_f32 v146, v164, v165
    v_mfma_f32_16x16x32_bf16 v[84:87], a[148:151], a[180:183], 0
    ds_read_b64_tr_b16 a[134:135], v239 offset:21000
    v_cvt_pk_bf16_f32 v147, v166, v167
    v_mfma_f32_16x16x32_bf16 v[96:99], a[152:155], a[176:179], 0
    ds_read_b64_tr_b16 a[136:137], v239 offset:20480
    v_cvt_pk_bf16_f32 v148, v168, v169
    v_mfma_f32_16x16x32_bf16 v[100:103], a[152:155], a[180:183], 0
    ds_read_b64_tr_b16 a[138:139], v238 offset:20992
    v_cvt_pk_bf16_f32 v149, v170, v171
    v_mfma_f32_16x16x32_bf16 v[112:115], a[156:159], a[176:179], 0
    ds_read_b64_tr_b16 a[140:141], v239 offset:20488
    v_cvt_pk_bf16_f32 v150, v172, v173
    v_mfma_f32_16x16x32_bf16 v[116:119], a[156:159], a[180:183], 0
    ds_read_b64_tr_b16 a[142:143], v238 offset:21000
    v_cvt_pk_bf16_f32 v151, v174, v175
    v_mfma_f32_16x16x32_bf16 v[72:75], a[144:147], a[184:187], 0
    ds_read_b128 a[200:203], v244 offset:2048
    v_cvt_pk_bf16_f32 v152, v176, v177
    v_mfma_f32_16x16x32_bf16 v[76:79], a[144:147], a[188:191], 0
    ds_read_b128 a[204:207], v244 offset:3072
    v_cvt_pk_bf16_f32 v153, v178, v179
    v_mfma_f32_16x16x32_bf16 v[88:91], a[148:151], a[184:187], 0
    v_cvt_pk_bf16_f32 v154, v180, v181
    v_mfma_f32_16x16x32_bf16 v[92:95], a[148:151], a[188:191], 0
    s_add_u32 m0, s55, 16384
    v_cvt_pk_bf16_f32 v155, v182, v183
    v_mfma_f32_16x16x32_bf16 v[104:107], a[152:155], a[184:187], 0
    s_add_u32 s92, s92, 1
    buffer_load_dwordx4 v230, s[36:39], s56 offen lds
    v_cvt_pk_bf16_f32 v156, v184, v185
    v_mfma_f32_16x16x32_bf16 v[108:111], a[152:155], a[188:191], 0
    s_cmp_eq_u32 s92, 16
    buffer_load_dwordx4 v231, s[36:39], s56 offen offset:1024 lds
    v_cvt_pk_bf16_f32 v157, v186, v187
    v_mfma_f32_16x16x32_bf16 v[120:123], a[156:159], a[184:187], 0
    s_cselect_b32 s64, s93, s58
    buffer_load_dwordx4 v230, s[36:39], s57 offen offset:2048 lds
    v_cvt_pk_bf16_f32 v158, v188, v189
    v_mfma_f32_16x16x32_bf16 v[124:127], a[156:159], a[188:191], 0
    buffer_load_dwordx4 v231, s[36:39], s57 offen offset:3072 lds
    v_cvt_pk_bf16_f32 v159, v190, v191
    s_mov_b32 s59, 4
L_q:
    s_waitcnt vmcnt(16) lgkmcnt(0)
    v_mfma_f32_16x16x32_bf16 v[0:3], a[128:131], a[192:195], v[0:3]
    s_add_u32 s56, s56, s64
    ds_read_b64_tr_b16 a[144:145], v238 offset:0
    v_mfma_f32_16x16x32_bf16 v[4:7], a[128:131], a[196:199], v[4:7]
    s_add_u32 s57, s57, s64
    ds_read_b64_tr_b16 a[146:147], v239 offset:512
    v_mfma_f32_16x16x32_bf16 v[16:19], a[132:135], a[192:195], v[16:19]
    ds_read_b64_tr_b16 a[148:149], v238 offset:8
    v_mfma_f32_16x16x32_bf16 v[20:23], a[132:135], a[196:199], v[20:23]
    ds_read_b64_tr_b16 a[150:151], v239 offset:520
    v_mfma_f32_16x16x32_bf16 v[32:35], a[136:139], a[192:195], v[32:35]
    ds_read_b64_tr_b16 a[152:153], v239 offset:0
    v_mfma_f32_16x16x32_bf16 v[36:39], a[136:139], a[196:199], v[36:39]
    s_add_u32 s76, s76, 4096
    ds_read_b64_tr_b16 a[154:155], v238 offset:512
    v_mfma_f32_16x16x32_bf16 v[48:51], a[140:143], a[192:195], v[48:51]
    s_and_b32 s76, s76, 0xffff
    ds_read_b64_tr_b16 a[156:157], v239 offset:8
    v_mfma_f32_16x16x32_bf16 v[52:55], a[140:143], a[196:199], v[52:55]
    ds_read_b64_tr_b16 a[158:159], v238 offset:520
    v_add_u32 v244, s76, v250
    v_mfma_f32_16x16x32_bf16 v[8:11], a[128:131], a[200:203], v[8:11]
    ds_read_b128 a[160:163], v244 offset:0
    v_mfma_f32_16x16x32_bf16 v[12:15], a[128:131], a[204:207], v[12:15]
    ds_read_b128 a[164:167], v244 offset:1024
    v_mfma_f32_16x16x32_bf16 v[24:27], a[132:135], a[200:203], v[24:27]
    v_mfma_f32_16x16x32_bf16 v[28:31], a[132:135], a[204:207], v[28:31]
    s_add_u32 m0, s55, 20480
    v_mfma_f32_16x16x32_bf16 v[40:43], a[136:139], a[200:203], v[40:43]
    buffer_load_dwordx4 v230, s[32:35], s56 offen lds
    v_mfma_f32_16x16x32_bf16 v[44:47], a[136:139], a[204:207], v[44:47]
    buffer_load_dwordx4 v231, s[32:35], s56 offen offset:1024 lds
    v_mfma_f32_16x16x32_bf16 v[56:59], a[140:143], a[200:203], v[56:59]
    buffer_load_dwordx4 v230, s[32:35], s57 offen offset:2048 lds
    v_mfma_f32_16x16x32_bf16 v[60:63], a[140:143], a[204:207], v[60:63]
    buffer_load_dwordx4 v231, s[32:35], s57 offen offset:3072 lds
    s_waitcnt vmcnt(16) lgkmcnt(0)
    v_mfma_f32_16x16x32_bf16 v[64:67], a[144:147], a[192:195], v[64:67]
    ds_read_b64_tr_b16 a[128:129], v238 offset:4096
    v_mfma_f32_16x16x32_bf16 v[68:71], a[144:147], a[196:199], v[68:71]
    ds_read_b64_tr_b16 a[130:131], v239 offset:4608
    v_mfma_f32_16x16x32_bf16 v[80:83], a[148:151], a[192:195], v[80:83]
    ds_read_b64_tr_b16 a[132:133], v238 offset:4104
    v_mfma_f32_16x16x32_bf16 v[84:87], a[148:151], a[196:199], v[84:87]
    ds_read_b64_tr_b16 a[134:135], v239 offset:4616
    v_mfma_f32_16x16x32_bf16 v[96:99], a[152:155], a[192:195], v[96:99]
    ds_read_b64_tr_b16 a[136:137], v239 offset:4096
    v_mfma_f32_16x16x32_bf16 v[100:103], a[152:155], a[196:199], v[100:103]
    ds_read_b64_tr_b16 a[138:139], v238 offset:4608
    v_mfma_f32_16x16x32_bf16 v[112:115], a[156:159], a[192:195], v[112:115]
    ds_read_b64_tr_b16 a[140:141], v239 offset:4104
    v_mfma_f32_16x16x32_bf16 v[116:119], a[156:159], a[196:199], v[116:119]
    ds_read_b64_tr_b16 a[142:143], v238 offset:4616
    v_mfma_f32_16x16x32_bf16 v[72:75], a[144:147], a[200:203], v[72:75]
    ds_read_b128 a[168:171], v244 offset:2048
    v_mfma_f32_16x16x32_bf16 v[76:79], a[144:147], a[204:207], v[76:79]
    ds_read_b128 a[172:175], v244 offset:3072
    v_mfma_f32_16x16x32_bf16 v[88:91], a[148:151], a[200:203], v[88:91]
    v_mfma_f32_16x16x32_bf16 v[92:95], a[148:151], a[204:207], v[92:95]
    s_add_u32 m0, s55, 0
    v_mfma_f32_16x16x32_bf16 v[104:107], a[152:155], a[200:203], v[104:107]
    s_add_u32 s92, s92, 1
    buffer_load_dwordx4 v230, s[36:39], s56 offen lds
    v_mfma_f32_16x16x32_bf16 v[108:111], a[152:155], a[204:207], v[108:111]
    s_cmp_eq_u32 s92, 16
    buffer_load_dwordx4 v231, s[36:39], s56 offen offset:1024 lds
    v_mfma_f32_16x16x32_bf16 v[120:123], a[156:159], a[200:203], v[120:123]
    s_cselect_b32 s64, s93, s58
    buffer_load_dwordx4 v230, s[36:39], s57 offen offset:2048 lds
    v_mfma_f32_16x16x32_bf16 v[124:127], a[156:159], a[204:207], v[124:127]
    buffer_load_dwordx4 v231, s[36:39], s57 offen offset:3072 lds
    s_waitcnt vmcnt(16) lgkmcnt(0)
    v_mfma_f32_16x16x32_bf16 v[0:3], a[128:131], a[160:163], v[0:3]
    s_add_u32 s56, s56, s64
    ds_read_b64_tr_b16 a[144:145], v238 offset:8192
    v_mfma_f32_16x16x32_bf16 v[4:7], a[128:131], a[164:167], v[4:7]
    s_add_u32 s57, s57, s64
    ds_read_b64_tr_b16 a[146:147], v239 offset:8704
    v_mfma_f32_16x16x32_bf16 v[16:19], a[132:135], a[160:163], v[16:19]
    ds_read_b64_tr_b16 a[148:149], v238 offset:8200
    v_mfma_f32_16x16x32_bf16 v[20:23], a[132:135], a[164:167], v[20:23]
    ds_read_b64_tr_b16 a[150:151], v239 offset:8712
    v_mfma_f32_16x16x32_bf16 v[32:35], a[136:139], a[160:163], v[32:35]
    ds_read_b64_tr_b16 a[152:153], v239 offset:8192
    v_mfma_f32_16x16x32_bf16 v[36:39], a[136:139], a[164:167], v[36:39]
    s_add_u32 s76, s76, 4096
    ds_read_b64_tr_b16 a[154:155], v238 offset:8704
    v_mfma_f32_16x16x32_bf16 v[48:51], a[140:143], a[160:163], v[48:51]
    s_and_b32 s76, s76, 0xffff
    ds_read_b64_tr_b16 a[156:157], v239 offset:8200
    v_mfma_f32_16x16x32_bf16 v[52:55], a[140:143], a[164:167], v[52:55]
    ds_read_b64_tr_b16 a[158:159], v238 offset:8712
    v_add_u32 v244, s76, v250
    v_mfma_f32_16x16x32_bf16 v[8:11], a[128:131], a[168:171], v[8:11]
    ds_read_b128 a[176:179], v244 offset:0
    v_mfma_f32_16x16x32_bf16 v[12:15], a[128:131], a[172:175], v[12:15]
    ds_read_b128 a[180:183], v244 offset:1024
    v_mfma_f32_16x16x32_bf16 v[24:27], a[132:135], a[168:171], v[24:27]
    v_mfma_f32_16x16x32_bf16 v[28:31], a[132:135], a[172:175], v[28:31]
    s_add_u32 m0, s55, 4096
    v_mfma_f32_16x16x32_bf16 v[40:43], a[136:139], a[168:171], v[40:43]
    buffer_load_dwordx4 v230, s[32:35], s56 offen lds
    v_mfma_f32_16x16x32_bf16 v[44:47], a[136:139], a[172:175], v[44:47]
    buffer_load_dwordx4 v231, s[32:35], s56 offen offset:1024 lds
    v_mfma_f32_16x16x32_bf16 v[56:59], a[140:143], a[168:171], v[56:59]
    buffer_load_dwordx4 v230, s[32:35], s57 offen offset:2048 lds
    v_mfma_f32_16x16x32_bf16 v[60:63], a[140:143], a[172:175], v[60:63]
    buffer_load_dwordx4 v231, s[32:35], s57 offen offset:3072 lds
    s_waitcnt vmcnt(16) lgkmcnt(0)
    v_mfma_f32_16x16x32_bf16 v[64:67], a[144:147], a[160:163], v[64:67]
    ds_read_b64_tr_b16 a[128:129], v238 offset:12288
    v_mfma_f32_16x16x32_bf16 v[68:71], a[144:147], a[164:167], v[68:71]
    ds_read_b64_tr_b16 a[130:131], v239 offset:12800
    v_mfma_f32_16x16x32_bf16 v[80:83], a[148:151], a[160:163], v[80:83]
    ds_read_b64_tr_b16 a[132:133], v238 offset:12296
    v_mfma_f32_16x16x32_bf16 v[84:87], a[148:151], a[164:167], v[84:87]
    ds_read_b64_tr_b16 a[134:135], v239 offset:12808
    v_mfma_f32_16x16x32_bf16 v[96:99], a[152:155], a[160:163], v[96:99]
    ds_read_b64_tr_b16 a[136:137], v239 offset:12288
    v_mfma_f32_16x16x32_bf16 v[100:103], a[152:155], a[164:167], v[100:103]
    ds_read_b64_tr_b16 a[138:139], v238 offset:12800
    v_mfma_f32_16x16x32_bf16 v[112:115], a[156:159], a[160:163], v[112:115]
    ds_read_b64_tr_b16 a[140:141], v239 offset:12296
    v_mfma_f32_16x16x32_bf16 v[116:119], a[156:159], a[164:167], v[116:119]
    ds_read_b64_tr_b16 a[142:143], v238 offset:12808
    v_mfma_f32_16x16x32_bf16 v[72:75], a[144:147], a[168:171], v[72:75]
    ds_read_b128 a[184:187], v244 offset:2048
    v_mfma_f32_16x16x32_bf16 v[76:79], a[144:147], a[172:175], v[76:79]
    ds_read_b128 a[188:191], v244 offset:3072
    v_mfma_f32_16x16x32_bf16 v[88:91], a[148:151], a[168:171], v[88:91]
    v_mfma_f32_16x16x32_bf16 v[92:95], a[148:151], a[172:175], v[92:95]
    s_add_u32 m0, s55, 8192
    v_mfma_f32_16x16x32_bf16 v[104:107], a[152:155], a[168:171], v[104:107]
    s_add_u32 s92, s92, 1
    buffer_load_dwordx4 v230, s[36:39], s56 offen lds
    v_mfma_f32_16x16x32_bf16 v[108:111], a[152:155], a[172:175], v[108:111]
    s_cmp_eq_u32 s92, 16
    buffer_load_dwordx4 v231, s[36:39], s56 offen offset:1024 lds
    v_mfma_f32_16x16x32_bf16 v[120:123], a[156:159], a[168:171], v[120:123]
    s_cselect_b32 s64, s93, s58
    buffer_load_dwordx4 v230, s[36:39], s57 offen offset:2048 lds
    v_mfma_f32_16x16x32_bf16 v[124:127], a[156:159], a[172:175], v[124:127]
    buffer_load_dwordx4 v231, s[36:39], s57 offen offset:3072 lds
    s_waitcnt vmcnt(16) lgkmcnt(0)
    v_mfma_f32_16x16x32_bf16 v[0:3], a[128:131], a[176:179], v[0:3]
    s_add_u32 s56, s56, s64
    ds_read_b64_tr_b16 a[144:145], v238 offset:16384
    v_mfma_f32_16x16x32_bf16 v[4:7], a[128:131], a[180:183], v[4:7]
    s_add_u32 s57, s57, s64
    ds_read_b64_tr_b16 a[146:147], v239 offset:16896
    v_mfma_f32_16x16x32_bf16 v[16:19], a[132:135], a[176:179], v[16:19]
    ds_read_b64_tr_b16 a[148:149], v238 offset:16392
    v_mfma_f32_16x16x32_bf16 v[20:23], a[132:135], a[180:183], v[20:23]
    ds_read_b64_tr_b16 a[150:151], v239 offset:16904
    v_mfma_f32_16x16x32_bf16 v[32:35], a[136:139], a[176:179], v[32:35]
    ds_read_b64_tr_b16 a[152:153], v239 offset:16384
    v_mfma_f32_16x16x32_bf16 v[36:39], a[136:139], a[180:183], v[36:39]
    s_add_u32 s76, s76, 4096
    ds_read_b64_tr_b16 a[154:155], v238 offset:16896
    v_mfma_f32_16x16x32_bf16 v[48:51], a[140:143], a[176:179], v[48:51]
    s_and_b32 s76, s76, 0xffff
    ds_read_b64_tr_b16 a[156:157], v239 offset:16392
    v_mfma_f32_16x16x32_bf16 v[52:55], a[140:143], a[180:183], v[52:55]
    ds_read_b64_tr_b16 a[158:159], v238 offset:16904
    v_add_u32 v244, s76, v250
    v_mfma_f32_16x16x32_bf16 v[8:11], a[128:131], a[184:187], v[8:11]
    ds_read_b128 a[192:195], v244 offset:0
    v_mfma_f32_16x16x32_bf16 v[12:15], a[128:131], a[188:191], v[12:15]
    ds_read_b128 a[196:199], v244 offset:1024
    v_mfma_f32_16x16x32_bf16 v[24:27], a[132:135], a[184:187], v[24:27]
    v_mfma_f32_16x16x32_bf16 v[28:31], a[132:135], a[188:191], v[28:31]
    s_add_u32 m0, s55, 12288
    v_mfma_f32_16x16x32_bf16 v[40:43], a[136:139], a[184:187], v[40:43]
    buffer_load_dwordx4 v230, s[32:35], s56 offen lds
    v_mfma_f32_16x16x32_bf16 v[44:47], a[136:139], a[188:191], v[44:47]
    buffer_load_dwordx4 v231, s[32:35], s56 offen offset:1024 lds
    v_mfma_f32_16x16x32_bf16 v[56:59], a[140:143], a[184:187], v[56:59]
    buffer_load_dwordx4 v230, s[32:35], s57 offen offset:2048 lds
    v_mfma_f32_16x16x32_bf16 v[60:63], a[140:143], a[188:191], v[60:63]
    buffer_load_dwordx4 v231, s[32:35], s57 offen offset:3072 lds
    s_waitcnt vmcnt(16) lgkmcnt(0)
    v_mfma_f32_16x16x32_bf16 v[64:67], a[144:147], a[176:179], v[64:67]
    ds_read_b64_tr_b16 a[128:129], v238 offset:20480
    v_mfma_f32_16x16x32_bf16 v[68:71], a[144:147], a[180:183], v[68:71]
    ds_read_b64_tr_b16 a[130:131], v239 offset:20992
    v_mfma_f32_16x16x32_bf16 v[80:83], a[148:151], a[176:179], v[80:83]
    ds_read_b64_tr_b16 a[132:133], v238 offset:20488
    v_mfma_f32_16x16x32_bf16 v[84:87], a[148:151], a[180:183], v[84:87]
    s_sub_u32 s59, s59, 1
    ds_read_b64_tr_b16 a[134:135], v239 offset:21000
    v_mfma_f32_16x16x32_bf16 v[96:99], a[152:155], a[176:179], v[96:99]
    ds_read_b64_tr_b16 a[136:137], v239 offset:20480
    v_mfma_f32_16x16x32_bf16 v[100:103], a[152:155], a[180:183], v[100:103]
    ds_read_b64_tr_b16 a[138:139], v238 offset:20992
    v_mfma_f32_16x16x32_bf16 v[112:115], a[156:159], a[176:179], v[112:115]
    ds_read_b64_tr_b16 a[140:141], v239 offset:20488
    v_mfma_f32_16x16x32_bf16 v[116:119], a[156:159], a[180:183], v[116:119]
    ds_read_b64_tr_b16 a[142:143], v238 offset:21000
    v_mfma_f32_16x16x32_bf16 v[72:75], a[144:147], a[184:187], v[72:75]
    ds_read_b128 a[200:203], v244 offset:2048
    v_mfma_f32_16x16x32_bf16 v[76:79], a[144:147], a[188:191], v[76:79]
    ds_read_b128 a[204:207], v244 offset:3072
    v_mfma_f32_16x16x32_bf16 v[88:91], a[148:151], a[184:187], v[88:91]
    v_mfma_f32_16x16x32_bf16 v[92:95], a[148:151], a[188:191], v[92:95]
    s_add_u32 m0, s55, 16384
    v_mfma_f32_16x16x32_bf16 v[104:107], a[152:155], a[184:187], v[104:107]
    s_add_u32 s92, s92, 1
    buffer_load_dwordx4 v230, s[36:39], s56 offen lds
    v_mfma_f32_16x16x32_bf16 v[108:111], a[152:155], a[188:191], v[108:111]
    s_cmp_eq_u32 s92, 16
    buffer_load_dwordx4 v231, s[36:39], s56 offen offset:1024 lds
    v_mfma_f32_16x16x32_bf16 v[120:123], a[156:159], a[184:187], v[120:123]
    s_cselect_b32 s64, s93, s58
    buffer_load_dwordx4 v230, s[36:39], s57 offen offset:2048 lds
    v_mfma_f32_16x16x32_bf16 v[124:127], a[156:159], a[188:191], v[124:127]
    buffer_load_dwordx4 v231, s[36:39], s57 offen offset:3072 lds
    s_cmp_lg_u32 s59, 0
    s_cbranch_scc1 L_q
    s_waitcnt vmcnt(16) lgkmcnt(0)
    v_mfma_f32_16x16x32_bf16 v[0:3], a[128:131], a[192:195], v[0:3]
    ds_read_b64_tr_b16 a[144:145], v238 offset:0
    v_accvgpr_write_b32 a208, v128
    v_mfma_f32_16x16x32_bf16 v[4:7], a[128:131], a[196:199], v[4:7]
    ds_read_b64_tr_b16 a[146:147], v239 offset:512
    v_accvgpr_write_b32 a209, v129
    v_mfma_f32_16x16x32_bf16 v[16:19], a[132:135], a[192:195], v[16:19]
    ds_read_b64_tr_b16 a[148:149], v238 offset:8
    v_accvgpr_write_b32 a210, v130
    v_mfma_f32_16x16x32_bf16 v[20:23], a[132:135], a[196:199], v[20:23]
    ds_read_b64_tr_b16 a[150:151], v239 offset:520
    v_accvgpr_write_b32 a211, v131
    v_mfma_f32_16x16x32_bf16 v[32:35], a[136:139], a[192:195], v[32:35]
    ds_read_b64_tr_b16 a[152:153], v239 offset:0
    v_accvgpr_write_b32 a212, v132
    v_mfma_f32_16x16x32_bf16 v[36:39], a[136:139], a[196:199], v[36:39]
    s_add_u32 s76, s76, 4096
    ds_read_b64_tr_b16 a[154:155], v238 offset:512
    v_accvgpr_write_b32 a213, v133
    v_mfma_f32_16x16x32_bf16 v[48:51], a[140:143], a[192:195], v[48:51]
    s_and_b32 s76, s76, 0xffff
    ds_read_b64_tr_b16 a[156:157], v239 offset:8
    v_accvgpr_write_b32 a214, v134
    v_mfma_f32_16x16x32_bf16 v[52:55], a[140:143], a[196:199], v[52:55]
    ds_read_b64_tr_b16 a[158:159], v238 offset:520
    v_add_u32 v244, s76, v250
    v_accvgpr_write_b32 a215, v135
    v_mfma_f32_16x16x32_bf16 v[8:11], a[128:131], a[200:203], v[8:11]
    ds_read_b128 a[160:163], v244 offset:0
    v_accvgpr_write_b32 a216, v136
    v_mfma_f32_16x16x32_bf16 v[12:15], a[128:131], a[204:207], v[12:15]
    ds_read_b128 a[164:167], v244 offset:1024
    v_accvgpr_write_b32 a217, v137
    v_mfma_f32_16x16x32_bf16 v[24:27], a[132:135], a[200:203], v[24:27]
    v_accvgpr_write_b32 a218, v138
    v_mfma_f32_16x16x32_bf16 v[28:31], a[132:135], a[204:207], v[28:31]
    s_add_u32 m0, s55, 20480
    v_accvgpr_write_b32 a219, v139
    v_mfma_f32_16x16x32_bf16 v[40:43], a[136:139], a[200:203], v[40:43]
    buffer_load_dwordx4 v224, s[40:43], s60 offen lds
    v_accvgpr_write_b32 a220, v140
    v_mfma_f32_16x16x32_bf16 v[44:47], a[136:139], a[204:207], v[44:47]
    buffer_load_dwordx4 v225, s[40:43], s60 offen offset:1024 lds
    v_accvgpr_write_b32 a221, v141
    v_mfma_f32_16x16x32_bf16 v[56:59], a[140:143], a[200:203], v[56:59]
    v_accvgpr_write_b32 a222, v142
    v_mfma_f32_16x16x32_bf16 v[60:63], a[140:143], a[204:207], v[60:63]
    v_accvgpr_write_b32 a223, v143
    s_add_u32 s60, s60, s61
    s_mov_b32 s32, s12
    s_mov_b32 s33, s13
    s_mov_b32 s34, 4194304
    s_mov_b32 s35, 0x20000
    s_add_u32 s36, s12, 128
    s_addc_u32 s37, s13, 0
    s_mov_b32 s38, 4194176
    s_mov_b32 s39, 0x20000
    s_lshl_b32 s56, s53, 19
    s_lshl_b32 s64, s52, 8
    s_add_u32 s56, s56, s64
    s_mov_b32 s92, 0
    s_add_u32 s57, s56, 14336
    s_mov_b32 s58, 32768
    s_mov_b32 s93, -491520
    s_waitcnt vmcnt(14) lgkmcnt(0)
    v_mfma_f32_16x16x32_bf16 v[64:67], a[144:147], a[192:195], v[64:67]
    ds_read_b64_tr_b16 a[128:129], v238 offset:4096
    v_accvgpr_write_b32 a224, v144
    v_mfma_f32_16x16x32_bf16 v[68:71], a[144:147], a[196:199], v[68:71]
    ds_read_b64_tr_b16 a[130:131], v239 offset:4608
    v_accvgpr_write_b32 a225, v145
    v_mfma_f32_16x16x32_bf16 v[80:83], a[148:151], a[192:195], v[80:83]
    ds_read_b64_tr_b16 a[132:133], v238 offset:4104
    v_accvgpr_write_b32 a226, v146
    v_mfma_f32_16x16x32_bf16 v[84:87], a[148:151], a[196:199], v[84:87]
    ds_read_b64_tr_b16 a[134:135], v239 offset:4616
    v_accvgpr_write_b32 a227, v147
    v_mfma_f32_16x16x32_bf16 v[96:99], a[152:155], a[192:195], v[96:99]
    ds_read_b64_tr_b16 a[136:137], v239 offset:4096
    v_accvgpr_write_b32 a228, v148
    v_mfma_f32_16x16x32_bf16 v[100:103], a[152:155], a[196:199], v[100:103]
    ds_read_b64_tr_b16 a[138:139], v238 offset:4608
    v_accvgpr_write_b32 a229, v149
    v_mfma_f32_16x16x32_bf16 v[112:115], a[156:159], a[192:195], v[112:115]
    ds_read_b64_tr_b16 a[140:141], v239 offset:4104
    v_accvgpr_write_b32 a230, v150
    v_mfma_f32_16x16x32_bf16 v[116:119], a[156:159], a[196:199], v[116:119]
    ds_read_b64_tr_b16 a[142:143], v238 offset:4616
    v_accvgpr_write_b32 a231, v151
    v_mfma_f32_16x16x32_bf16 v[72:75], a[144:147], a[200:203], v[72:75]
    ds_read_b128 a[168:171], v244 offset:2048
    v_accvgpr_write_b32 a232, v152
    v_mfma_f32_16x16x32_bf16 v[76:79], a[144:147], a[204:207], v[76:79]
    ds_read_b128 a[172:175], v244 offset:3072
    v_accvgpr_write_b32 a233, v153
    v_mfma_f32_16x16x32_bf16 v[88:91], a[148:151], a[200:203], v[88:91]
    v_accvgpr_write_b32 a234, v154
    v_mfma_f32_16x16x32_bf16 v[92:95], a[148:151], a[204:207], v[92:95]
    s_add_u32 m0, s55, 0
    v_accvgpr_write_b32 a235, v155
    v_mfma_f32_16x16x32_bf16 v[104:107], a[152:155], a[200:203], v[104:107]
    buffer_load_dwordx4 v232, s[32:35], s56 offen lds
    v_accvgpr_write_b32 a236, v156
    v_mfma_f32_16x16x32_bf16 v[108:111], a[152:155], a[204:207], v[108:111]
    buffer_load_dwordx4 v233, s[32:35], s56 offen offset:1024 lds
    v_accvgpr_write_b32 a237, v157
    v_mfma_f32_16x16x32_bf16 v[120:123], a[156:159], a[200:203], v[120:123]
    buffer_load_dwordx4 v232, s[32:35], s57 offen offset:2048 lds
    v_accvgpr_write_b32 a238, v158
    v_mfma_f32_16x16x32_bf16 v[124:127], a[156:159], a[204:207], v[124:127]
    buffer_load_dwordx4 v233, s[32:35], s57 offen offset:3072 lds
    v_accvgpr_write_b32 a239, v159
    s_add_u32 s56, s56, 32768
    s_add_u32 s57, s57, 32768
    s_waitcnt vmcnt(14) lgkmcnt(0)
    v_mfma_f32_16x16x32_bf16 v[0:3], a[128:131], a[160:163], v[0:3]
    ds_read_b64_tr_b16 a[144:145], v238 offset:8192
    v_mov_b32 v192, 0
    v_mfma_f32_16x16x32_bf16 v[4:7], a[128:131], a[164:167], v[4:7]
    ds_read_b64_tr_b16 a[146:147], v239 offset:8704
    v_mov_b32 v193, 0
    v_mfma_f32_16x16x32_bf16 v[16:19], a[132:135], a[160:163], v[16:19]
    ds_read_b64_tr_b16 a[148:149], v238 offset:8200
    v_mov_b32 v194, 0
    v_mfma_f32_16x16x32_bf16 v[20:23], a[132:135], a[164:167], v[20:23]
    ds_read_b64_tr_b16 a[150:151], v239 offset:8712
    v_mov_b32 v195, 0
    v_mfma_f32_16x16x32_bf16 v[32:35], a[136:139], a[160:163], v[32:35]
    ds_read_b64_tr_b16 a[152:153], v239 offset:8192
    v_mov_b32 v196, 0
    v_mfma_f32_16x16x32_bf16 v[36:39], a[136:139], a[164:167], v[36:39]
    s_add_u32 s76, s76, 4096
    ds_read_b64_tr_b16 a[154:155], v238 offset:8704
    v_mov_b32 v197, 0
    v_mfma_f32_16x16x32_bf16 v[48:51], a[140:143], a[160:163], v[48:51]
    s_and_b32 s76, s76, 0xffff
    ds_read_b64_tr_b16 a[156:157], v239 offset:8200
    v_mov_b32 v198, 0
    v_mfma_f32_16x16x32_bf16 v[52:55], a[140:143], a[164:167], v[52:55]
    ds_read_b64_tr_b16 a[158:159], v238 offset:8712
    v_add_u32 v244, s76, v250
    v_mov_b32 v199, 0
    v_mfma_f32_16x16x32_bf16 v[8:11], a[128:131], a[168:171], v[8:11]
    ds_read_b128 a[176:179], v244 offset:0
    v_mfma_f32_16x16x32_bf16 v[12:15], a[128:131], a[172:175], v[12:15]
    ds_read_b128 a[180:183], v244 offset:1024
    v_mfma_f32_16x16x32_bf16 v[24:27], a[132:135], a[168:171], v[24:27]
    v_mfma_f32_16x16x32_bf16 v[28:31], a[132:135], a[172:175], v[28:31]
    s_add_u32 m0, s55, 4096
    v_mfma_f32_16x16x32_bf16 v[40:43], a[136:139], a[168:171], v[40:43]
    buffer_load_dwordx4 v232, s[32:35], s56 offen lds
    v_mfma_f32_16x16x32_bf16 v[44:47], a[136:139], a[172:175], v[44:47]
    buffer_load_dwordx4 v233, s[32:35], s56 offen offset:1024 lds
    v_mfma_f32_16x16x32_bf16 v[56:59], a[140:143], a[168:171], v[56:59]
    buffer_load_dwordx4 v232, s[32:35], s57 offen offset:2048 lds
    v_mfma_f32_16x16x32_bf16 v[60:63], a[140:143], a[172:175], v[60:63]
    buffer_load_dwordx4 v233, s[32:35], s57 offen offset:3072 lds
    s_add_u32 s56, s56, 32768
    s_add_u32 s57, s57, 32768
    s_waitcnt vmcnt(14) lgkmcnt(0)
    v_mfma_f32_16x16x32_bf16 v[64:67], a[144:147], a[160:163], v[64:67]
    ds_read_b64_tr_b16 a[128:129], v238 offset:12288
    v_mfma_f32_16x16x32_bf16 v[68:71], a[144:147], a[164:167], v[68:71]
    ds_read_b64_tr_b16 a[130:131], v239 offset:12800
    v_mfma_f32_16x16x32_bf16 v[80:83], a[148:151], a[160:163], v[80:83]
    ds_read_b64_tr_b16 a[132:133], v238 offset:12296
    v_mfma_f32_16x16x32_bf16 v[84:87], a[148:151], a[164:167], v[84:87]
    ds_read_b64_tr_b16 a[134:135], v239 offset:12808
    v_mfma_f32_16x16x32_bf16 v[96:99], a[152:155], a[160:163], v[96:99]
    ds_read_b64_tr_b16 a[136:137], v239 offset:12288
    v_mfma_f32_16x16x32_bf16 v[100:103], a[152:155], a[164:167], v[100:103]
    ds_read_b64_tr_b16 a[138:139], v238 offset:12800
    v_mfma_f32_16x16x32_bf16 v[112:115], a[156:159], a[160:163], v[112:115]
    ds_read_b64_tr_b16 a[140:141], v239 offset:12296
    v_mfma_f32_16x16x32_bf16 v[116:119], a[156:159], a[164:167], v[116:119]
    ds_read_b64_tr_b16 a[142:143], v238 offset:12808
    v_mfma_f32_16x16x32_bf16 v[72:75], a[144:147], a[168:171], v[72:75]
    ds_read_b128 a[184:187], v244 offset:2048
    v_mfma_f32_16x16x32_bf16 v[76:79], a[144:147], a[172:175], v[76:79]
    ds_read_b128 a[188:191], v244 offset:3072
    v_mfma_f32_16x16x32_bf16 v[88:91], a[148:151], a[168:171], v[88:91]
    v_mfma_f32_16x16x32_bf16 v[92:95], a[148:151], a[172:175], v[92:95]
    s_add_u32 m0, s55, 8192
    v_mfma_f32_16x16x32_bf16 v[104:107], a[152:155], a[168:171], v[104:107]
    buffer_load_dwordx4 v224, s[40:43], s60 offen lds
    v_mfma_f32_16x16x32_bf16 v[108:111], a[152:155], a[172:175], v[108:111]
    buffer_load_dwordx4 v225, s[40:43], s60 offen offset:1024 lds
    v_mfma_f32_16x16x32_bf16 v[120:123], a[156:159], a[168:171], v[120:123]
    buffer_load_dwordx4 v226, s[44:47], s60 offen offset:2048 lds
    v_mfma_f32_16x16x32_bf16 v[124:127], a[156:159], a[172:175], v[124:127]
    buffer_load_dwordx4 v227, s[44:47], s60 offen offset:3072 lds
    s_add_u32 s60, s60, s61
    s_waitcnt vmcnt(14) lgkmcnt(0)
    v_mfma_f32_16x16x32_bf16 v[0:3], a[128:131], a[176:179], v[0:3]
    ds_read_b64_tr_b16 a[144:145], v238 offset:16384
    v_mfma_f32_16x16x32_bf16 v[4:7], a[128:131], a[180:183], v[4:7]
    ds_read_b64_tr_b16 a[146:147], v239 offset:16896
    v_mfma_f32_16x16x32_bf16 v[16:19], a[132:135], a[176:179], v[16:19]
    ds_read_b64_tr_b16 a[148:149], v238 offset:16392
    v_mfma_f32_16x16x32_bf16 v[20:23], a[132:135], a[180:183], v[20:23]
    ds_read_b64_tr_b16 a[150:151], v239 offset:16904
    v_mfma_f32_16x16x32_bf16 v[32:35], a[136:139], a[176:179], v[32:35]
    ds_read_b64_tr_b16 a[152:153], v239 offset:16384
    v_mfma_f32_16x16x32_bf16 v[36:39], a[136:139], a[180:183], v[36:39]
    ds_read_b64_tr_b16 a[154:155], v238 offset:16896
    v_mfma_f32_16x16x32_bf16 v[48:51], a[140:143], a[176:179], v[48:51]
    ds_read_b64_tr_b16 a[156:157], v239 offset:16392
    v_mfma_f32_16x16x32_bf16 v[52:55], a[140:143], a[180:183], v[52:55]
    ds_read_b64_tr_b16 a[158:159], v238 offset:16904
    v_mfma_f32_16x16x32_bf16 v[8:11], a[128:131], a[184:187], v[8:11]
    v_mfma_f32_16x16x32_bf16 v[12:15], a[128:131], a[188:191], v[12:15]
    v_mfma_f32_16x16x32_bf16 v[24:27], a[132:135], a[184:187], v[24:27]
    v_mfma_f32_16x16x32_bf16 v[28:31], a[132:135], a[188:191], v[28:31]
    s_add_u32 m0, s55, 12288
    v_mfma_f32_16x16x32_bf16 v[40:43], a[136:139], a[184:187], v[40:43]
    buffer_load_dwordx4 v224, s[40:43], s60 offen lds
    v_mfma_f32_16x16x32_bf16 v[44:47], a[136:139], a[188:191], v[44:47]
    buffer_load_dwordx4 v225, s[40:43], s60 offen offset:1024 lds
    v_mfma_f32_16x16x32_bf16 v[56:59], a[140:143], a[184:187], v[56:59]
    buffer_load_dwordx4 v226, s[44:47], s60 offen offset:2048 lds
    v_mfma_f32_16x16x32_bf16 v[60:63], a[140:143], a[188:191], v[60:63]
    buffer_load_dwordx4 v227, s[44:47], s60 offen offset:3072 lds
    s_add_u32 s60, s60, s61
    s_waitcnt lgkmcnt(0)
    v_mfma_f32_16x16x32_bf16 v[64:67], a[144:147], a[176:179], v[64:67]
    v_cvt_pk_bf16_f32 v0, v0, v1
    v_cvt_pk_bf16_f32 v1, v2, v3
    v_mfma_f32_16x16x32_bf16 v[68:71], a[144:147], a[180:183], v[68:71]
    v_cvt_pk_bf16_f32 v16, v16, v17
    v_cvt_pk_bf16_f32 v17, v18, v19
    v_mfma_f32_16x16x32_bf16 v[80:83], a[148:151], a[176:179], v[80:83]
    v_accvgpr_write_b32 a0, v0
    v_accvgpr_write_b32 a1, v1
    v_mfma_f32_16x16x32_bf16 v[84:87], a[148:151], a[180:183], v[84:87]
    v_accvgpr_write_b32 a2, v16
    v_accvgpr_write_b32 a3, v17
    v_mfma_f32_16x16x32_bf16 v[96:99], a[152:155], a[176:179], v[96:99]
    v_cvt_pk_bf16_f32 v4, v4, v5
    v_cvt_pk_bf16_f32 v5, v6, v7
    v_mfma_f32_16x16x32_bf16 v[100:103], a[152:155], a[180:183], v[100:103]
    v_cvt_pk_bf16_f32 v20, v20, v21
    v_cvt_pk_bf16_f32 v21, v22, v23
    v_mfma_f32_16x16x32_bf16 v[112:115], a[156:159], a[176:179], v[112:115]
    v_accvgpr_write_b32 a16, v4
    v_accvgpr_write_b32 a17, v5
    v_mfma_f32_16x16x32_bf16 v[116:119], a[156:159], a[180:183], v[116:119]
    v_accvgpr_write_b32 a18, v20
    v_accvgpr_write_b32 a19, v21
    v_mfma_f32_16x16x32_bf16 v[72:75], a[144:147], a[184:187], v[72:75]
    v_cvt_pk_bf16_f32 v8, v8, v9
    v_cvt_pk_bf16_f32 v9, v10, v11
    v_mfma_f32_16x16x32_bf16 v[76:79], a[144:147], a[188:191], v[76:79]
    v_cvt_pk_bf16_f32 v24, v24, v25
    v_cvt_pk_bf16_f32 v25, v26, v27
    v_mfma_f32_16x16x32_bf16 v[88:91], a[148:151], a[184:187], v[88:91]
    v_accvgpr_write_b32 a32, v8
    v_accvgpr_write_b32 a33, v9
    v_mfma_f32_16x16x32_bf16 v[92:95], a[148:151], a[188:191], v[92:95]
    s_add_u32 m0, s55, 16384
    v_accvgpr_write_b32 a34, v24
    v_accvgpr_write_b32 a35, v25
    v_mfma_f32_16x16x32_bf16 v[104:107], a[152:155], a[184:187], v[104:107]
    buffer_load_dwordx4 v224, s[40:43], s60 offen lds
    v_cvt_pk_bf16_f32 v12, v12, v13
    v_cvt_pk_bf16_f32 v13, v14, v15
    v_mfma_f32_16x16x32_bf16 v[108:111], a[152:155], a[188:191], v[108:111]
    buffer_load_dwordx4 v225, s[40:43], s60 offen offset:1024 lds
    v_cvt_pk_bf16_f32 v28, v28, v29
    v_cvt_pk_bf16_f32 v29, v30, v31
    v_mfma_f32_16x16x32_bf16 v[120:123], a[156:159], a[184:187], v[120:123]
    buffer_load_dwordx4 v226, s[44:47], s60 offen offset:2048 lds
    v_accvgpr_write_b32 a48, v12
    v_accvgpr_write_b32 a49, v13
    v_mfma_f32_16x16x32_bf16 v[124:127], a[156:159], a[188:191], v[124:127]
    buffer_load_dwordx4 v227, s[44:47], s60 offen offset:3072 lds
    v_accvgpr_write_b32 a50, v28
    v_accvgpr_write_b32 a51, v29
    s_add_u32 s60, s60, s61
    s_waitcnt vmcnt(20)
    s_barrier
    ds_read_b128 a[64:67], v212 offset:12288
    ds_read_b128 a[68:71], v213 offset:12288
    ds_read_b128 a[72:75], v214 offset:12288
    ds_read_b128 a[76:79], v215 offset:12288
    ds_read_b128 a[80:83], v212 offset:61440
    ds_read_b128 a[84:87], v213 offset:61440
    ds_read_b128 a[88:91], v214 offset:61440
    ds_read_b128 a[92:95], v215 offset:61440
    v_cvt_pk_bf16_f32 v32, v32, v33
    v_cvt_pk_bf16_f32 v33, v34, v35
    v_cvt_pk_bf16_f32 v48, v48, v49
    v_cvt_pk_bf16_f32 v49, v50, v51
    s_waitcnt lgkmcnt(0)
    v_mfma_f32_16x16x32_bf16 v[128:131], a[64:67], a[0:3], 0
    v_accvgpr_write_b32 a4, v32
    v_accvgpr_write_b32 a5, v33
    v_accvgpr_write_b32 a6, v48
    v_accvgpr_write_b32 a7, v49
    v_cvt_pk_bf16_f32 v36, v36, v37
    v_cvt_pk_bf16_f32 v37, v38, v39
    v_cvt_pk_bf16_f32 v52, v52, v53
    v_cvt_pk_bf16_f32 v53, v54, v55
    v_mfma_f32_16x16x32_bf16 v[136:139], a[64:67], a[16:19], 0
    v_accvgpr_write_b32 a20, v36
    v_accvgpr_write_b32 a21, v37
    v_accvgpr_write_b32 a22, v52
    v_accvgpr_write_b32 a23, v53
    v_cvt_pk_bf16_f32 v40, v40, v41
    v_cvt_pk_bf16_f32 v41, v42, v43
    v_cvt_pk_bf16_f32 v56, v56, v57
    v_cvt_pk_bf16_f32 v57, v58, v59
    v_mfma_f32_16x16x32_bf16 v[144:147], a[64:67], a[32:35], 0
    v_accvgpr_write_b32 a36, v40
    v_accvgpr_write_b32 a37, v41
    v_accvgpr_write_b32 a38, v56
    v_accvgpr_write_b32 a39, v57
    v_cvt_pk_bf16_f32 v44, v44, v45
    v_cvt_pk_bf16_f32 v45, v46, v47
    v_cvt_pk_bf16_f32 v60, v60, v61
    v_cvt_pk_bf16_f32 v61, v62, v63
    v_mfma_f32_16x16x32_bf16 v[152:155], a[64:67], a[48:51], 0
    v_accvgpr_write_b32 a52, v44
    v_accvgpr_write_b32 a53, v45
    v_accvgpr_write_b32 a54, v60
    v_accvgpr_write_b32 a55, v61
    v_cvt_pk_bf16_f32 v64, v64, v65
    v_cvt_pk_bf16_f32 v65, v66, v67
    v_cvt_pk_bf16_f32 v80, v80, v81
    v_cvt_pk_bf16_f32 v81, v82, v83
    v_mfma_f32_16x16x32_bf16 v[128:131], a[68:71], a[4:7], v[128:131]
    v_accvgpr_write_b32 a8, v64
    v_accvgpr_write_b32 a9, v65
    v_accvgpr_write_b32 a10, v80
    v_accvgpr_write_b32 a11, v81
    v_cvt_pk_bf16_f32 v68, v68, v69
    v_cvt_pk_bf16_f32 v69, v70, v71
    v_cvt_pk_bf16_f32 v84, v84, v85
    v_cvt_pk_bf16_f32 v85, v86, v87
    v_mfma_f32_16x16x32_bf16 v[136:139], a[68:71], a[20:23], v[136:139]
    v_accvgpr_write_b32 a24, v68
    v_accvgpr_write_b32 a25, v69
    v_accvgpr_write_b32 a26, v84
    v_accvgpr_write_b32 a27, v85
    v_cvt_pk_bf16_f32 v72, v72, v73
    v_cvt_pk_bf16_f32 v73, v74, v75
    v_cvt_pk_bf16_f32 v88, v88, v89
    v_cvt_pk_bf16_f32 v89, v90, v91
    v_mfma_f32_16x16x32_bf16 v[144:147], a[68:71], a[36:39], v[144:147]
    v_accvgpr_write_b32 a40, v72
    v_accvgpr_write_b32 a41, v73
    v_accvgpr_write_b32 a42, v88
    v_accvgpr_write_b32 a43, v89
    v_cvt_pk_bf16_f32 v76, v76, v77
    v_cvt_pk_bf16_f32 v77, v78, v79
    v_cvt_pk_bf16_f32 v92, v92, v93
    v_cvt_pk_bf16_f32 v93, v94, v95
    v_mfma_f32_16x16x32_bf16 v[152:155], a[68:71], a[52:55], v[152:155]
    v_accvgpr_write_b32 a56, v76
    v_accvgpr_write_b32 a57, v77
    v_accvgpr_write_b32 a58, v92
    v_accvgpr_write_b32 a59, v93
    v_cvt_pk_bf16_f32 v96, v96, v97
    v_cvt_pk_bf16_f32 v97, v98, v99
    v_cvt_pk_bf16_f32 v112, v112, v113
    v_cvt_pk_bf16_f32 v113, v114, v115
    v_mfma_f32_16x16x32_bf16 v[128:131], a[72:75], a[8:11], v[128:131]
    v_accvgpr_write_b32 a12, v96
    v_accvgpr_write_b32 a13, v97
    v_accvgpr_write_b32 a14, v112
    v_accvgpr_write_b32 a15, v113
    v_cvt_pk_bf16_f32 v100, v100, v101
    v_cvt_pk_bf16_f32 v101, v102, v103
    v_cvt_pk_bf16_f32 v116, v116, v117
    v_cvt_pk_bf16_f32 v117, v118, v119
    v_mfma_f32_16x16x32_bf16 v[136:139], a[72:75], a[24:27], v[136:139]
    v_accvgpr_write_b32 a28, v100
    v_accvgpr_write_b32 a29, v101
    v_accvgpr_write_b32 a30, v116
    v_accvgpr_write_b32 a31, v117
    v_cvt_pk_bf16_f32 v104, v104, v105
    v_cvt_pk_bf16_f32 v105, v106, v107
    v_cvt_pk_bf16_f32 v120, v120, v121
    v_cvt_pk_bf16_f32 v121, v122, v123
    v_mfma_f32_16x16x32_bf16 v[144:147], a[72:75], a[40:43], v[144:147]
    v_accvgpr_write_b32 a44, v104
    v_accvgpr_write_b32 a45, v105
    v_accvgpr_write_b32 a46, v120
    v_accvgpr_write_b32 a47, v121
    v_cvt_pk_bf16_f32 v108, v108, v109
    v_cvt_pk_bf16_f32 v109, v110, v111
    v_cvt_pk_bf16_f32 v124, v124, v125
    v_cvt_pk_bf16_f32 v125, v126, v127
    v_mfma_f32_16x16x32_bf16 v[152:155], a[72:75], a[56:59], v[152:155]
    v_accvgpr_write_b32 a60, v108
    v_accvgpr_write_b32 a61, v109
    v_accvgpr_write_b32 a62, v124
    v_accvgpr_write_b32 a63, v125
    s_nop 0
    v_mfma_f32_16x16x32_bf16 v[128:131], a[76:79], a[12:15], v[128:131]
    v_mfma_f32_16x16x32_bf16 v[136:139], a[76:79], a[28:31], v[136:139]
    v_mfma_f32_16x16x32_bf16 v[144:147], a[76:79], a[44:47], v[144:147]
    v_mfma_f32_16x16x32_bf16 v[152:155], a[76:79], a[60:63], v[152:155]
    s_nop 5
    v_max3_f32 v176, v128, v129, v130
    v_max3_f32 v177, v136, v137, v138
    v_max3_f32 v178, v144, v145, v146
    v_max3_f32 v179, v152, v153, v154
    v_max_f32 v176, v176, v131
    v_max_f32 v177, v177, v139
    v_max_f32 v178, v178, v147
    v_max_f32 v179, v179, v155
    v_mov_b32 v180, v176
    v_mov_b32 v181, v177
    v_mov_b32 v182, v178
    v_mov_b32 v183, v179
    v_permlane16_swap_b32 v180, v176
    v_permlane16_swap_b32 v181, v177
    v_permlane16_swap_b32 v182, v178
    v_permlane16_swap_b32 v183, v179
    v_max_f32 v176, v176, v180
    v_max_f32 v177, v177, v181
    v_max_f32 v178, v178, v182
    v_max_f32 v179, v179, v183
    v_mov_b32 v180, v176
    v_mov_b32 v181, v177
    v_mov_b32 v182, v178
    v_mov_b32 v183, v179
    v_permlane32_swap_b32 v180, v176
    v_permlane32_swap_b32 v181, v177
    v_permlane32_swap_b32 v182, v178
    v_permlane32_swap_b32 v183, v179
    v_max_f32 v176, v176, v180
    v_max_f32 v177, v177, v181
    v_max_f32 v178, v178, v182
    v_max_f32 v179, v179, v183
    v_sub_f32 v160, 0, v176
    v_sub_f32 v161, 0, v176
    v_sub_f32 v162, 0, v176
    v_sub_f32 v163, 0, v176
    v_sub_f32 v164, 0, v177
    v_sub_f32 v165, 0, v177
    v_sub_f32 v166, 0, v177
    v_sub_f32 v167, 0, v177
    v_sub_f32 v168, 0, v178
    v_sub_f32 v169, 0, v178
    v_sub_f32 v170, 0, v178
    v_sub_f32 v171, 0, v178
    v_sub_f32 v172, 0, v179
    v_sub_f32 v173, 0, v179
    v_sub_f32 v174, 0, v179
    v_sub_f32 v175, 0, v179
    s_mov_b32 s59, 15
    s_cmp_eq_u32 s52, 0
    s_cselect_b32 s86, 12, 7
    v_mfma_f32_16x16x32_bf16 v[128:131], a[64:67], a[0:3], v[160:163]
    v_mfma_f32_16x16x32_bf16 v[128:131], a[68:71], a[4:7], v[128:131]
    v_mfma_f32_16x16x32_bf16 v[128:131], a[72:75], a[8:11], v[128:131]
    v_mfma_f32_16x16x32_bf16 v[128:131], a[76:79], a[12:15], v[128:131]
    s_waitcnt vmcnt(8) lgkmcnt(0)
    v_mfma_f32_16x16x32_bf16 v[132:135], a[80:83], a[0:3], v[160:163]
    s_barrier
    v_mfma_f32_16x16x32_bf16 v[132:135], a[84:87], a[4:7], v[132:135]
    s_add_u32 m0, s55, 20480
    v_mfma_f32_16x16x32_bf16 v[132:135], a[88:91], a[8:11], v[132:135]
    v_mfma_f32_16x16x32_bf16 v[132:135], a[92:95], a[12:15], v[132:135]
    v_mfma_f32_16x16x32_bf16 v[136:139], a[64:67], a[16:19], v[164:167]
    buffer_load_dwordx4 v224, s[40:43], s60 offen lds
    v_mfma_f32_16x16x32_bf16 v[136:139], a[68:71], a[20:23], v[136:139]
    v_mfma_f32_16x16x32_bf16 v[136:139], a[72:75], a[24:27], v[136:139]
    v_mfma_f32_16x16x32_bf16 v[136:139], a[76:79], a[28:31], v[136:139]
    v_exp_f32 v128, v128
    v_mfma_f32_16x16x32_bf16 v[140:143], a[80:83], a[16:19], v[164:167]
    buffer_load_dwordx4 v225, s[40:43], s60 offen offset:1024 lds
    v_mfma_f32_16x16x32_bf16 v[140:143], a[84:87], a[20:23], v[140:143]
    v_exp_f32 v129, v129
    v_mfma_f32_16x16x32_bf16 v[140:143], a[88:91], a[24:27], v[140:143]
    v_cvt_pk_bf16_f32 v176, v128, v129
    v_mfma_f32_16x16x32_bf16 v[140:143], a[92:95], a[28:31], v[140:143]
    v_exp_f32 v130, v130
    buffer_load_dwordx4 v226, s[44:47], s60 offen offset:2048 lds
    v_exp_f32 v131, v131
    ds_read_b64_tr_b16 a[96:97], v216 offset:2048
    v_cvt_pk_bf16_f32 v177, v130, v131
    v_exp_f32 v132, v132
    buffer_load_dwordx4 v227, s[44:47], s60 offen offset:3072 lds
    ds_read_b64_tr_b16 a[98:99], v216 offset:51200
    s_add_u32 s60, s60, s61
    v_exp_f32 v133, v133
    ds_read_b64_tr_b16 a[100:101], v217 offset:2048
    v_cvt_pk_bf16_f32 v178, v132, v133
    v_exp_f32 v134, v134
    ds_read_b64_tr_b16 a[102:103], v217 offset:51200
    v_exp_f32 v135, v135
    ds_read_b64_tr_b16 a[104:105], v218 offset:2048
    v_cvt_pk_bf16_f32 v179, v134, v135
    v_exp_f32 v136, v136
    buffer_store_dwordx4 a[208:211], v245, s[48:51], s77 offen offset:0 sc1
    ds_read_b64_tr_b16 a[106:107], v218 offset:51200
    v_exp_f32 v137, v137
    ds_read_b64_tr_b16 a[108:109], v219 offset:2048
    v_cvt_pk_bf16_f32 v180, v136, v137
    v_exp_f32 v138, v138
    ds_read_b64_tr_b16 a[110:111], v219 offset:51200
    v_mfma_f32_16x16x32_bf16 v[144:147], a[64:67], a[32:35], v[168:171]
    ds_read_b64_tr_b16 a[112:113], v220 offset:2048
    v_mfma_f32_16x16x32_bf16 v[144:147], a[68:71], a[36:39], v[144:147]
    v_exp_f32 v139, v139
    v_mfma_f32_16x16x32_bf16 v[144:147], a[72:75], a[40:43], v[144:147]
    ds_read_b64_tr_b16 a[114:115], v220 offset:51200
    v_cvt_pk_bf16_f32 v181, v138, v139
    v_mfma_f32_16x16x32_bf16 v[144:147], a[76:79], a[44:47], v[144:147]
    v_exp_f32 v140, v140
    v_mfma_f32_16x16x32_bf16 v[148:151], a[80:83], a[32:35], v[168:171]
    ds_read_b64_tr_b16 a[116:117], v221 offset:2048
    v_mfma_f32_16x16x32_bf16 v[148:151], a[84:87], a[36:39], v[148:151]
    v_exp_f32 v141, v141
    v_mfma_f32_16x16x32_bf16 v[148:151], a[88:91], a[40:43], v[148:151]
    ds_read_b64_tr_b16 a[118:119], v221 offset:51200
    v_cvt_pk_bf16_f32 v182, v140, v141
    v_mfma_f32_16x16x32_bf16 v[148:151], a[92:95], a[44:47], v[148:151]
    v_exp_f32 v142, v142
    v_mfma_f32_16x16x32_bf16 v[152:155], a[64:67], a[48:51], v[172:175]
    ds_read_b64_tr_b16 a[120:121], v222 offset:2048
    v_mfma_f32_16x16x32_bf16 v[152:155], a[68:71], a[52:55], v[152:155]
    v_exp_f32 v143, v143
    v_mfma_f32_16x16x32_bf16 v[152:155], a[72:75], a[56:59], v[152:155]
    ds_read_b64_tr_b16 a[122:123], v222 offset:51200
    v_cvt_pk_bf16_f32 v183, v142, v143
    v_mfma_f32_16x16x32_bf16 v[152:155], a[76:79], a[60:63], v[152:155]
    v_exp_f32 v144, v144
    v_mfma_f32_16x16x32_bf16 v[156:159], a[80:83], a[48:51], v[172:175]
    ds_read_b64_tr_b16 a[124:125], v223 offset:2048
    v_mfma_f32_16x16x32_bf16 v[156:159], a[84:87], a[52:55], v[156:159]
    v_exp_f32 v145, v145
    v_mfma_f32_16x16x32_bf16 v[156:159], a[88:91], a[56:59], v[156:159]
    ds_read_b64_tr_b16 a[126:127], v223 offset:51200
    v_cvt_pk_bf16_f32 v184, v144, v145
    v_mfma_f32_16x16x32_bf16 v[156:159], a[92:95], a[60:63], v[156:159]
    s_waitcnt lgkmcnt(8)
    v_exp_f32 v146, v146
    v_mfma_f32_16x16x32_bf16 v[0:3], a[96:99], v[176:179], 0
    ds_read_b128 a[64:67], v212 offset:0
    v_mfma_f32_16x16x32_bf16 v[4:7], a[96:99], v[180:183], 0
    v_exp_f32 v147, v147
    v_mfma_f32_16x16x32_bf16 v[16:19], a[100:103], v[176:179], 0
    ds_read_b128 a[68:71], v213 offset:0
    v_cvt_pk_bf16_f32 v185, v146, v147
    v_mfma_f32_16x16x32_bf16 v[20:23], a[100:103], v[180:183], 0
    v_exp_f32 v148, v148
    v_mfma_f32_16x16x32_bf16 v[32:35], a[104:107], v[176:179], 0
    ds_read_b128 a[72:75], v214 offset:0
    v_mfma_f32_16x16x32_bf16 v[36:39], a[104:107], v[180:183], 0
    v_exp_f32 v149, v149
    v_mfma_f32_16x16x32_bf16 v[48:51], a[108:111], v[176:179], 0
    ds_read_b128 a[76:79], v215 offset:0
    v_cvt_pk_bf16_f32 v186, v148, v149
    v_mfma_f32_16x16x32_bf16 v[52:55], a[108:111], v[180:183], 0
    s_waitcnt lgkmcnt(4)
    v_exp_f32 v150, v150
    v_mfma_f32_16x16x32_bf16 v[64:67], a[112:115], v[176:179], 0
    buffer_store_dwordx4 a[212:215], v245, s[48:51], s77 offen offset:1024 sc1
    ds_read_b128 a[80:83], v212 offset:49152
    v_mfma_f32_16x16x32_bf16 v[68:71], a[112:115], v[180:183], 0
    v_exp_f32 v151, v151
    v_mfma_f32_16x16x32_bf16 v[80:83], a[116:119], v[176:179], 0
    ds_read_b128 a[84:87], v213 offset:49152
    v_cvt_pk_bf16_f32 v187, v150, v151
    v_mfma_f32_16x16x32_bf16 v[84:87], a[116:119], v[180:183], 0
    v_exp_f32 v152, v152
    v_mfma_f32_16x16x32_bf16 v[96:99], a[120:123], v[176:179], 0
    ds_read_b128 a[88:91], v214 offset:49152
    v_mfma_f32_16x16x32_bf16 v[100:103], a[120:123], v[180:183], 0
    v_exp_f32 v153, v153
    v_mfma_f32_16x16x32_bf16 v[112:115], a[124:127], v[176:179], 0
    ds_read_b128 a[92:95], v215 offset:49152
    v_cvt_pk_bf16_f32 v188, v152, v153
    v_mfma_f32_16x16x32_bf16 v[116:119], a[124:127], v[180:183], 0
    v_exp_f32 v154, v154
    v_smfmac_f32_16x16x64_bf16 v[192:195], v[208:211], v[176:183], v207
    s_waitcnt lgkmcnt(4)
    v_mfma_f32_16x16x32_bf16 v[128:131], a[64:67], a[0:3], v[160:163]
    v_mfma_f32_16x16x32_bf16 v[128:131], a[68:71], a[4:7], v[128:131]
    v_exp_f32 v155, v155
    v_mfma_f32_16x16x32_bf16 v[128:131], a[72:75], a[8:11], v[128:131]
    v_cvt_pk_bf16_f32 v189, v154, v155
    v_mfma_f32_16x16x32_bf16 v[128:131], a[76:79], a[12:15], v[128:131]
    s_waitcnt vmcnt(10) lgkmcnt(0)
    v_exp_f32 v156, v156
    v_mfma_f32_16x16x32_bf16 v[132:135], a[80:83], a[0:3], v[160:163]
    s_barrier
    v_mfma_f32_16x16x32_bf16 v[132:135], a[84:87], a[4:7], v[132:135]
    s_add_u32 m0, s55, 8192
    v_exp_f32 v157, v157
    v_mfma_f32_16x16x32_bf16 v[132:135], a[88:91], a[8:11], v[132:135]
    v_cvt_pk_bf16_f32 v190, v156, v157
    v_mfma_f32_16x16x32_bf16 v[132:135], a[92:95], a[12:15], v[132:135]
    v_exp_f32 v158, v158
    v_mfma_f32_16x16x32_bf16 v[136:139], a[64:67], a[16:19], v[164:167]
    buffer_load_dwordx4 v224, s[40:43], s60 offen lds
    v_mfma_f32_16x16x32_bf16 v[136:139], a[68:71], a[20:23], v[136:139]
    v_exp_f32 v159, v159
    v_mfma_f32_16x16x32_bf16 v[136:139], a[72:75], a[24:27], v[136:139]
    v_cvt_pk_bf16_f32 v191, v158, v159
    v_mfma_f32_16x16x32_bf16 v[136:139], a[76:79], a[28:31], v[136:139]
    v_exp_f32 v128, v128
    v_mfma_f32_16x16x32_bf16 v[140:143], a[80:83], a[16:19], v[164:167]
    buffer_load_dwordx4 v225, s[40:43], s60 offen offset:1024 lds
    v_mfma_f32_16x16x32_bf16 v[140:143], a[84:87], a[20:23], v[140:143]
    v_exp_f32 v129, v129
    v_mfma_f32_16x16x32_bf16 v[140:143], a[88:91], a[24:27], v[140:143]
    v_cvt_pk_bf16_f32 v176, v128, v129
    v_mfma_f32_16x16x32_bf16 v[140:143], a[92:95], a[28:31], v[140:143]
    v_exp_f32 v130, v130
    v_mfma_f32_16x16x32_bf16 v[8:11], a[96:99], v[184:187], 0
    buffer_load_dwordx4 v226, s[44:47], s60 offen offset:2048 lds
    v_mfma_f32_16x16x32_bf16 v[12:15], a[96:99], v[188:191], 0
    v_exp_f32 v131, v131
    v_mfma_f32_16x16x32_bf16 v[24:27], a[100:103], v[184:187], 0
    ds_read_b64_tr_b16 a[96:97], v216 offset:6144
    v_cvt_pk_bf16_f32 v177, v130, v131
    v_mfma_f32_16x16x32_bf16 v[28:31], a[100:103], v[188:191], 0
    v_exp_f32 v132, v132
    v_mfma_f32_16x16x32_bf16 v[40:43], a[104:107], v[184:187], 0
    buffer_load_dwordx4 v227, s[44:47], s60 offen offset:3072 lds
    ds_read_b64_tr_b16 a[98:99], v216 offset:55296
    v_mfma_f32_16x16x32_bf16 v[44:47], a[104:107], v[188:191], 0
    s_add_u32 s60, s60, s61
    v_exp_f32 v133, v133
    v_mfma_f32_16x16x32_bf16 v[56:59], a[108:111], v[184:187], 0
    ds_read_b64_tr_b16 a[100:101], v217 offset:6144
    v_cvt_pk_bf16_f32 v178, v132, v133
    v_mfma_f32_16x16x32_bf16 v[60:63], a[108:111], v[188:191], 0
    v_exp_f32 v134, v134
    v_mfma_f32_16x16x32_bf16 v[72:75], a[112:115], v[184:187], 0
    ds_read_b64_tr_b16 a[102:103], v217 offset:55296
    v_mfma_f32_16x16x32_bf16 v[76:79], a[112:115], v[188:191], 0
    v_exp_f32 v135, v135
    v_mfma_f32_16x16x32_bf16 v[88:91], a[116:119], v[184:187], 0
    ds_read_b64_tr_b16 a[104:105], v218 offset:6144
    v_cvt_pk_bf16_f32 v179, v134, v135
    v_mfma_f32_16x16x32_bf16 v[92:95], a[116:119], v[188:191], 0
    v_exp_f32 v136, v136
    v_mfma_f32_16x16x32_bf16 v[104:107], a[120:123], v[184:187], 0
    buffer_store_dwordx4 a[216:219], v245, s[48:51], s77 offen offset:2048 sc1
    ds_read_b64_tr_b16 a[106:107], v218 offset:55296
    v_mfma_f32_16x16x32_bf16 v[108:111], a[120:123], v[188:191], 0
    v_exp_f32 v137, v137
    v_mfma_f32_16x16x32_bf16 v[120:123], a[124:127], v[184:187], 0
    ds_read_b64_tr_b16 a[108:109], v219 offset:6144
    v_cvt_pk_bf16_f32 v180, v136, v137
    v_mfma_f32_16x16x32_bf16 v[124:127], a[124:127], v[188:191], 0
    v_exp_f32 v138, v138
    v_smfmac_f32_16x16x64_bf16 v[196:199], v[208:211], v[184:191], v207
    ds_read_b64_tr_b16 a[110:111], v219 offset:55296
    v_mfma_f32_16x16x32_bf16 v[144:147], a[64:67], a[32:35], v[168:171]
    ds_read_b64_tr_b16 a[112:113], v220 offset:6144
    v_mfma_f32_16x16x32_bf16 v[144:147], a[68:71], a[36:39], v[144:147]
    v_exp_f32 v139, v139
    v_mfma_f32_16x16x32_bf16 v[144:147], a[72:75], a[40:43], v[144:147]
    ds_read_b64_tr_b16 a[114:115], v220 offset:55296
    v_cvt_pk_bf16_f32 v181, v138, v139
    v_mfma_f32_16x16x32_bf16 v[144:147], a[76:79], a[44:47], v[144:147]
    v_exp_f32 v140, v140
    v_mfma_f32_16x16x32_bf16 v[148:151], a[80:83], a[32:35], v[168:171]
    ds_read_b64_tr_b16 a[116:117], v221 offset:6144
    v_mfma_f32_16x16x32_bf16 v[148:151], a[84:87], a[36:39], v[148:151]
    v_exp_f32 v141, v141
    v_mfma_f32_16x16x32_bf16 v[148:151], a[88:91], a[40:43], v[148:151]
    ds_read_b64_tr_b16 a[118:119], v221 offset:55296
    v_cvt_pk_bf16_f32 v182, v140, v141
    v_mfma_f32_16x16x32_bf16 v[148:151], a[92:95], a[44:47], v[148:151]
    v_exp_f32 v142, v142
    v_mfma_f32_16x16x32_bf16 v[152:155], a[64:67], a[48:51], v[172:175]
    ds_read_b64_tr_b16 a[120:121], v222 offset:6144
    v_mfma_f32_16x16x32_bf16 v[152:155], a[68:71], a[52:55], v[152:155]
    v_exp_f32 v143, v143
    v_mfma_f32_16x16x32_bf16 v[152:155], a[72:75], a[56:59], v[152:155]
    ds_read_b64_tr_b16 a[122:123], v222 offset:55296
    v_cvt_pk_bf16_f32 v183, v142, v143
    v_mfma_f32_16x16x32_bf16 v[152:155], a[76:79], a[60:63], v[152:155]
    v_exp_f32 v144, v144
    v_mfma_f32_16x16x32_bf16 v[156:159], a[80:83], a[48:51], v[172:175]
    ds_read_b64_tr_b16 a[124:125], v223 offset:6144
    v_mfma_f32_16x16x32_bf16 v[156:159], a[84:87], a[52:55], v[156:159]
    v_exp_f32 v145, v145
    v_mfma_f32_16x16x32_bf16 v[156:159], a[88:91], a[56:59], v[156:159]
    ds_read_b64_tr_b16 a[126:127], v223 offset:55296
    v_cvt_pk_bf16_f32 v184, v144, v145
    v_mfma_f32_16x16x32_bf16 v[156:159], a[92:95], a[60:63], v[156:159]
    s_waitcnt lgkmcnt(8)
    v_exp_f32 v146, v146
    v_mfma_f32_16x16x32_bf16 v[0:3], a[96:99], v[176:179], v[0:3]
    ds_read_b128 a[64:67], v212 offset:4096
    v_mfma_f32_16x16x32_bf16 v[4:7], a[96:99], v[180:183], v[4:7]
    v_exp_f32 v147, v147
    v_mfma_f32_16x16x32_bf16 v[16:19], a[100:103], v[176:179], v[16:19]
    ds_read_b128 a[68:71], v213 offset:4096
    v_cvt_pk_bf16_f32 v185, v146, v147
    v_mfma_f32_16x16x32_bf16 v[20:23], a[100:103], v[180:183], v[20:23]
    v_exp_f32 v148, v148
    v_mfma_f32_16x16x32_bf16 v[32:35], a[104:107], v[176:179], v[32:35]
    ds_read_b128 a[72:75], v214 offset:4096
    v_mfma_f32_16x16x32_bf16 v[36:39], a[104:107], v[180:183], v[36:39]
    v_exp_f32 v149, v149
    v_mfma_f32_16x16x32_bf16 v[48:51], a[108:111], v[176:179], v[48:51]
    ds_read_b128 a[76:79], v215 offset:4096
    v_cvt_pk_bf16_f32 v186, v148, v149
    v_mfma_f32_16x16x32_bf16 v[52:55], a[108:111], v[180:183], v[52:55]
    s_waitcnt lgkmcnt(4)
    v_exp_f32 v150, v150
    v_mfma_f32_16x16x32_bf16 v[64:67], a[112:115], v[176:179], v[64:67]
    buffer_store_dwordx4 a[220:223], v245, s[48:51], s77 offen offset:3072 sc1
    ds_read_b128 a[80:83], v212 offset:53248
    v_mfma_f32_16x16x32_bf16 v[68:71], a[112:115], v[180:183], v[68:71]
    v_exp_f32 v151, v151
    v_mfma_f32_16x16x32_bf16 v[80:83], a[116:119], v[176:179], v[80:83]
    ds_read_b128 a[84:87], v213 offset:53248
    v_cvt_pk_bf16_f32 v187, v150, v151
    v_mfma_f32_16x16x32_bf16 v[84:87], a[116:119], v[180:183], v[84:87]
    v_exp_f32 v152, v152
    v_mfma_f32_16x16x32_bf16 v[96:99], a[120:123], v[176:179], v[96:99]
    ds_read_b128 a[88:91], v214 offset:53248
    v_mfma_f32_16x16x32_bf16 v[100:103], a[120:123], v[180:183], v[100:103]
    s_add_u32 s77, s77, 4096
    v_exp_f32 v153, v153
    v_mfma_f32_16x16x32_bf16 v[112:115], a[124:127], v[176:179], v[112:115]
    ds_read_b128 a[92:95], v215 offset:53248
    v_cvt_pk_bf16_f32 v188, v152, v153
    v_mfma_f32_16x16x32_bf16 v[116:119], a[124:127], v[180:183], v[116:119]
    v_exp_f32 v154, v154
    v_smfmac_f32_16x16x64_bf16 v[192:195], v[208:211], v[176:183], v207
    s_waitcnt lgkmcnt(4)
    v_mfma_f32_16x16x32_bf16 v[128:131], a[64:67], a[0:3], v[160:163]
    v_mfma_f32_16x16x32_bf16 v[128:131], a[68:71], a[4:7], v[128:131]
    v_exp_f32 v155, v155
    v_mfma_f32_16x16x32_bf16 v[128:131], a[72:75], a[8:11], v[128:131]
    v_cvt_pk_bf16_f32 v189, v154, v155
    v_mfma_f32_16x16x32_bf16 v[128:131], a[76:79], a[12:15], v[128:131]
    s_waitcnt vmcnt(12) lgkmcnt(0)
    v_exp_f32 v156, v156
    v_mfma_f32_16x16x32_bf16 v[132:135], a[80:83], a[0:3], v[160:163]
    s_barrier
    v_mfma_f32_16x16x32_bf16 v[132:135], a[84:87], a[4:7], v[132:135]
    s_add_u32 m0, s55, 12288
    v_exp_f32 v157, v157
    v_mfma_f32_16x16x32_bf16 v[132:135], a[88:91], a[8:11], v[132:135]
    v_cvt_pk_bf16_f32 v190, v156, v157
    v_mfma_f32_16x16x32_bf16 v[132:135], a[92:95], a[12:15], v[132:135]
    v_exp_f32 v158, v158
    v_mfma_f32_16x16x32_bf16 v[136:139], a[64:67], a[16:19], v[164:167]
    buffer_load_dwordx4 v224, s[40:43], s60 offen lds
    v_mfma_f32_16x16x32_bf16 v[136:139], a[68:71], a[20:23], v[136:139]
    v_exp_f32 v159, v159
    v_mfma_f32_16x16x32_bf16 v[136:139], a[72:75], a[24:27], v[136:139]
    v_cvt_pk_bf16_f32 v191, v158, v159
    v_mfma_f32_16x16x32_bf16 v[136:139], a[76:79], a[28:31], v[136:139]
    v_exp_f32 v128, v128
    v_mfma_f32_16x16x32_bf16 v[140:143], a[80:83], a[16:19], v[164:167]
    buffer_load_dwordx4 v225, s[40:43], s60 offen offset:1024 lds
    v_mfma_f32_16x16x32_bf16 v[140:143], a[84:87], a[20:23], v[140:143]
    v_exp_f32 v129, v129
    v_mfma_f32_16x16x32_bf16 v[140:143], a[88:91], a[24:27], v[140:143]
    v_cvt_pk_bf16_f32 v176, v128, v129
    v_mfma_f32_16x16x32_bf16 v[140:143], a[92:95], a[28:31], v[140:143]
    v_exp_f32 v130, v130
    v_mfma_f32_16x16x32_bf16 v[8:11], a[96:99], v[184:187], v[8:11]
    buffer_load_dwordx4 v226, s[44:47], s60 offen offset:2048 lds
    v_mfma_f32_16x16x32_bf16 v[12:15], a[96:99], v[188:191], v[12:15]
    v_exp_f32 v131, v131
    v_mfma_f32_16x16x32_bf16 v[24:27], a[100:103], v[184:187], v[24:27]
    ds_read_b64_tr_b16 a[96:97], v216 offset:10240
    v_cvt_pk_bf16_f32 v177, v130, v131
    v_mfma_f32_16x16x32_bf16 v[28:31], a[100:103], v[188:191], v[28:31]
    v_exp_f32 v132, v132
    v_mfma_f32_16x16x32_bf16 v[40:43], a[104:107], v[184:187], v[40:43]
    buffer_load_dwordx4 v227, s[44:47], s60 offen offset:3072 lds
    ds_read_b64_tr_b16 a[98:99], v216 offset:59392
    v_mfma_f32_16x16x32_bf16 v[44:47], a[104:107], v[188:191], v[44:47]
    s_add_u32 s60, s60, s61
    v_exp_f32 v133, v133
    v_mfma_f32_16x16x32_bf16 v[56:59], a[108:111], v[184:187], v[56:59]
    ds_read_b64_tr_b16 a[100:101], v217 offset:10240
    v_cvt_pk_bf16_f32 v178, v132, v133
    v_mfma_f32_16x16x32_bf16 v[60:63], a[108:111], v[188:191], v[60:63]
    v_exp_f32 v134, v134
    v_mfma_f32_16x16x32_bf16 v[72:75], a[112:115], v[184:187], v[72:75]
    ds_read_b64_tr_b16 a[102:103], v217 offset:59392
    v_mfma_f32_16x16x32_bf16 v[76:79], a[112:115], v[188:191], v[76:79]
    v_exp_f32 v135, v135
    v_mfma_f32_16x16x32_bf16 v[88:91], a[116:119], v[184:187], v[88:91]
    ds_read_b64_tr_b16 a[104:105], v218 offset:10240
    v_cvt_pk_bf16_f32 v179, v134, v135
    v_mfma_f32_16x16x32_bf16 v[92:95], a[116:119], v[188:191], v[92:95]
    v_exp_f32 v136, v136
    v_mfma_f32_16x16x32_bf16 v[104:107], a[120:123], v[184:187], v[104:107]
    buffer_store_dwordx4 a[224:227], v245, s[48:51], s77 offen offset:0 sc1
    ds_read_b64_tr_b16 a[106:107], v218 offset:59392
    v_mfma_f32_16x16x32_bf16 v[108:111], a[120:123], v[188:191], v[108:111]
    v_exp_f32 v137, v137
    v_mfma_f32_16x16x32_bf16 v[120:123], a[124:127], v[184:187], v[120:123]
    ds_read_b64_tr_b16 a[108:109], v219 offset:10240
    v_cvt_pk_bf16_f32 v180, v136, v137
    v_mfma_f32_16x16x32_bf16 v[124:127], a[124:127], v[188:191], v[124:127]
    v_exp_f32 v138, v138
    v_smfmac_f32_16x16x64_bf16 v[196:199], v[208:211], v[184:191], v207
    ds_read_b64_tr_b16 a[110:111], v219 offset:59392
    v_mfma_f32_16x16x32_bf16 v[144:147], a[64:67], a[32:35], v[168:171]
    ds_read_b64_tr_b16 a[112:113], v220 offset:10240
    v_mfma_f32_16x16x32_bf16 v[144:147], a[68:71], a[36:39], v[144:147]
    v_exp_f32 v139, v139
    v_mfma_f32_16x16x32_bf16 v[144:147], a[72:75], a[40:43], v[144:147]
    ds_read_b64_tr_b16 a[114:115], v220 offset:59392
    v_cvt_pk_bf16_f32 v181, v138, v139
    v_mfma_f32_16x16x32_bf16 v[144:147], a[76:79], a[44:47], v[144:147]
    v_exp_f32 v140, v140
    v_mfma_f32_16x16x32_bf16 v[148:151], a[80:83], a[32:35], v[168:171]
    ds_read_b64_tr_b16 a[116:117], v221 offset:10240
    v_mfma_f32_16x16x32_bf16 v[148:151], a[84:87], a[36:39], v[148:151]
    v_exp_f32 v141, v141
    v_mfma_f32_16x16x32_bf16 v[148:151], a[88:91], a[40:43], v[148:151]
    ds_read_b64_tr_b16 a[118:119], v221 offset:59392
    v_cvt_pk_bf16_f32 v182, v140, v141
    v_mfma_f32_16x16x32_bf16 v[148:151], a[92:95], a[44:47], v[148:151]
    v_exp_f32 v142, v142
    v_mfma_f32_16x16x32_bf16 v[152:155], a[64:67], a[48:51], v[172:175]
    ds_read_b64_tr_b16 a[120:121], v222 offset:10240
    v_mfma_f32_16x16x32_bf16 v[152:155], a[68:71], a[52:55], v[152:155]
    v_exp_f32 v143, v143
    v_mfma_f32_16x16x32_bf16 v[152:155], a[72:75], a[56:59], v[152:155]
    ds_read_b64_tr_b16 a[122:123], v222 offset:59392
    v_cvt_pk_bf16_f32 v183, v142, v143
    v_mfma_f32_16x16x32_bf16 v[152:155], a[76:79], a[60:63], v[152:155]
    v_exp_f32 v144, v144
    v_mfma_f32_16x16x32_bf16 v[156:159], a[80:83], a[48:51], v[172:175]
    ds_read_b64_tr_b16 a[124:125], v223 offset:10240
    v_mfma_f32_16x16x32_bf16 v[156:159], a[84:87], a[52:55], v[156:159]
    v_exp_f32 v145, v145
    v_mfma_f32_16x16x32_bf16 v[156:159], a[88:91], a[56:59], v[156:159]
    ds_read_b64_tr_b16 a[126:127], v223 offset:59392
    v_cvt_pk_bf16_f32 v184, v144, v145
    v_mfma_f32_16x16x32_bf16 v[156:159], a[92:95], a[60:63], v[156:159]
    s_waitcnt lgkmcnt(8)
    v_exp_f32 v146, v146
    v_mfma_f32_16x16x32_bf16 v[0:3], a[96:99], v[176:179], v[0:3]
    ds_read_b128 a[64:67], v212 offset:8192
    v_mfma_f32_16x16x32_bf16 v[4:7], a[96:99], v[180:183], v[4:7]
    v_exp_f32 v147, v147
    v_mfma_f32_16x16x32_bf16 v[16:19], a[100:103], v[176:179], v[16:19]
    ds_read_b128 a[68:71], v213 offset:8192
    v_cvt_pk_bf16_f32 v185, v146, v147
    v_mfma_f32_16x16x32_bf16 v[20:23], a[100:103], v[180:183], v[20:23]
    v_exp_f32 v148, v148
    v_mfma_f32_16x16x32_bf16 v[32:35], a[104:107], v[176:179], v[32:35]
    ds_read_b128 a[72:75], v214 offset:8192
    v_mfma_f32_16x16x32_bf16 v[36:39], a[104:107], v[180:183], v[36:39]
    v_exp_f32 v149, v149
    v_mfma_f32_16x16x32_bf16 v[48:51], a[108:111], v[176:179], v[48:51]
    ds_read_b128 a[76:79], v215 offset:8192
    v_cvt_pk_bf16_f32 v186, v148, v149
    v_mfma_f32_16x16x32_bf16 v[52:55], a[108:111], v[180:183], v[52:55]
    s_waitcnt lgkmcnt(4)
    v_exp_f32 v150, v150
    v_mfma_f32_16x16x32_bf16 v[64:67], a[112:115], v[176:179], v[64:67]
    buffer_store_dwordx4 a[228:231], v245, s[48:51], s77 offen offset:1024 sc1
    ds_read_b128 a[80:83], v212 offset:57344
    v_mfma_f32_16x16x32_bf16 v[68:71], a[112:115], v[180:183], v[68:71]
    v_exp_f32 v151, v151
    v_mfma_f32_16x16x32_bf16 v[80:83], a[116:119], v[176:179], v[80:83]
    ds_read_b128 a[84:87], v213 offset:57344
    v_cvt_pk_bf16_f32 v187, v150, v151
    v_mfma_f32_16x16x32_bf16 v[84:87], a[116:119], v[180:183], v[84:87]
    v_exp_f32 v152, v152
    v_mfma_f32_16x16x32_bf16 v[96:99], a[120:123], v[176:179], v[96:99]
    ds_read_b128 a[88:91], v214 offset:57344
    v_mfma_f32_16x16x32_bf16 v[100:103], a[120:123], v[180:183], v[100:103]
    v_exp_f32 v153, v153
    v_mfma_f32_16x16x32_bf16 v[112:115], a[124:127], v[176:179], v[112:115]
    ds_read_b128 a[92:95], v215 offset:57344
    v_cvt_pk_bf16_f32 v188, v152, v153
    v_mfma_f32_16x16x32_bf16 v[116:119], a[124:127], v[180:183], v[116:119]
    v_exp_f32 v154, v154
    v_smfmac_f32_16x16x64_bf16 v[192:195], v[208:211], v[176:183], v207
    s_waitcnt lgkmcnt(4)
    v_mfma_f32_16x16x32_bf16 v[128:131], a[64:67], a[0:3], v[160:163]
    v_mfma_f32_16x16x32_bf16 v[128:131], a[68:71], a[4:7], v[128:131]
    v_exp_f32 v155, v155
    v_mfma_f32_16x16x32_bf16 v[128:131], a[72:75], a[8:11], v[128:131]
    v_cvt_pk_bf16_f32 v189, v154, v155
    v_mfma_f32_16x16x32_bf16 v[128:131], a[76:79], a[12:15], v[128:131]
    s_waitcnt vmcnt(14) lgkmcnt(0)
    v_exp_f32 v156, v156
    v_mfma_f32_16x16x32_bf16 v[132:135], a[80:83], a[0:3], v[160:163]
    s_barrier
    v_mfma_f32_16x16x32_bf16 v[132:135], a[84:87], a[4:7], v[132:135]
    s_add_u32 m0, s55, 16384
    v_exp_f32 v157, v157
    v_mfma_f32_16x16x32_bf16 v[132:135], a[88:91], a[8:11], v[132:135]
    v_cvt_pk_bf16_f32 v190, v156, v157
    v_mfma_f32_16x16x32_bf16 v[132:135], a[92:95], a[12:15], v[132:135]
    v_exp_f32 v158, v158
    v_mfma_f32_16x16x32_bf16 v[136:139], a[64:67], a[16:19], v[164:167]
    buffer_load_dwordx4 v224, s[40:43], s60 offen lds
    v_mfma_f32_16x16x32_bf16 v[136:139], a[68:71], a[20:23], v[136:139]
    v_exp_f32 v159, v159
    v_mfma_f32_16x16x32_bf16 v[136:139], a[72:75], a[24:27], v[136:139]
    v_cvt_pk_bf16_f32 v191, v158, v159
    v_mfma_f32_16x16x32_bf16 v[136:139], a[76:79], a[28:31], v[136:139]
    v_exp_f32 v128, v128
    v_mfma_f32_16x16x32_bf16 v[140:143], a[80:83], a[16:19], v[164:167]
    buffer_load_dwordx4 v225, s[40:43], s60 offen offset:1024 lds
    v_mfma_f32_16x16x32_bf16 v[140:143], a[84:87], a[20:23], v[140:143]
    v_exp_f32 v129, v129
    v_mfma_f32_16x16x32_bf16 v[140:143], a[88:91], a[24:27], v[140:143]
    v_cvt_pk_bf16_f32 v176, v128, v129
    v_mfma_f32_16x16x32_bf16 v[140:143], a[92:95], a[28:31], v[140:143]
    v_exp_f32 v130, v130
    v_mfma_f32_16x16x32_bf16 v[8:11], a[96:99], v[184:187], v[8:11]
    buffer_load_dwordx4 v226, s[44:47], s60 offen offset:2048 lds
    v_mfma_f32_16x16x32_bf16 v[12:15], a[96:99], v[188:191], v[12:15]
    v_exp_f32 v131, v131
    v_mfma_f32_16x16x32_bf16 v[24:27], a[100:103], v[184:187], v[24:27]
    ds_read_b64_tr_b16 a[96:97], v216 offset:14336
    v_cvt_pk_bf16_f32 v177, v130, v131
    v_mfma_f32_16x16x32_bf16 v[28:31], a[100:103], v[188:191], v[28:31]
    v_exp_f32 v132, v132
    v_mfma_f32_16x16x32_bf16 v[40:43], a[104:107], v[184:187], v[40:43]
    buffer_load_dwordx4 v227, s[44:47], s60 offen offset:3072 lds
    ds_read_b64_tr_b16 a[98:99], v216 offset:63488
    v_mfma_f32_16x16x32_bf16 v[44:47], a[104:107], v[188:191], v[44:47]
    s_add_u32 s60, s60, s61
    v_exp_f32 v133, v133
    v_mfma_f32_16x16x32_bf16 v[56:59], a[108:111], v[184:187], v[56:59]
    ds_read_b64_tr_b16 a[100:101], v217 offset:14336
    v_cvt_pk_bf16_f32 v178, v132, v133
    v_mfma_f32_16x16x32_bf16 v[60:63], a[108:111], v[188:191], v[60:63]
    v_exp_f32 v134, v134
    v_mfma_f32_16x16x32_bf16 v[72:75], a[112:115], v[184:187], v[72:75]
    ds_read_b64_tr_b16 a[102:103], v217 offset:63488
    v_mfma_f32_16x16x32_bf16 v[76:79], a[112:115], v[188:191], v[76:79]
    v_exp_f32 v135, v135
    v_mfma_f32_16x16x32_bf16 v[88:91], a[116:119], v[184:187], v[88:91]
    ds_read_b64_tr_b16 a[104:105], v218 offset:14336
    v_cvt_pk_bf16_f32 v179, v134, v135
    v_mfma_f32_16x16x32_bf16 v[92:95], a[116:119], v[188:191], v[92:95]
    v_exp_f32 v136, v136
    v_mfma_f32_16x16x32_bf16 v[104:107], a[120:123], v[184:187], v[104:107]
    buffer_store_dwordx4 a[232:235], v245, s[48:51], s77 offen offset:2048 sc1
    ds_read_b64_tr_b16 a[106:107], v218 offset:63488
    v_mfma_f32_16x16x32_bf16 v[108:111], a[120:123], v[188:191], v[108:111]
    v_exp_f32 v137, v137
    v_mfma_f32_16x16x32_bf16 v[120:123], a[124:127], v[184:187], v[120:123]
    ds_read_b64_tr_b16 a[108:109], v219 offset:14336
    v_cvt_pk_bf16_f32 v180, v136, v137
    v_mfma_f32_16x16x32_bf16 v[124:127], a[124:127], v[188:191], v[124:127]
    v_exp_f32 v138, v138
    v_smfmac_f32_16x16x64_bf16 v[196:199], v[208:211], v[184:191], v207
    ds_read_b64_tr_b16 a[110:111], v219 offset:63488
    v_mfma_f32_16x16x32_bf16 v[144:147], a[64:67], a[32:35], v[168:171]
    ds_read_b64_tr_b16 a[112:113], v220 offset:14336
    v_mfma_f32_16x16x32_bf16 v[144:147], a[68:71], a[36:39], v[144:147]
    v_exp_f32 v139, v139
    v_mfma_f32_16x16x32_bf16 v[144:147], a[72:75], a[40:43], v[144:147]
    ds_read_b64_tr_b16 a[114:115], v220 offset:63488
    v_cvt_pk_bf16_f32 v181, v138, v139
    v_mfma_f32_16x16x32_bf16 v[144:147], a[76:79], a[44:47], v[144:147]
    v_exp_f32 v140, v140
    v_mfma_f32_16x16x32_bf16 v[148:151], a[80:83], a[32:35], v[168:171]
    ds_read_b64_tr_b16 a[116:117], v221 offset:14336
    v_mfma_f32_16x16x32_bf16 v[148:151], a[84:87], a[36:39], v[148:151]
    v_exp_f32 v141, v141
    v_mfma_f32_16x16x32_bf16 v[148:151], a[88:91], a[40:43], v[148:151]
    ds_read_b64_tr_b16 a[118:119], v221 offset:63488
    v_cvt_pk_bf16_f32 v182, v140, v141
    v_mfma_f32_16x16x32_bf16 v[148:151], a[92:95], a[44:47], v[148:151]
    v_exp_f32 v142, v142
    v_mfma_f32_16x16x32_bf16 v[152:155], a[64:67], a[48:51], v[172:175]
    ds_read_b64_tr_b16 a[120:121], v222 offset:14336
    v_mfma_f32_16x16x32_bf16 v[152:155], a[68:71], a[52:55], v[152:155]
    v_exp_f32 v143, v143
    v_mfma_f32_16x16x32_bf16 v[152:155], a[72:75], a[56:59], v[152:155]
    ds_read_b64_tr_b16 a[122:123], v222 offset:63488
    v_cvt_pk_bf16_f32 v183, v142, v143
    v_mfma_f32_16x16x32_bf16 v[152:155], a[76:79], a[60:63], v[152:155]
    v_exp_f32 v144, v144
    v_mfma_f32_16x16x32_bf16 v[156:159], a[80:83], a[48:51], v[172:175]
    ds_read_b64_tr_b16 a[124:125], v223 offset:14336
    v_mfma_f32_16x16x32_bf16 v[156:159], a[84:87], a[52:55], v[156:159]
    v_exp_f32 v145, v145
    v_mfma_f32_16x16x32_bf16 v[156:159], a[88:91], a[56:59], v[156:159]
    ds_read_b64_tr_b16 a[126:127], v223 offset:63488
    v_cvt_pk_bf16_f32 v184, v144, v145
    v_mfma_f32_16x16x32_bf16 v[156:159], a[92:95], a[60:63], v[156:159]
    s_waitcnt lgkmcnt(8)
    v_exp_f32 v146, v146
    v_mfma_f32_16x16x32_bf16 v[0:3], a[96:99], v[176:179], v[0:3]
    ds_read_b128 a[64:67], v212 offset:12288
    v_mfma_f32_16x16x32_bf16 v[4:7], a[96:99], v[180:183], v[4:7]
    v_exp_f32 v147, v147
    v_mfma_f32_16x16x32_bf16 v[16:19], a[100:103], v[176:179], v[16:19]
    ds_read_b128 a[68:71], v213 offset:12288
    v_cvt_pk_bf16_f32 v185, v146, v147
    v_mfma_f32_16x16x32_bf16 v[20:23], a[100:103], v[180:183], v[20:23]
    v_exp_f32 v148, v148
    v_mfma_f32_16x16x32_bf16 v[32:35], a[104:107], v[176:179], v[32:35]
    ds_read_b128 a[72:75], v214 offset:12288
    v_mfma_f32_16x16x32_bf16 v[36:39], a[104:107], v[180:183], v[36:39]
    v_exp_f32 v149, v149
    v_mfma_f32_16x16x32_bf16 v[48:51], a[108:111], v[176:179], v[48:51]
    ds_read_b128 a[76:79], v215 offset:12288
    v_cvt_pk_bf16_f32 v186, v148, v149
    v_mfma_f32_16x16x32_bf16 v[52:55], a[108:111], v[180:183], v[52:55]
    s_waitcnt lgkmcnt(4)
    v_exp_f32 v150, v150
    v_mfma_f32_16x16x32_bf16 v[64:67], a[112:115], v[176:179], v[64:67]
    buffer_store_dwordx4 a[236:239], v245, s[48:51], s77 offen offset:3072 sc1
    ds_read_b128 a[80:83], v212 offset:61440
    v_mfma_f32_16x16x32_bf16 v[68:71], a[112:115], v[180:183], v[68:71]
    v_exp_f32 v151, v151
    v_mfma_f32_16x16x32_bf16 v[80:83], a[116:119], v[176:179], v[80:83]
    ds_read_b128 a[84:87], v213 offset:61440
    v_cvt_pk_bf16_f32 v187, v150, v151
    v_mfma_f32_16x16x32_bf16 v[84:87], a[116:119], v[180:183], v[84:87]
    v_exp_f32 v152, v152
    v_mfma_f32_16x16x32_bf16 v[96:99], a[120:123], v[176:179], v[96:99]
    ds_read_b128 a[88:91], v214 offset:61440
    v_mfma_f32_16x16x32_bf16 v[100:103], a[120:123], v[180:183], v[100:103]
    v_exp_f32 v153, v153
    v_mfma_f32_16x16x32_bf16 v[112:115], a[124:127], v[176:179], v[112:115]
    ds_read_b128 a[92:95], v215 offset:61440
    v_cvt_pk_bf16_f32 v188, v152, v153
    v_mfma_f32_16x16x32_bf16 v[116:119], a[124:127], v[180:183], v[116:119]
    v_exp_f32 v154, v154
    v_smfmac_f32_16x16x64_bf16 v[192:195], v[208:211], v[176:183], v207
    s_waitcnt lgkmcnt(4)
    s_branch L_ENTRY
.p2align 6
L_ATT:
    v_mfma_f32_16x16x32_bf16 v[128:131], a[64:67], a[0:3], v[160:163]
    v_mfma_f32_16x16x32_bf16 v[128:131], a[68:71], a[4:7], v[128:131]
    v_exp_f32 v155, v155
    v_mfma_f32_16x16x32_bf16 v[128:131], a[72:75], a[8:11], v[128:131]
    v_cvt_pk_bf16_f32 v189, v154, v155
    v_mfma_f32_16x16x32_bf16 v[128:131], a[76:79], a[12:15], v[128:131]
    s_waitcnt vmcnt(8) lgkmcnt(0)
    v_exp_f32 v156, v156
    v_mfma_f32_16x16x32_bf16 v[132:135], a[80:83], a[0:3], v[160:163]
    s_barrier
    v_mfma_f32_16x16x32_bf16 v[132:135], a[84:87], a[4:7], v[132:135]
    s_add_u32 m0, s55, 8192
    v_exp_f32 v157, v157
    v_mfma_f32_16x16x32_bf16 v[132:135], a[88:91], a[8:11], v[132:135]
    v_cvt_pk_bf16_f32 v190, v156, v157
    v_mfma_f32_16x16x32_bf16 v[132:135], a[92:95], a[12:15], v[132:135]
    v_exp_f32 v158, v158
    v_mfma_f32_16x16x32_bf16 v[136:139], a[64:67], a[16:19], v[164:167]
    buffer_load_dwordx4 v224, s[40:43], s60 offen lds
    v_mfma_f32_16x16x32_bf16 v[136:139], a[68:71], a[20:23], v[136:139]
    v_exp_f32 v159, v159
    v_mfma_f32_16x16x32_bf16 v[136:139], a[72:75], a[24:27], v[136:139]
    v_cvt_pk_bf16_f32 v191, v158, v159
    v_mfma_f32_16x16x32_bf16 v[136:139], a[76:79], a[28:31], v[136:139]
    v_exp_f32 v128, v128
    v_mfma_f32_16x16x32_bf16 v[140:143], a[80:83], a[16:19], v[164:167]
    buffer_load_dwordx4 v225, s[40:43], s60 offen offset:1024 lds
    v_mfma_f32_16x16x32_bf16 v[140:143], a[84:87], a[20:23], v[140:143]
    v_exp_f32 v129, v129
    v_mfma_f32_16x16x32_bf16 v[140:143], a[88:91], a[24:27], v[140:143]
    v_cvt_pk_bf16_f32 v176, v128, v129
    v_mfma_f32_16x16x32_bf16 v[140:143], a[92:95], a[28:31], v[140:143]
    v_exp_f32 v130, v130
    v_mfma_f32_16x16x32_bf16 v[8:11], a[96:99], v[184:187], v[8:11]
    buffer_load_dwordx4 v226, s[44:47], s60 offen offset:2048 lds
    v_mfma_f32_16x16x32_bf16 v[12:15], a[96:99], v[188:191], v[12:15]
    v_exp_f32 v131, v131
    v_mfma_f32_16x16x32_bf16 v[24:27], a[100:103], v[184:187], v[24:27]
    ds_read_b64_tr_b16 a[96:97], v216 offset:6144
    v_cvt_pk_bf16_f32 v177, v130, v131
    v_mfma_f32_16x16x32_bf16 v[28:31], a[100:103], v[188:191], v[28:31]
    v_exp_f32 v132, v132
    v_mfma_f32_16x16x32_bf16 v[40:43], a[104:107], v[184:187], v[40:43]
    buffer_load_dwordx4 v227, s[44:47], s60 offen offset:3072 lds
    ds_read_b64_tr_b16 a[98:99], v216 offset:55296
    v_mfma_f32_16x16x32_bf16 v[44:47], a[104:107], v[188:191], v[44:47]
    s_add_u32 s60, s60, s61
    v_exp_f32 v133, v133
    v_mfma_f32_16x16x32_bf16 v[56:59], a[108:111], v[184:187], v[56:59]
    ds_read_b64_tr_b16 a[100:101], v217 offset:6144
    v_cvt_pk_bf16_f32 v178, v132, v133
    v_mfma_f32_16x16x32_bf16 v[60:63], a[108:111], v[188:191], v[60:63]
    v_exp_f32 v134, v134
    v_mfma_f32_16x16x32_bf16 v[72:75], a[112:115], v[184:187], v[72:75]
    ds_read_b64_tr_b16 a[102:103], v217 offset:55296
    v_mfma_f32_16x16x32_bf16 v[76:79], a[112:115], v[188:191], v[76:79]
    v_exp_f32 v135, v135
    v_mfma_f32_16x16x32_bf16 v[88:91], a[116:119], v[184:187], v[88:91]
    ds_read_b64_tr_b16 a[104:105], v218 offset:6144
    v_cvt_pk_bf16_f32 v179, v134, v135
    v_mfma_f32_16x16x32_bf16 v[92:95], a[116:119], v[188:191], v[92:95]
    v_exp_f32 v136, v136
    v_mfma_f32_16x16x32_bf16 v[104:107], a[120:123], v[184:187], v[104:107]
    ds_read_b64_tr_b16 a[106:107], v218 offset:55296
    v_mfma_f32_16x16x32_bf16 v[108:111], a[120:123], v[188:191], v[108:111]
    v_exp_f32 v137, v137
    v_mfma_f32_16x16x32_bf16 v[120:123], a[124:127], v[184:187], v[120:123]
    ds_read_b64_tr_b16 a[108:109], v219 offset:6144
    v_cvt_pk_bf16_f32 v180, v136, v137
    v_mfma_f32_16x16x32_bf16 v[124:127], a[124:127], v[188:191], v[124:127]
    v_exp_f32 v138, v138
    v_smfmac_f32_16x16x64_bf16 v[196:199], v[208:211], v[184:191], v207
    ds_read_b64_tr_b16 a[110:111], v219 offset:55296
    v_mfma_f32_16x16x32_bf16 v[144:147], a[64:67], a[32:35], v[168:171]
    ds_read_b64_tr_b16 a[112:113], v220 offset:6144
    v_mfma_f32_16x16x32_bf16 v[144:147], a[68:71], a[36:39], v[144:147]
    v_exp_f32 v139, v139
    v_mfma_f32_16x16x32_bf16 v[144:147], a[72:75], a[40:43], v[144:147]
    ds_read_b64_tr_b16 a[114:115], v220 offset:55296
    v_cvt_pk_bf16_f32 v181, v138, v139
    v_mfma_f32_16x16x32_bf16 v[144:147], a[76:79], a[44:47], v[144:147]
    v_exp_f32 v140, v140
    v_mfma_f32_16x16x32_bf16 v[148:151], a[80:83], a[32:35], v[168:171]
    ds_read_b64_tr_b16 a[116:117], v221 offset:6144
    v_mfma_f32_16x16x32_bf16 v[148:151], a[84:87], a[36:39], v[148:151]
    v_exp_f32 v141, v141
    v_mfma_f32_16x16x32_bf16 v[148:151], a[88:91], a[40:43], v[148:151]
    ds_read_b64_tr_b16 a[118:119], v221 offset:55296
    v_cvt_pk_bf16_f32 v182, v140, v141
    v_mfma_f32_16x16x32_bf16 v[148:151], a[92:95], a[44:47], v[148:151]
    v_exp_f32 v142, v142
    v_mfma_f32_16x16x32_bf16 v[152:155], a[64:67], a[48:51], v[172:175]
    ds_read_b64_tr_b16 a[120:121], v222 offset:6144
    v_mfma_f32_16x16x32_bf16 v[152:155], a[68:71], a[52:55], v[152:155]
    v_exp_f32 v143, v143
    v_mfma_f32_16x16x32_bf16 v[152:155], a[72:75], a[56:59], v[152:155]
    ds_read_b64_tr_b16 a[122:123], v222 offset:55296
    v_cvt_pk_bf16_f32 v183, v142, v143
    v_mfma_f32_16x16x32_bf16 v[152:155], a[76:79], a[60:63], v[152:155]
    v_exp_f32 v144, v144
    v_mfma_f32_16x16x32_bf16 v[156:159], a[80:83], a[48:51], v[172:175]
    ds_read_b64_tr_b16 a[124:125], v223 offset:6144
    v_mfma_f32_16x16x32_bf16 v[156:159], a[84:87], a[52:55], v[156:159]
    v_exp_f32 v145, v145
    v_mfma_f32_16x16x32_bf16 v[156:159], a[88:91], a[56:59], v[156:159]
    ds_read_b64_tr_b16 a[126:127], v223 offset:55296
    v_cvt_pk_bf16_f32 v184, v144, v145
    v_mfma_f32_16x16x32_bf16 v[156:159], a[92:95], a[60:63], v[156:159]
    s_waitcnt lgkmcnt(8)
    v_exp_f32 v146, v146
    v_mfma_f32_16x16x32_bf16 v[0:3], a[96:99], v[176:179], v[0:3]
    ds_read_b128 a[64:67], v212 offset:4096
    v_mfma_f32_16x16x32_bf16 v[4:7], a[96:99], v[180:183], v[4:7]
    v_exp_f32 v147, v147
    v_mfma_f32_16x16x32_bf16 v[16:19], a[100:103], v[176:179], v[16:19]
    ds_read_b128 a[68:71], v213 offset:4096
    v_cvt_pk_bf16_f32 v185, v146, v147
    v_mfma_f32_16x16x32_bf16 v[20:23], a[100:103], v[180:183], v[20:23]
    v_exp_f32 v148, v148
    v_mfma_f32_16x16x32_bf16 v[32:35], a[104:107], v[176:179], v[32:35]
    ds_read_b128 a[72:75], v214 offset:4096
    v_mfma_f32_16x16x32_bf16 v[36:39], a[104:107], v[180:183], v[36:39]
    v_exp_f32 v149, v149
    v_mfma_f32_16x16x32_bf16 v[48:51], a[108:111], v[176:179], v[48:51]
    ds_read_b128 a[76:79], v215 offset:4096
    v_cvt_pk_bf16_f32 v186, v148, v149
    v_mfma_f32_16x16x32_bf16 v[52:55], a[108:111], v[180:183], v[52:55]
    s_waitcnt lgkmcnt(4)
    v_exp_f32 v150, v150
    v_mfma_f32_16x16x32_bf16 v[64:67], a[112:115], v[176:179], v[64:67]
    ds_read_b128 a[80:83], v212 offset:53248
    v_mfma_f32_16x16x32_bf16 v[68:71], a[112:115], v[180:183], v[68:71]
    v_exp_f32 v151, v151
    v_mfma_f32_16x16x32_bf16 v[80:83], a[116:119], v[176:179], v[80:83]
    ds_read_b128 a[84:87], v213 offset:53248
    v_cvt_pk_bf16_f32 v187, v150, v151
    v_mfma_f32_16x16x32_bf16 v[84:87], a[116:119], v[180:183], v[84:87]
    v_exp_f32 v152, v152
    v_mfma_f32_16x16x32_bf16 v[96:99], a[120:123], v[176:179], v[96:99]
    ds_read_b128 a[88:91], v214 offset:53248
    v_mfma_f32_16x16x32_bf16 v[100:103], a[120:123], v[180:183], v[100:103]
    v_exp_f32 v153, v153
    v_mfma_f32_16x16x32_bf16 v[112:115], a[124:127], v[176:179], v[112:115]
    ds_read_b128 a[92:95], v215 offset:53248
    v_cvt_pk_bf16_f32 v188, v152, v153
    v_mfma_f32_16x16x32_bf16 v[116:119], a[124:127], v[180:183], v[116:119]
    v_exp_f32 v154, v154
    v_smfmac_f32_16x16x64_bf16 v[192:195], v[208:211], v[176:183], v207
    s_waitcnt lgkmcnt(4)
    v_mfma_f32_16x16x32_bf16 v[128:131], a[64:67], a[0:3], v[160:163]
    v_mfma_f32_16x16x32_bf16 v[128:131], a[68:71], a[4:7], v[128:131]
    v_exp_f32 v155, v155
    v_mfma_f32_16x16x32_bf16 v[128:131], a[72:75], a[8:11], v[128:131]
    v_cvt_pk_bf16_f32 v189, v154, v155
    v_mfma_f32_16x16x32_bf16 v[128:131], a[76:79], a[12:15], v[128:131]
    s_waitcnt vmcnt(8) lgkmcnt(0)
    v_exp_f32 v156, v156
    v_mfma_f32_16x16x32_bf16 v[132:135], a[80:83], a[0:3], v[160:163]
    s_barrier
    v_mfma_f32_16x16x32_bf16 v[132:135], a[84:87], a[4:7], v[132:135]
    s_add_u32 m0, s55, 12288
    v_exp_f32 v157, v157
    v_mfma_f32_16x16x32_bf16 v[132:135], a[88:91], a[8:11], v[132:135]
    v_cvt_pk_bf16_f32 v190, v156, v157
    v_mfma_f32_16x16x32_bf16 v[132:135], a[92:95], a[12:15], v[132:135]
    v_exp_f32 v158, v158
    v_mfma_f32_16x16x32_bf16 v[136:139], a[64:67], a[16:19], v[164:167]
    buffer_load_dwordx4 v224, s[40:43], s60 offen lds
    v_mfma_f32_16x16x32_bf16 v[136:139], a[68:71], a[20:23], v[136:139]
    v_exp_f32 v159, v159
    v_mfma_f32_16x16x32_bf16 v[136:139], a[72:75], a[24:27], v[136:139]
    v_cvt_pk_bf16_f32 v191, v158, v159
    v_mfma_f32_16x16x32_bf16 v[136:139], a[76:79], a[28:31], v[136:139]
    v_exp_f32 v128, v128
    v_mfma_f32_16x16x32_bf16 v[140:143], a[80:83], a[16:19], v[164:167]
    buffer_load_dwordx4 v225, s[40:43], s60 offen offset:1024 lds
    v_mfma_f32_16x16x32_bf16 v[140:143], a[84:87], a[20:23], v[140:143]
    v_exp_f32 v129, v129
    v_mfma_f32_16x16x32_bf16 v[140:143], a[88:91], a[24:27], v[140:143]
    v_cvt_pk_bf16_f32 v176, v128, v129
    v_mfma_f32_16x16x32_bf16 v[140:143], a[92:95], a[28:31], v[140:143]
    v_exp_f32 v130, v130
    v_mfma_f32_16x16x32_bf16 v[8:11], a[96:99], v[184:187], v[8:11]
    buffer_load_dwordx4 v226, s[44:47], s60 offen offset:2048 lds
    v_mfma_f32_16x16x32_bf16 v[12:15], a[96:99], v[188:191], v[12:15]
    v_exp_f32 v131, v131
    v_mfma_f32_16x16x32_bf16 v[24:27], a[100:103], v[184:187], v[24:27]
    ds_read_b64_tr_b16 a[96:97], v216 offset:10240
    v_cvt_pk_bf16_f32 v177, v130, v131
    v_mfma_f32_16x16x32_bf16 v[28:31], a[100:103], v[188:191], v[28:31]
    v_exp_f32 v132, v132
    v_mfma_f32_16x16x32_bf16 v[40:43], a[104:107], v[184:187], v[40:43]
    buffer_load_dwordx4 v227, s[44:47], s60 offen offset:3072 lds
    ds_read_b64_tr_b16 a[98:99], v216 offset:59392
    v_mfma_f32_16x16x32_bf16 v[44:47], a[104:107], v[188:191], v[44:47]
    s_add_u32 s60, s60, s61
    v_exp_f32 v133, v133
    v_mfma_f32_16x16x32_bf16 v[56:59], a[108:111], v[184:187], v[56:59]
    ds_read_b64_tr_b16 a[100:101], v217 offset:10240
    v_cvt_pk_bf16_f32 v178, v132, v133
    v_mfma_f32_16x16x32_bf16 v[60:63], a[108:111], v[188:191], v[60:63]
    v_exp_f32 v134, v134
    v_mfma_f32_16x16x32_bf16 v[72:75], a[112:115], v[184:187], v[72:75]
    ds_read_b64_tr_b16 a[102:103], v217 offset:59392
    v_mfma_f32_16x16x32_bf16 v[76:79], a[112:115], v[188:191], v[76:79]
    v_exp_f32 v135, v135
    v_mfma_f32_16x16x32_bf16 v[88:91], a[116:119], v[184:187], v[88:91]
    ds_read_b64_tr_b16 a[104:105], v218 offset:10240
    v_cvt_pk_bf16_f32 v179, v134, v135
    v_mfma_f32_16x16x32_bf16 v[92:95], a[116:119], v[188:191], v[92:95]
    v_exp_f32 v136, v136
    v_mfma_f32_16x16x32_bf16 v[104:107], a[120:123], v[184:187], v[104:107]
    ds_read_b64_tr_b16 a[106:107], v218 offset:59392
    v_mfma_f32_16x16x32_bf16 v[108:111], a[120:123], v[188:191], v[108:111]
    v_exp_f32 v137, v137
    v_mfma_f32_16x16x32_bf16 v[120:123], a[124:127], v[184:187], v[120:123]
    ds_read_b64_tr_b16 a[108:109], v219 offset:10240
    v_cvt_pk_bf16_f32 v180, v136, v137
    v_mfma_f32_16x16x32_bf16 v[124:127], a[124:127], v[188:191], v[124:127]
    v_exp_f32 v138, v138
    v_smfmac_f32_16x16x64_bf16 v[196:199], v[208:211], v[184:191], v207
    ds_read_b64_tr_b16 a[110:111], v219 offset:59392
    v_mfma_f32_16x16x32_bf16 v[144:147], a[64:67], a[32:35], v[168:171]
    ds_read_b64_tr_b16 a[112:113], v220 offset:10240
    v_mfma_f32_16x16x32_bf16 v[144:147], a[68:71], a[36:39], v[144:147]
    v_exp_f32 v139, v139
    v_mfma_f32_16x16x32_bf16 v[144:147], a[72:75], a[40:43], v[144:147]
    ds_read_b64_tr_b16 a[114:115], v220 offset:59392
    v_cvt_pk_bf16_f32 v181, v138, v139
    v_mfma_f32_16x16x32_bf16 v[144:147], a[76:79], a[44:47], v[144:147]
    v_exp_f32 v140, v140
    v_mfma_f32_16x16x32_bf16 v[148:151], a[80:83], a[32:35], v[168:171]
    ds_read_b64_tr_b16 a[116:117], v221 offset:10240
    v_mfma_f32_16x16x32_bf16 v[148:151], a[84:87], a[36:39], v[148:151]
    v_exp_f32 v141, v141
    v_mfma_f32_16x16x32_bf16 v[148:151], a[88:91], a[40:43], v[148:151]
    ds_read_b64_tr_b16 a[118:119], v221 offset:59392
    v_cvt_pk_bf16_f32 v182, v140, v141
    v_mfma_f32_16x16x32_bf16 v[148:151], a[92:95], a[44:47], v[148:151]
    v_exp_f32 v142, v142
    v_mfma_f32_16x16x32_bf16 v[152:155], a[64:67], a[48:51], v[172:175]
    ds_read_b64_tr_b16 a[120:121], v222 offset:10240
    v_mfma_f32_16x16x32_bf16 v[152:155], a[68:71], a[52:55], v[152:155]
    v_exp_f32 v143, v143
    v_mfma_f32_16x16x32_bf16 v[152:155], a[72:75], a[56:59], v[152:155]
    ds_read_b64_tr_b16 a[122:123], v222 offset:59392
    v_cvt_pk_bf16_f32 v183, v142, v143
    v_mfma_f32_16x16x32_bf16 v[152:155], a[76:79], a[60:63], v[152:155]
    v_exp_f32 v144, v144
    v_mfma_f32_16x16x32_bf16 v[156:159], a[80:83], a[48:51], v[172:175]
    ds_read_b64_tr_b16 a[124:125], v223 offset:10240
    v_mfma_f32_16x16x32_bf16 v[156:159], a[84:87], a[52:55], v[156:159]
    v_exp_f32 v145, v145
    v_mfma_f32_16x16x32_bf16 v[156:159], a[88:91], a[56:59], v[156:159]
    ds_read_b64_tr_b16 a[126:127], v223 offset:59392
    v_cvt_pk_bf16_f32 v184, v144, v145
    v_mfma_f32_16x16x32_bf16 v[156:159], a[92:95], a[60:63], v[156:159]
    s_waitcnt lgkmcnt(8)
    v_exp_f32 v146, v146
    v_mfma_f32_16x16x32_bf16 v[0:3], a[96:99], v[176:179], v[0:3]
    ds_read_b128 a[64:67], v212 offset:8192
    v_mfma_f32_16x16x32_bf16 v[4:7], a[96:99], v[180:183], v[4:7]
    v_exp_f32 v147, v147
    v_mfma_f32_16x16x32_bf16 v[16:19], a[100:103], v[176:179], v[16:19]
    ds_read_b128 a[68:71], v213 offset:8192
    v_cvt_pk_bf16_f32 v185, v146, v147
    v_mfma_f32_16x16x32_bf16 v[20:23], a[100:103], v[180:183], v[20:23]
    v_exp_f32 v148, v148
    v_mfma_f32_16x16x32_bf16 v[32:35], a[104:107], v[176:179], v[32:35]
    ds_read_b128 a[72:75], v214 offset:8192
    v_mfma_f32_16x16x32_bf16 v[36:39], a[104:107], v[180:183], v[36:39]
    v_exp_f32 v149, v149
    v_mfma_f32_16x16x32_bf16 v[48:51], a[108:111], v[176:179], v[48:51]
    ds_read_b128 a[76:79], v215 offset:8192
    v_cvt_pk_bf16_f32 v186, v148, v149
    v_mfma_f32_16x16x32_bf16 v[52:55], a[108:111], v[180:183], v[52:55]
    s_waitcnt lgkmcnt(4)
    v_exp_f32 v150, v150
    v_mfma_f32_16x16x32_bf16 v[64:67], a[112:115], v[176:179], v[64:67]
    ds_read_b128 a[80:83], v212 offset:57344
    v_mfma_f32_16x16x32_bf16 v[68:71], a[112:115], v[180:183], v[68:71]
    v_exp_f32 v151, v151
    v_mfma_f32_16x16x32_bf16 v[80:83], a[116:119], v[176:179], v[80:83]
    ds_read_b128 a[84:87], v213 offset:57344
    v_cvt_pk_bf16_f32 v187, v150, v151
    v_mfma_f32_16x16x32_bf16 v[84:87], a[116:119], v[180:183], v[84:87]
    v_exp_f32 v152, v152
    v_mfma_f32_16x16x32_bf16 v[96:99], a[120:123], v[176:179], v[96:99]
    ds_read_b128 a[88:91], v214 offset:57344
    v_mfma_f32_16x16x32_bf16 v[100:103], a[120:123], v[180:183], v[100:103]
    v_exp_f32 v153, v153
    v_mfma_f32_16x16x32_bf16 v[112:115], a[124:127], v[176:179], v[112:115]
    ds_read_b128 a[92:95], v215 offset:57344
    v_cvt_pk_bf16_f32 v188, v152, v153
    v_mfma_f32_16x16x32_bf16 v[116:119], a[124:127], v[180:183], v[116:119]
    v_exp_f32 v154, v154
    v_smfmac_f32_16x16x64_bf16 v[192:195], v[208:211], v[176:183], v207
    s_waitcnt lgkmcnt(4)
    v_mfma_f32_16x16x32_bf16 v[128:131], a[64:67], a[0:3], v[160:163]
    v_mfma_f32_16x16x32_bf16 v[128:131], a[68:71], a[4:7], v[128:131]
    v_exp_f32 v155, v155
    v_mfma_f32_16x16x32_bf16 v[128:131], a[72:75], a[8:11], v[128:131]
    v_cvt_pk_bf16_f32 v189, v154, v155
    v_mfma_f32_16x16x32_bf16 v[128:131], a[76:79], a[12:15], v[128:131]
    s_waitcnt vmcnt(8) lgkmcnt(0)
    v_exp_f32 v156, v156
    v_mfma_f32_16x16x32_bf16 v[132:135], a[80:83], a[0:3], v[160:163]
    s_barrier
    v_mfma_f32_16x16x32_bf16 v[132:135], a[84:87], a[4:7], v[132:135]
    s_add_u32 m0, s55, 16384
    v_exp_f32 v157, v157
    v_mfma_f32_16x16x32_bf16 v[132:135], a[88:91], a[8:11], v[132:135]
    v_cvt_pk_bf16_f32 v190, v156, v157
    v_mfma_f32_16x16x32_bf16 v[132:135], a[92:95], a[12:15], v[132:135]
    v_exp_f32 v158, v158
    v_mfma_f32_16x16x32_bf16 v[136:139], a[64:67], a[16:19], v[164:167]
    buffer_load_dwordx4 v224, s[40:43], s60 offen lds
    v_mfma_f32_16x16x32_bf16 v[136:139], a[68:71], a[20:23], v[136:139]
    v_exp_f32 v159, v159
    v_mfma_f32_16x16x32_bf16 v[136:139], a[72:75], a[24:27], v[136:139]
    v_cvt_pk_bf16_f32 v191, v158, v159
    v_mfma_f32_16x16x32_bf16 v[136:139], a[76:79], a[28:31], v[136:139]
    v_exp_f32 v128, v128
    v_mfma_f32_16x16x32_bf16 v[140:143], a[80:83], a[16:19], v[164:167]
    buffer_load_dwordx4 v225, s[40:43], s60 offen offset:1024 lds
    v_mfma_f32_16x16x32_bf16 v[140:143], a[84:87], a[20:23], v[140:143]
    v_exp_f32 v129, v129
    v_mfma_f32_16x16x32_bf16 v[140:143], a[88:91], a[24:27], v[140:143]
    v_cvt_pk_bf16_f32 v176, v128, v129
    v_mfma_f32_16x16x32_bf16 v[140:143], a[92:95], a[28:31], v[140:143]
    v_exp_f32 v130, v130
    v_mfma_f32_16x16x32_bf16 v[8:11], a[96:99], v[184:187], v[8:11]
    buffer_load_dwordx4 v226, s[44:47], s60 offen offset:2048 lds
    v_mfma_f32_16x16x32_bf16 v[12:15], a[96:99], v[188:191], v[12:15]
    v_exp_f32 v131, v131
    v_mfma_f32_16x16x32_bf16 v[24:27], a[100:103], v[184:187], v[24:27]
    ds_read_b64_tr_b16 a[96:97], v216 offset:14336
    v_cvt_pk_bf16_f32 v177, v130, v131
    v_mfma_f32_16x16x32_bf16 v[28:31], a[100:103], v[188:191], v[28:31]
    v_exp_f32 v132, v132
    v_mfma_f32_16x16x32_bf16 v[40:43], a[104:107], v[184:187], v[40:43]
    buffer_load_dwordx4 v227, s[44:47], s60 offen offset:3072 lds
    ds_read_b64_tr_b16 a[98:99], v216 offset:63488
    v_mfma_f32_16x16x32_bf16 v[44:47], a[104:107], v[188:191], v[44:47]
    s_add_u32 s60, s60, s61
    v_exp_f32 v133, v133
    v_mfma_f32_16x16x32_bf16 v[56:59], a[108:111], v[184:187], v[56:59]
    ds_read_b64_tr_b16 a[100:101], v217 offset:14336
    v_cvt_pk_bf16_f32 v178, v132, v133
    v_mfma_f32_16x16x32_bf16 v[60:63], a[108:111], v[188:191], v[60:63]
    v_exp_f32 v134, v134
    v_mfma_f32_16x16x32_bf16 v[72:75], a[112:115], v[184:187], v[72:75]
    ds_read_b64_tr_b16 a[102:103], v217 offset:63488
    v_mfma_f32_16x16x32_bf16 v[76:79], a[112:115], v[188:191], v[76:79]
    v_exp_f32 v135, v135
    v_mfma_f32_16x16x32_bf16 v[88:91], a[116:119], v[184:187], v[88:91]
    ds_read_b64_tr_b16 a[104:105], v218 offset:14336
    v_cvt_pk_bf16_f32 v179, v134, v135
    v_mfma_f32_16x16x32_bf16 v[92:95], a[116:119], v[188:191], v[92:95]
    v_exp_f32 v136, v136
    v_mfma_f32_16x16x32_bf16 v[104:107], a[120:123], v[184:187], v[104:107]
    ds_read_b64_tr_b16 a[106:107], v218 offset:63488
    v_mfma_f32_16x16x32_bf16 v[108:111], a[120:123], v[188:191], v[108:111]
    v_exp_f32 v137, v137
    v_mfma_f32_16x16x32_bf16 v[120:123], a[124:127], v[184:187], v[120:123]
    ds_read_b64_tr_b16 a[108:109], v219 offset:14336
    v_cvt_pk_bf16_f32 v180, v136, v137
    v_mfma_f32_16x16x32_bf16 v[124:127], a[124:127], v[188:191], v[124:127]
    v_exp_f32 v138, v138
    v_smfmac_f32_16x16x64_bf16 v[196:199], v[208:211], v[184:191], v207
    ds_read_b64_tr_b16 a[110:111], v219 offset:63488
    v_mfma_f32_16x16x32_bf16 v[144:147], a[64:67], a[32:35], v[168:171]
    ds_read_b64_tr_b16 a[112:113], v220 offset:14336
    v_mfma_f32_16x16x32_bf16 v[144:147], a[68:71], a[36:39], v[144:147]
    v_exp_f32 v139, v139
    v_mfma_f32_16x16x32_bf16 v[144:147], a[72:75], a[40:43], v[144:147]
    ds_read_b64_tr_b16 a[114:115], v220 offset:63488
    v_cvt_pk_bf16_f32 v181, v138, v139
    v_mfma_f32_16x16x32_bf16 v[144:147], a[76:79], a[44:47], v[144:147]
    v_exp_f32 v140, v140
    v_mfma_f32_16x16x32_bf16 v[148:151], a[80:83], a[32:35], v[168:171]
    ds_read_b64_tr_b16 a[116:117], v221 offset:14336
    v_mfma_f32_16x16x32_bf16 v[148:151], a[84:87], a[36:39], v[148:151]
    v_exp_f32 v141, v141
    v_mfma_f32_16x16x32_bf16 v[148:151], a[88:91], a[40:43], v[148:151]
    ds_read_b64_tr_b16 a[118:119], v221 offset:63488
    v_cvt_pk_bf16_f32 v182, v140, v141
    v_mfma_f32_16x16x32_bf16 v[148:151], a[92:95], a[44:47], v[148:151]
    v_exp_f32 v142, v142
    v_mfma_f32_16x16x32_bf16 v[152:155], a[64:67], a[48:51], v[172:175]
    ds_read_b64_tr_b16 a[120:121], v222 offset:14336
    v_mfma_f32_16x16x32_bf16 v[152:155], a[68:71], a[52:55], v[152:155]
    v_exp_f32 v143, v143
    v_mfma_f32_16x16x32_bf16 v[152:155], a[72:75], a[56:59], v[152:155]
    ds_read_b64_tr_b16 a[122:123], v222 offset:63488
    v_cvt_pk_bf16_f32 v183, v142, v143
    v_mfma_f32_16x16x32_bf16 v[152:155], a[76:79], a[60:63], v[152:155]
    v_exp_f32 v144, v144
    v_mfma_f32_16x16x32_bf16 v[156:159], a[80:83], a[48:51], v[172:175]
    ds_read_b64_tr_b16 a[124:125], v223 offset:14336
    v_mfma_f32_16x16x32_bf16 v[156:159], a[84:87], a[52:55], v[156:159]
    v_exp_f32 v145, v145
    v_mfma_f32_16x16x32_bf16 v[156:159], a[88:91], a[56:59], v[156:159]
    ds_read_b64_tr_b16 a[126:127], v223 offset:63488
    v_cvt_pk_bf16_f32 v184, v144, v145
    v_mfma_f32_16x16x32_bf16 v[156:159], a[92:95], a[60:63], v[156:159]
    s_waitcnt lgkmcnt(8)
    v_exp_f32 v146, v146
    v_mfma_f32_16x16x32_bf16 v[0:3], a[96:99], v[176:179], v[0:3]
    ds_read_b128 a[64:67], v212 offset:12288
    v_mfma_f32_16x16x32_bf16 v[4:7], a[96:99], v[180:183], v[4:7]
    v_exp_f32 v147, v147
    v_mfma_f32_16x16x32_bf16 v[16:19], a[100:103], v[176:179], v[16:19]
    ds_read_b128 a[68:71], v213 offset:12288
    v_cvt_pk_bf16_f32 v185, v146, v147
    v_mfma_f32_16x16x32_bf16 v[20:23], a[100:103], v[180:183], v[20:23]
    v_exp_f32 v148, v148
    v_mfma_f32_16x16x32_bf16 v[32:35], a[104:107], v[176:179], v[32:35]
    ds_read_b128 a[72:75], v214 offset:12288
    v_mfma_f32_16x16x32_bf16 v[36:39], a[104:107], v[180:183], v[36:39]
    v_exp_f32 v149, v149
    v_mfma_f32_16x16x32_bf16 v[48:51], a[108:111], v[176:179], v[48:51]
    ds_read_b128 a[76:79], v215 offset:12288
    v_cvt_pk_bf16_f32 v186, v148, v149
    v_mfma_f32_16x16x32_bf16 v[52:55], a[108:111], v[180:183], v[52:55]
    s_waitcnt lgkmcnt(4)
    v_exp_f32 v150, v150
    v_mfma_f32_16x16x32_bf16 v[64:67], a[112:115], v[176:179], v[64:67]
    ds_read_b128 a[80:83], v212 offset:61440
    v_mfma_f32_16x16x32_bf16 v[68:71], a[112:115], v[180:183], v[68:71]
    v_exp_f32 v151, v151
    v_mfma_f32_16x16x32_bf16 v[80:83], a[116:119], v[176:179], v[80:83]
    ds_read_b128 a[84:87], v213 offset:61440
    v_cvt_pk_bf16_f32 v187, v150, v151
    v_mfma_f32_16x16x32_bf16 v[84:87], a[116:119], v[180:183], v[84:87]
    v_exp_f32 v152, v152
    v_mfma_f32_16x16x32_bf16 v[96:99], a[120:123], v[176:179], v[96:99]
    ds_read_b128 a[88:91], v214 offset:61440
    v_mfma_f32_16x16x32_bf16 v[100:103], a[120:123], v[180:183], v[100:103]
    v_exp_f32 v153, v153
    v_mfma_f32_16x16x32_bf16 v[112:115], a[124:127], v[176:179], v[112:115]
    ds_read_b128 a[92:95], v215 offset:61440
    v_cvt_pk_bf16_f32 v188, v152, v153
    v_mfma_f32_16x16x32_bf16 v[116:119], a[124:127], v[180:183], v[116:119]
    s_cmp_eq_u32 s59, 0
    v_exp_f32 v154, v154
    v_smfmac_f32_16x16x64_bf16 v[192:195], v[208:211], v[176:183], v207
    s_waitcnt lgkmcnt(4)
    s_cbranch_scc1 M_DRAIN
L_ENTRY:
    v_mfma_f32_16x16x32_bf16 v[128:131], a[64:67], a[0:3], v[160:163]
    v_mfma_f32_16x16x32_bf16 v[128:131], a[68:71], a[4:7], v[128:131]
    v_exp_f32 v155, v155
    v_mfma_f32_16x16x32_bf16 v[128:131], a[72:75], a[8:11], v[128:131]
    v_cvt_pk_bf16_f32 v189, v154, v155
    v_mfma_f32_16x16x32_bf16 v[128:131], a[76:79], a[12:15], v[128:131]
    s_waitcnt vmcnt(8) lgkmcnt(0)
    v_exp_f32 v156, v156
    v_mfma_f32_16x16x32_bf16 v[132:135], a[80:83], a[0:3], v[160:163]
    s_barrier
    v_mfma_f32_16x16x32_bf16 v[132:135], a[84:87], a[4:7], v[132:135]
    s_add_u32 m0, s55, 20480
    v_exp_f32 v157, v157
    v_mfma_f32_16x16x32_bf16 v[132:135], a[88:91], a[8:11], v[132:135]
    v_cvt_pk_bf16_f32 v190, v156, v157
    v_mfma_f32_16x16x32_bf16 v[132:135], a[92:95], a[12:15], v[132:135]
    v_exp_f32 v158, v158
    v_mfma_f32_16x16x32_bf16 v[136:139], a[64:67], a[16:19], v[164:167]
    buffer_load_dwordx4 v224, s[40:43], s60 offen lds
    v_mfma_f32_16x16x32_bf16 v[136:139], a[68:71], a[20:23], v[136:139]
    v_exp_f32 v159, v159
    v_mfma_f32_16x16x32_bf16 v[136:139], a[72:75], a[24:27], v[136:139]
    v_cvt_pk_bf16_f32 v191, v158, v159
    v_mfma_f32_16x16x32_bf16 v[136:139], a[76:79], a[28:31], v[136:139]
    v_exp_f32 v128, v128
    v_mfma_f32_16x16x32_bf16 v[140:143], a[80:83], a[16:19], v[164:167]
    buffer_load_dwordx4 v225, s[40:43], s60 offen offset:1024 lds
    v_mfma_f32_16x16x32_bf16 v[140:143], a[84:87], a[20:23], v[140:143]
    v_exp_f32 v129, v129
    v_mfma_f32_16x16x32_bf16 v[140:143], a[88:91], a[24:27], v[140:143]
    v_cvt_pk_bf16_f32 v176, v128, v129
    v_mfma_f32_16x16x32_bf16 v[140:143], a[92:95], a[28:31], v[140:143]
    v_exp_f32 v130, v130
    v_mfma_f32_16x16x32_bf16 v[8:11], a[96:99], v[184:187], v[8:11]
    buffer_load_dwordx4 v226, s[44:47], s60 offen offset:2048 lds
    v_mfma_f32_16x16x32_bf16 v[12:15], a[96:99], v[188:191], v[12:15]
    v_exp_f32 v131, v131
    v_mfma_f32_16x16x32_bf16 v[24:27], a[100:103], v[184:187], v[24:27]
    ds_read_b64_tr_b16 a[96:97], v216 offset:2048
    v_cvt_pk_bf16_f32 v177, v130, v131
    v_mfma_f32_16x16x32_bf16 v[28:31], a[100:103], v[188:191], v[28:31]
    v_exp_f32 v132, v132
    v_mfma_f32_16x16x32_bf16 v[40:43], a[104:107], v[184:187], v[40:43]
    buffer_load_dwordx4 v227, s[44:47], s60 offen offset:3072 lds
    ds_read_b64_tr_b16 a[98:99], v216 offset:51200
    v_mfma_f32_16x16x32_bf16 v[44:47], a[104:107], v[188:191], v[44:47]
    s_add_u32 s60, s60, s61
    v_exp_f32 v133, v133
    v_mfma_f32_16x16x32_bf16 v[56:59], a[108:111], v[184:187], v[56:59]
    ds_read_b64_tr_b16 a[100:101], v217 offset:2048
    v_cvt_pk_bf16_f32 v178, v132, v133
    v_mfma_f32_16x16x32_bf16 v[60:63], a[108:111], v[188:191], v[60:63]
    v_exp_f32 v134, v134
    v_mfma_f32_16x16x32_bf16 v[72:75], a[112:115], v[184:187], v[72:75]
    ds_read_b64_tr_b16 a[102:103], v217 offset:51200
    v_mfma_f32_16x16x32_bf16 v[76:79], a[112:115], v[188:191], v[76:79]
    v_exp_f32 v135, v135
    v_mfma_f32_16x16x32_bf16 v[88:91], a[116:119], v[184:187], v[88:91]
    ds_read_b64_tr_b16 a[104:105], v218 offset:2048
    v_cvt_pk_bf16_f32 v179, v134, v135
    v_mfma_f32_16x16x32_bf16 v[92:95], a[116:119], v[188:191], v[92:95]
    v_exp_f32 v136, v136
    v_mfma_f32_16x16x32_bf16 v[104:107], a[120:123], v[184:187], v[104:107]
    ds_read_b64_tr_b16 a[106:107], v218 offset:51200
    v_mfma_f32_16x16x32_bf16 v[108:111], a[120:123], v[188:191], v[108:111]
    v_exp_f32 v137, v137
    v_mfma_f32_16x16x32_bf16 v[120:123], a[124:127], v[184:187], v[120:123]
    ds_read_b64_tr_b16 a[108:109], v219 offset:2048
    v_cvt_pk_bf16_f32 v180, v136, v137
    v_mfma_f32_16x16x32_bf16 v[124:127], a[124:127], v[188:191], v[124:127]
    v_exp_f32 v138, v138
    v_smfmac_f32_16x16x64_bf16 v[196:199], v[208:211], v[184:191], v207
    ds_read_b64_tr_b16 a[110:111], v219 offset:51200
    v_mfma_f32_16x16x32_bf16 v[144:147], a[64:67], a[32:35], v[168:171]
    ds_read_b64_tr_b16 a[112:113], v220 offset:2048
    v_mfma_f32_16x16x32_bf16 v[144:147], a[68:71], a[36:39], v[144:147]
    v_exp_f32 v139, v139
    v_mfma_f32_16x16x32_bf16 v[144:147], a[72:75], a[40:43], v[144:147]
    ds_read_b64_tr_b16 a[114:115], v220 offset:51200
    v_cvt_pk_bf16_f32 v181, v138, v139
    v_mfma_f32_16x16x32_bf16 v[144:147], a[76:79], a[44:47], v[144:147]
    v_exp_f32 v140, v140
    v_mfma_f32_16x16x32_bf16 v[148:151], a[80:83], a[32:35], v[168:171]
    ds_read_b64_tr_b16 a[116:117], v221 offset:2048
    v_mfma_f32_16x16x32_bf16 v[148:151], a[84:87], a[36:39], v[148:151]
    v_exp_f32 v141, v141
    v_mfma_f32_16x16x32_bf16 v[148:151], a[88:91], a[40:43], v[148:151]
    ds_read_b64_tr_b16 a[118:119], v221 offset:51200
    v_cvt_pk_bf16_f32 v182, v140, v141
    v_mfma_f32_16x16x32_bf16 v[148:151], a[92:95], a[44:47], v[148:151]
    v_exp_f32 v142, v142
    v_mfma_f32_16x16x32_bf16 v[152:155], a[64:67], a[48:51], v[172:175]
    ds_read_b64_tr_b16 a[120:121], v222 offset:2048
    v_mfma_f32_16x16x32_bf16 v[152:155], a[68:71], a[52:55], v[152:155]
    v_exp_f32 v143, v143
    v_mfma_f32_16x16x32_bf16 v[152:155], a[72:75], a[56:59], v[152:155]
    ds_read_b64_tr_b16 a[122:123], v222 offset:51200
    v_cvt_pk_bf16_f32 v183, v142, v143
    v_mfma_f32_16x16x32_bf16 v[152:155], a[76:79], a[60:63], v[152:155]
    v_exp_f32 v144, v144
    v_mfma_f32_16x16x32_bf16 v[156:159], a[80:83], a[48:51], v[172:175]
    ds_read_b64_tr_b16 a[124:125], v223 offset:2048
    v_mfma_f32_16x16x32_bf16 v[156:159], a[84:87], a[52:55], v[156:159]
    v_exp_f32 v145, v145
    v_mfma_f32_16x16x32_bf16 v[156:159], a[88:91], a[56:59], v[156:159]
    ds_read_b64_tr_b16 a[126:127], v223 offset:51200
    v_cvt_pk_bf16_f32 v184, v144, v145
    v_mfma_f32_16x16x32_bf16 v[156:159], a[92:95], a[60:63], v[156:159]
    s_waitcnt lgkmcnt(8)
    v_exp_f32 v146, v146
    v_mfma_f32_16x16x32_bf16 v[0:3], a[96:99], v[176:179], v[0:3]
    ds_read_b128 a[64:67], v212 offset:0
    v_mfma_f32_16x16x32_bf16 v[4:7], a[96:99], v[180:183], v[4:7]
    v_exp_f32 v147, v147
    v_mfma_f32_16x16x32_bf16 v[16:19], a[100:103], v[176:179], v[16:19]
    ds_read_b128 a[68:71], v213 offset:0
    v_cvt_pk_bf16_f32 v185, v146, v147
    v_mfma_f32_16x16x32_bf16 v[20:23], a[100:103], v[180:183], v[20:23]
    v_exp_f32 v148, v148
    v_mfma_f32_16x16x32_bf16 v[32:35], a[104:107], v[176:179], v[32:35]
    ds_read_b128 a[72:75], v214 offset:0
    v_mfma_f32_16x16x32_bf16 v[36:39], a[104:107], v[180:183], v[36:39]
    v_exp_f32 v149, v149
    v_mfma_f32_16x16x32_bf16 v[48:51], a[108:111], v[176:179], v[48:51]
    ds_read_b128 a[76:79], v215 offset:0
    v_cvt_pk_bf16_f32 v186, v148, v149
    v_mfma_f32_16x16x32_bf16 v[52:55], a[108:111], v[180:183], v[52:55]
    s_waitcnt lgkmcnt(4)
    v_exp_f32 v150, v150
    v_mfma_f32_16x16x32_bf16 v[64:67], a[112:115], v[176:179], v[64:67]
    ds_read_b128 a[80:83], v212 offset:49152
    v_mfma_f32_16x16x32_bf16 v[68:71], a[112:115], v[180:183], v[68:71]
    v_exp_f32 v151, v151
    v_mfma_f32_16x16x32_bf16 v[80:83], a[116:119], v[176:179], v[80:83]
    ds_read_b128 a[84:87], v213 offset:49152
    v_cvt_pk_bf16_f32 v187, v150, v151
    v_mfma_f32_16x16x32_bf16 v[84:87], a[116:119], v[180:183], v[84:87]
    v_exp_f32 v152, v152
    v_mfma_f32_16x16x32_bf16 v[96:99], a[120:123], v[176:179], v[96:99]
    ds_read_b128 a[88:91], v214 offset:49152
    v_mfma_f32_16x16x32_bf16 v[100:103], a[120:123], v[180:183], v[100:103]
    s_sub_u32 s59, s59, 1
    v_exp_f32 v153, v153
    v_mfma_f32_16x16x32_bf16 v[112:115], a[124:127], v[176:179], v[112:115]
    ds_read_b128 a[92:95], v215 offset:49152
    v_cvt_pk_bf16_f32 v188, v152, v153
    v_mfma_f32_16x16x32_bf16 v[116:119], a[124:127], v[180:183], v[116:119]
    s_cmp_lg_u32 s59, s86
    v_exp_f32 v154, v154
    v_smfmac_f32_16x16x64_bf16 v[192:195], v[208:211], v[176:183], v207
    s_waitcnt lgkmcnt(4)
    s_cbranch_scc1 L_ATT
    s_cmp_eq_u32 s86, 7
    s_cbranch_scc1 M_H7
    s_cmp_eq_u32 s86, 5
    s_cbranch_scc1 M_H5
    s_cmp_eq_u32 s86, 0
    s_cbranch_scc1 M_H0
M_H12:
    s_mov_b32 s86, 7
    s_lshl_b32 s66, s54, 2
    v_mov_b32 v234, s66
    v_mov_b32 v235, 1
    s_movk_i32 s67, 128
    v_writelane_b32 v234, s67, 1
    s_cmp_eq_u32 s62, 7
    s_cselect_b32 exec_lo, 3, 1
    s_mov_b32 exec_hi, 0
    buffer_atomic_add v235, v234, s[80:83], 0 offen
    s_mov_b64 exec, -1
    s_branch L_ATT
M_H7:
    s_mov_b32 s86, 5
    s_lshl_b32 s64, s84, 2
    v_and_b32 v236, 1, v246
    v_cmp_eq_u32 vcc, 0, v236
    v_mov_b32 v234, s64
    v_mov_b32 v235, 0x80
    v_cndmask_b32 v234, v235, v234, vcc
    v_mov_b32 v235, 8
    v_cndmask_b32 v235, 32, v235, vcc
    buffer_load_dword v236, v234, s[80:83], 0 offen sc1
    s_branch L_ATT
M_H0:
    s_mov_b32 s86, 99
    s_mov_b32 s40, s12
    s_mov_b32 s41, s13
    s_mov_b32 s42, 4194304
    s_mov_b32 s43, 0x20000
    s_add_u32 s44, s12, 14336
    s_addc_u32 s45, s13, 0
    s_mov_b32 s46, 4179968
    s_mov_b32 s47, 0x20000
    s_mov_b32 s60, s56
    s_mov_b32 s61, 32768
    v_mov_b32 v224, v232
    v_mov_b32 v225, v233
    v_mov_b32 v226, v232
    v_mov_b32 v227, v233
    s_branch L_ATT
L_CHECK:
    buffer_load_dword v236, v234, s[80:83], 0 offen sc1
    s_waitcnt vmcnt(0)
    v_cmp_lt_u32 vcc, v236, v235
    s_sub_u32 s64, s64, 1
    s_cbranch_scc1 M_READY
    s_cbranch_vccnz L_CHECK
    s_branch M_READY
M_H5:
    s_mov_b32 s86, 0
    v_cmp_lt_u32 vcc, v236, v235
    s_mov_b32 s64, 131072
    s_cbranch_vccnz L_CHECK
M_READY:
    s_mul_i32 s64, s52, 57344
    s_mul_i32 s87, s84, 229376
    s_add_u32 s87, s87, s64
    s_mul_i32 s88, s85, 229376
    s_add_u32 s88, s88, s64
    s_add_u32 s88, s88, 8388608
    s_add_u32 s89, s87, 4096
    s_add_u32 s76, s88, 4096
    s_mov_b32 s77, 268435456
    v_mfma_f32_16x16x32_bf16 v[128:131], a[64:67], a[0:3], v[160:163]
    v_mfma_f32_16x16x32_bf16 v[128:131], a[68:71], a[4:7], v[128:131]
    v_exp_f32 v155, v155
    v_mfma_f32_16x16x32_bf16 v[128:131], a[72:75], a[8:11], v[128:131]
    v_cvt_pk_bf16_f32 v189, v154, v155
    v_mfma_f32_16x16x32_bf16 v[128:131], a[76:79], a[12:15], v[128:131]
    s_waitcnt vmcnt(8) lgkmcnt(0)
    v_exp_f32 v156, v156
    v_mfma_f32_16x16x32_bf16 v[132:135], a[80:83], a[0:3], v[160:163]
    s_barrier
    v_mfma_f32_16x16x32_bf16 v[132:135], a[84:87], a[4:7], v[132:135]
    s_add_u32 m0, s55, 8192
    v_exp_f32 v157, v157
    v_mfma_f32_16x16x32_bf16 v[132:135], a[88:91], a[8:11], v[132:135]
    v_cvt_pk_bf16_f32 v190, v156, v157
    v_mfma_f32_16x16x32_bf16 v[132:135], a[92:95], a[12:15], v[132:135]
    v_exp_f32 v158, v158
    v_mfma_f32_16x16x32_bf16 v[136:139], a[64:67], a[16:19], v[164:167]
    buffer_load_dwordx4 v224, s[40:43], s60 offen lds
    v_mfma_f32_16x16x32_bf16 v[136:139], a[68:71], a[20:23], v[136:139]
    v_exp_f32 v159, v159
    v_mfma_f32_16x16x32_bf16 v[136:139], a[72:75], a[24:27], v[136:139]
    v_cvt_pk_bf16_f32 v191, v158, v159
    v_mfma_f32_16x16x32_bf16 v[136:139], a[76:79], a[28:31], v[136:139]
    v_exp_f32 v128, v128
    v_mfma_f32_16x16x32_bf16 v[140:143], a[80:83], a[16:19], v[164:167]
    buffer_load_dwordx4 v225, s[40:43], s60 offen offset:1024 lds
    v_mfma_f32_16x16x32_bf16 v[140:143], a[84:87], a[20:23], v[140:143]
    v_exp_f32 v129, v129
    v_mfma_f32_16x16x32_bf16 v[140:143], a[88:91], a[24:27], v[140:143]
    v_cvt_pk_bf16_f32 v176, v128, v129
    v_mfma_f32_16x16x32_bf16 v[140:143], a[92:95], a[28:31], v[140:143]
    v_exp_f32 v130, v130
    v_mfma_f32_16x16x32_bf16 v[8:11], a[96:99], v[184:187], v[8:11]
    buffer_load_dwordx4 v226, s[44:47], s60 offen offset:2048 lds
    v_mfma_f32_16x16x32_bf16 v[12:15], a[96:99], v[188:191], v[12:15]
    v_exp_f32 v131, v131
    v_mfma_f32_16x16x32_bf16 v[24:27], a[100:103], v[184:187], v[24:27]
    ds_read_b64_tr_b16 a[96:97], v216 offset:6144
    v_cvt_pk_bf16_f32 v177, v130, v131
    v_mfma_f32_16x16x32_bf16 v[28:31], a[100:103], v[188:191], v[28:31]
    v_exp_f32 v132, v132
    v_mfma_f32_16x16x32_bf16 v[40:43], a[104:107], v[184:187], v[40:43]
    buffer_load_dwordx4 v227, s[44:47], s60 offen offset:3072 lds
    ds_read_b64_tr_b16 a[98:99], v216 offset:55296
    v_mfma_f32_16x16x32_bf16 v[44:47], a[104:107], v[188:191], v[44:47]
    s_add_u32 s60, s60, s61
    v_exp_f32 v133, v133
    v_mfma_f32_16x16x32_bf16 v[56:59], a[108:111], v[184:187], v[56:59]
    buffer_load_dwordx4 a[160:163], v245, s[48:51], s88 offen offset:0 sc1
    ds_read_b64_tr_b16 a[100:101], v217 offset:6144
    v_cvt_pk_bf16_f32 v178, v132, v133
    v_mfma_f32_16x16x32_bf16 v[60:63], a[108:111], v[188:191], v[60:63]
    v_exp_f32 v134, v134
    v_mfma_f32_16x16x32_bf16 v[72:75], a[112:115], v[184:187], v[72:75]
    buffer_load_dwordx4 a[176:179], v245, s[48:51], s87 offen offset:0 sc1
    ds_read_b64_tr_b16 a[102:103], v217 offset:55296
    v_mfma_f32_16x16x32_bf16 v[76:79], a[112:115], v[188:191], v[76:79]
    v_exp_f32 v135, v135
    v_mfma_f32_16x16x32_bf16 v[88:91], a[116:119], v[184:187], v[88:91]
    buffer_load_dwordx4 a[164:167], v245, s[48:51], s88 offen offset:1024 sc1
    ds_read_b64_tr_b16 a[104:105], v218 offset:6144
    v_cvt_pk_bf16_f32 v179, v134, v135
    v_mfma_f32_16x16x32_bf16 v[92:95], a[116:119], v[188:191], v[92:95]
    v_exp_f32 v136, v136
    v_mfma_f32_16x16x32_bf16 v[104:107], a[120:123], v[184:187], v[104:107]
    buffer_load_dwordx4 a[180:183], v245, s[48:51], s87 offen offset:1024 sc1
    ds_read_b64_tr_b16 a[106:107], v218 offset:55296
    v_mfma_f32_16x16x32_bf16 v[108:111], a[120:123], v[188:191], v[108:111]
    v_exp_f32 v137, v137
    v_mfma_f32_16x16x32_bf16 v[120:123], a[124:127], v[184:187], v[120:123]
    buffer_load_dwordx4 a[168:171], v245, s[48:51], s88 offen offset:2048 sc1
    ds_read_b64_tr_b16 a[108:109], v219 offset:6144
    v_cvt_pk_bf16_f32 v180, v136, v137
    v_mfma_f32_16x16x32_bf16 v[124:127], a[124:127], v[188:191], v[124:127]
    v_exp_f32 v138, v138
    v_smfmac_f32_16x16x64_bf16 v[196:199], v[208:211], v[184:191], v207
    ds_read_b64_tr_b16 a[110:111], v219 offset:55296
    v_mfma_f32_16x16x32_bf16 v[144:147], a[64:67], a[32:35], v[168:171]
    buffer_load_dwordx4 a[184:187], v245, s[48:51], s87 offen offset:2048 sc1
    ds_read_b64_tr_b16 a[112:113], v220 offset:6144
    v_mfma_f32_16x16x32_bf16 v[144:147], a[68:71], a[36:39], v[144:147]
    v_exp_f32 v139, v139
    v_mfma_f32_16x16x32_bf16 v[144:147], a[72:75], a[40:43], v[144:147]
    ds_read_b64_tr_b16 a[114:115], v220 offset:55296
    v_cvt_pk_bf16_f32 v181, v138, v139
    v_mfma_f32_16x16x32_bf16 v[144:147], a[76:79], a[44:47], v[144:147]
    v_exp_f32 v140, v140
    v_mfma_f32_16x16x32_bf16 v[148:151], a[80:83], a[32:35], v[168:171]
    buffer_load_dwordx4 a[172:175], v245, s[48:51], s88 offen offset:3072 sc1
    ds_read_b64_tr_b16 a[116:117], v221 offset:6144
    v_mfma_f32_16x16x32_bf16 v[148:151], a[84:87], a[36:39], v[148:151]
    v_exp_f32 v141, v141
    v_mfma_f32_16x16x32_bf16 v[148:151], a[88:91], a[40:43], v[148:151]
    buffer_load_dwordx4 a[188:191], v245, s[48:51], s87 offen offset:3072 sc1
    ds_read_b64_tr_b16 a[118:119], v221 offset:55296
    v_cvt_pk_bf16_f32 v182, v140, v141
    v_mfma_f32_16x16x32_bf16 v[148:151], a[92:95], a[44:47], v[148:151]
    s_mov_b32 s87, s89
    v_exp_f32 v142, v142
    v_mfma_f32_16x16x32_bf16 v[152:155], a[64:67], a[48:51], v[172:175]
    ds_read_b64_tr_b16 a[120:121], v222 offset:6144
    v_mfma_f32_16x16x32_bf16 v[152:155], a[68:71], a[52:55], v[152:155]
    s_mov_b32 s88, s76
    v_exp_f32 v143, v143
    v_mfma_f32_16x16x32_bf16 v[152:155], a[72:75], a[56:59], v[152:155]
    ds_read_b64_tr_b16 a[122:123], v222 offset:55296
    v_cvt_pk_bf16_f32 v183, v142, v143
    v_mfma_f32_16x16x32_bf16 v[152:155], a[76:79], a[60:63], v[152:155]
    s_add_u32 s89, s89, 4096
    v_exp_f32 v144, v144
    v_mfma_f32_16x16x32_bf16 v[156:159], a[80:83], a[48:51], v[172:175]
    ds_read_b64_tr_b16 a[124:125], v223 offset:6144
    v_mfma_f32_16x16x32_bf16 v[156:159], a[84:87], a[52:55], v[156:159]
    s_add_u32 s76, s76, 4096
    v_exp_f32 v145, v145
    v_mfma_f32_16x16x32_bf16 v[156:159], a[88:91], a[56:59], v[156:159]
    ds_read_b64_tr_b16 a[126:127], v223 offset:55296
    v_cvt_pk_bf16_f32 v184, v144, v145
    v_mfma_f32_16x16x32_bf16 v[156:159], a[92:95], a[60:63], v[156:159]
    s_waitcnt lgkmcnt(8)
    v_exp_f32 v146, v146
    v_mfma_f32_16x16x32_bf16 v[0:3], a[96:99], v[176:179], v[0:3]
    ds_read_b128 a[64:67], v212 offset:4096
    v_mfma_f32_16x16x32_bf16 v[4:7], a[96:99], v[180:183], v[4:7]
    v_exp_f32 v147, v147
    v_mfma_f32_16x16x32_bf16 v[16:19], a[100:103], v[176:179], v[16:19]
    ds_read_b128 a[68:71], v213 offset:4096
    v_cvt_pk_bf16_f32 v185, v146, v147
    v_mfma_f32_16x16x32_bf16 v[20:23], a[100:103], v[180:183], v[20:23]
    v_exp_f32 v148, v148
    v_mfma_f32_16x16x32_bf16 v[32:35], a[104:107], v[176:179], v[32:35]
    ds_read_b128 a[72:75], v214 offset:4096
    v_mfma_f32_16x16x32_bf16 v[36:39], a[104:107], v[180:183], v[36:39]
    v_exp_f32 v149, v149
    v_mfma_f32_16x16x32_bf16 v[48:51], a[108:111], v[176:179], v[48:51]
    ds_read_b128 a[76:79], v215 offset:4096
    v_cvt_pk_bf16_f32 v186, v148, v149
    v_mfma_f32_16x16x32_bf16 v[52:55], a[108:111], v[180:183], v[52:55]
    s_waitcnt lgkmcnt(4)
    v_exp_f32 v150, v150
    v_mfma_f32_16x16x32_bf16 v[64:67], a[112:115], v[176:179], v[64:67]
    ds_read_b128 a[80:83], v212 offset:53248
    v_mfma_f32_16x16x32_bf16 v[68:71], a[112:115], v[180:183], v[68:71]
    v_exp_f32 v151, v151
    v_mfma_f32_16x16x32_bf16 v[80:83], a[116:119], v[176:179], v[80:83]
    ds_read_b128 a[84:87], v213 offset:53248
    v_cvt_pk_bf16_f32 v187, v150, v151
    v_mfma_f32_16x16x32_bf16 v[84:87], a[116:119], v[180:183], v[84:87]
    v_exp_f32 v152, v152
    v_mfma_f32_16x16x32_bf16 v[96:99], a[120:123], v[176:179], v[96:99]
    ds_read_b128 a[88:91], v214 offset:53248
    v_mfma_f32_16x16x32_bf16 v[100:103], a[120:123], v[180:183], v[100:103]
    v_exp_f32 v153, v153
    v_mfma_f32_16x16x32_bf16 v[112:115], a[124:127], v[176:179], v[112:115]
    ds_read_b128 a[92:95], v215 offset:53248
    v_cvt_pk_bf16_f32 v188, v152, v153
    v_mfma_f32_16x16x32_bf16 v[116:119], a[124:127], v[180:183], v[116:119]
    v_exp_f32 v154, v154
    v_smfmac_f32_16x16x64_bf16 v[192:195], v[208:211], v[176:183], v207
    s_waitcnt lgkmcnt(4)
    v_mfma_f32_16x16x32_bf16 v[128:131], a[64:67], a[0:3], v[160:163]
    v_mfma_f32_16x16x32_bf16 v[128:131], a[68:71], a[4:7], v[128:131]
    v_exp_f32 v155, v155
    v_mfma_f32_16x16x32_bf16 v[128:131], a[72:75], a[8:11], v[128:131]
    v_cvt_pk_bf16_f32 v189, v154, v155
    v_mfma_f32_16x16x32_bf16 v[128:131], a[76:79], a[12:15], v[128:131]
    s_waitcnt vmcnt(16) lgkmcnt(0)
    v_exp_f32 v156, v156
    v_mfma_f32_16x16x32_bf16 v[132:135], a[80:83], a[0:3], v[160:163]
    s_barrier
    v_mfma_f32_16x16x32_bf16 v[132:135], a[84:87], a[4:7], v[132:135]
    s_add_u32 m0, s55, 12288
    v_exp_f32 v157, v157
    v_mfma_f32_16x16x32_bf16 v[132:135], a[88:91], a[8:11], v[132:135]
    v_cvt_pk_bf16_f32 v190, v156, v157
    v_mfma_f32_16x16x32_bf16 v[132:135], a[92:95], a[12:15], v[132:135]
    v_exp_f32 v158, v158
    v_mfma_f32_16x16x32_bf16 v[136:139], a[64:67], a[16:19], v[164:167]
    buffer_load_dwordx4 v224, s[40:43], s60 offen lds
    v_mfma_f32_16x16x32_bf16 v[136:139], a[68:71], a[20:23], v[136:139]
    v_exp_f32 v159, v159
    v_mfma_f32_16x16x32_bf16 v[136:139], a[72:75], a[24:27], v[136:139]
    v_cvt_pk_bf16_f32 v191, v158, v159
    v_mfma_f32_16x16x32_bf16 v[136:139], a[76:79], a[28:31], v[136:139]
    v_exp_f32 v128, v128
    v_mfma_f32_16x16x32_bf16 v[140:143], a[80:83], a[16:19], v[164:167]
    buffer_load_dwordx4 v225, s[40:43], s60 offen offset:1024 lds
    v_mfma_f32_16x16x32_bf16 v[140:143], a[84:87], a[20:23], v[140:143]
    v_exp_f32 v129, v129
    v_mfma_f32_16x16x32_bf16 v[140:143], a[88:91], a[24:27], v[140:143]
    v_cvt_pk_bf16_f32 v176, v128, v129
    v_mfma_f32_16x16x32_bf16 v[140:143], a[92:95], a[28:31], v[140:143]
    v_exp_f32 v130, v130
    v_mfma_f32_16x16x32_bf16 v[8:11], a[96:99], v[184:187], v[8:11]
    buffer_load_dwordx4 v226, s[44:47], s60 offen offset:2048 lds
    v_mfma_f32_16x16x32_bf16 v[12:15], a[96:99], v[188:191], v[12:15]
    v_exp_f32 v131, v131
    v_mfma_f32_16x16x32_bf16 v[24:27], a[100:103], v[184:187], v[24:27]
    ds_read_b64_tr_b16 a[96:97], v216 offset:10240
    v_cvt_pk_bf16_f32 v177, v130, v131
    v_mfma_f32_16x16x32_bf16 v[28:31], a[100:103], v[188:191], v[28:31]
    v_exp_f32 v132, v132
    v_mfma_f32_16x16x32_bf16 v[40:43], a[104:107], v[184:187], v[40:43]
    buffer_load_dwordx4 v227, s[44:47], s60 offen offset:3072 lds
    ds_read_b64_tr_b16 a[98:99], v216 offset:59392
    v_mfma_f32_16x16x32_bf16 v[44:47], a[104:107], v[188:191], v[44:47]
    s_add_u32 s60, s60, s61
    v_exp_f32 v133, v133
    v_mfma_f32_16x16x32_bf16 v[56:59], a[108:111], v[184:187], v[56:59]
    buffer_load_dwordx4 a[128:131], v245, s[48:51], s88 offen offset:0 sc1
    ds_read_b64_tr_b16 a[100:101], v217 offset:10240
    v_cvt_pk_bf16_f32 v178, v132, v133
    v_mfma_f32_16x16x32_bf16 v[60:63], a[108:111], v[188:191], v[60:63]
    v_exp_f32 v134, v134
    v_mfma_f32_16x16x32_bf16 v[72:75], a[112:115], v[184:187], v[72:75]
    buffer_load_dwordx4 a[144:147], v245, s[48:51], s87 offen offset:0 sc1
    ds_read_b64_tr_b16 a[102:103], v217 offset:59392
    v_mfma_f32_16x16x32_bf16 v[76:79], a[112:115], v[188:191], v[76:79]
    v_exp_f32 v135, v135
    v_mfma_f32_16x16x32_bf16 v[88:91], a[116:119], v[184:187], v[88:91]
    buffer_load_dwordx4 a[132:135], v245, s[48:51], s88 offen offset:1024 sc1
    ds_read_b64_tr_b16 a[104:105], v218 offset:10240
    v_cvt_pk_bf16_f32 v179, v134, v135
    v_mfma_f32_16x16x32_bf16 v[92:95], a[116:119], v[188:191], v[92:95]
    v_exp_f32 v136, v136
    v_mfma_f32_16x16x32_bf16 v[104:107], a[120:123], v[184:187], v[104:107]
    buffer_load_dwordx4 a[148:151], v245, s[48:51], s87 offen offset:1024 sc1
    ds_read_b64_tr_b16 a[106:107], v218 offset:59392
    v_mfma_f32_16x16x32_bf16 v[108:111], a[120:123], v[188:191], v[108:111]
    v_exp_f32 v137, v137
    v_mfma_f32_16x16x32_bf16 v[120:123], a[124:127], v[184:187], v[120:123]
    buffer_load_dwordx4 a[136:139], v245, s[48:51], s88 offen offset:2048 sc1
    ds_read_b64_tr_b16 a[108:109], v219 offset:10240
    v_cvt_pk_bf16_f32 v180, v136, v137
    v_mfma_f32_16x16x32_bf16 v[124:127], a[124:127], v[188:191], v[124:127]
    v_exp_f32 v138, v138
    v_smfmac_f32_16x16x64_bf16 v[196:199], v[208:211], v[184:191], v207
    ds_read_b64_tr_b16 a[110:111], v219 offset:59392
    v_mfma_f32_16x16x32_bf16 v[144:147], a[64:67], a[32:35], v[168:171]
    buffer_load_dwordx4 a[152:155], v245, s[48:51], s87 offen offset:2048 sc1
    ds_read_b64_tr_b16 a[112:113], v220 offset:10240
    v_mfma_f32_16x16x32_bf16 v[144:147], a[68:71], a[36:39], v[144:147]
    v_exp_f32 v139, v139
    v_mfma_f32_16x16x32_bf16 v[144:147], a[72:75], a[40:43], v[144:147]
    ds_read_b64_tr_b16 a[114:115], v220 offset:59392
    v_cvt_pk_bf16_f32 v181, v138, v139
    v_mfma_f32_16x16x32_bf16 v[144:147], a[76:79], a[44:47], v[144:147]
    v_exp_f32 v140, v140
    v_mfma_f32_16x16x32_bf16 v[148:151], a[80:83], a[32:35], v[168:171]
    buffer_load_dwordx4 a[140:143], v245, s[48:51], s88 offen offset:3072 sc1
    ds_read_b64_tr_b16 a[116:117], v221 offset:10240
    v_mfma_f32_16x16x32_bf16 v[148:151], a[84:87], a[36:39], v[148:151]
    v_exp_f32 v141, v141
    v_mfma_f32_16x16x32_bf16 v[148:151], a[88:91], a[40:43], v[148:151]
    buffer_load_dwordx4 a[156:159], v245, s[48:51], s87 offen offset:3072 sc1
    ds_read_b64_tr_b16 a[118:119], v221 offset:59392
    v_cvt_pk_bf16_f32 v182, v140, v141
    v_mfma_f32_16x16x32_bf16 v[148:151], a[92:95], a[44:47], v[148:151]
    s_mov_b32 s87, s89
    v_exp_f32 v142, v142
    v_mfma_f32_16x16x32_bf16 v[152:155], a[64:67], a[48:51], v[172:175]
    ds_read_b64_tr_b16 a[120:121], v222 offset:10240
    v_mfma_f32_16x16x32_bf16 v[152:155], a[68:71], a[52:55], v[152:155]
    s_mov_b32 s88, s76
    v_exp_f32 v143, v143
    v_mfma_f32_16x16x32_bf16 v[152:155], a[72:75], a[56:59], v[152:155]
    ds_read_b64_tr_b16 a[122:123], v222 offset:59392
    v_cvt_pk_bf16_f32 v183, v142, v143
    v_mfma_f32_16x16x32_bf16 v[152:155], a[76:79], a[60:63], v[152:155]
    s_add_u32 s89, s89, 4096
    v_exp_f32 v144, v144
    v_mfma_f32_16x16x32_bf16 v[156:159], a[80:83], a[48:51], v[172:175]
    ds_read_b64_tr_b16 a[124:125], v223 offset:10240
    v_mfma_f32_16x16x32_bf16 v[156:159], a[84:87], a[52:55], v[156:159]
    s_add_u32 s76, s76, 4096
    v_exp_f32 v145, v145
    v_mfma_f32_16x16x32_bf16 v[156:159], a[88:91], a[56:59], v[156:159]
    ds_read_b64_tr_b16 a[126:127], v223 offset:59392
    v_cvt_pk_bf16_f32 v184, v144, v145
    v_mfma_f32_16x16x32_bf16 v[156:159], a[92:95], a[60:63], v[156:159]
    s_waitcnt lgkmcnt(8)
    v_exp_f32 v146, v146
    v_mfma_f32_16x16x32_bf16 v[0:3], a[96:99], v[176:179], v[0:3]
    ds_read_b128 a[64:67], v212 offset:8192
    v_mfma_f32_16x16x32_bf16 v[4:7], a[96:99], v[180:183], v[4:7]
    v_exp_f32 v147, v147
    v_mfma_f32_16x16x32_bf16 v[16:19], a[100:103], v[176:179], v[16:19]
    ds_read_b128 a[68:71], v213 offset:8192
    v_cvt_pk_bf16_f32 v185, v146, v147
    v_mfma_f32_16x16x32_bf16 v[20:23], a[100:103], v[180:183], v[20:23]
    v_exp_f32 v148, v148
    v_mfma_f32_16x16x32_bf16 v[32:35], a[104:107], v[176:179], v[32:35]
    ds_read_b128 a[72:75], v214 offset:8192
    v_mfma_f32_16x16x32_bf16 v[36:39], a[104:107], v[180:183], v[36:39]
    v_exp_f32 v149, v149
    v_mfma_f32_16x16x32_bf16 v[48:51], a[108:111], v[176:179], v[48:51]
    ds_read_b128 a[76:79], v215 offset:8192
    v_cvt_pk_bf16_f32 v186, v148, v149
    v_mfma_f32_16x16x32_bf16 v[52:55], a[108:111], v[180:183], v[52:55]
    s_waitcnt lgkmcnt(4)
    v_exp_f32 v150, v150
    v_mfma_f32_16x16x32_bf16 v[64:67], a[112:115], v[176:179], v[64:67]
    ds_read_b128 a[80:83], v212 offset:57344
    v_mfma_f32_16x16x32_bf16 v[68:71], a[112:115], v[180:183], v[68:71]
    v_exp_f32 v151, v151
    v_mfma_f32_16x16x32_bf16 v[80:83], a[116:119], v[176:179], v[80:83]
    ds_read_b128 a[84:87], v213 offset:57344
    v_cvt_pk_bf16_f32 v187, v150, v151
    v_mfma_f32_16x16x32_bf16 v[84:87], a[116:119], v[180:183], v[84:87]
    v_exp_f32 v152, v152
    v_mfma_f32_16x16x32_bf16 v[96:99], a[120:123], v[176:179], v[96:99]
    ds_read_b128 a[88:91], v214 offset:57344
    v_mfma_f32_16x16x32_bf16 v[100:103], a[120:123], v[180:183], v[100:103]
    v_exp_f32 v153, v153
    v_mfma_f32_16x16x32_bf16 v[112:115], a[124:127], v[176:179], v[112:115]
    ds_read_b128 a[92:95], v215 offset:57344
    v_cvt_pk_bf16_f32 v188, v152, v153
    v_mfma_f32_16x16x32_bf16 v[116:119], a[124:127], v[180:183], v[116:119]
    v_exp_f32 v154, v154
    v_smfmac_f32_16x16x64_bf16 v[192:195], v[208:211], v[176:183], v207
    s_waitcnt lgkmcnt(4)
    v_mfma_f32_16x16x32_bf16 v[128:131], a[64:67], a[0:3], v[160:163]
    v_mfma_f32_16x16x32_bf16 v[128:131], a[68:71], a[4:7], v[128:131]
    v_exp_f32 v155, v155
    v_mfma_f32_16x16x32_bf16 v[128:131], a[72:75], a[8:11], v[128:131]
    v_cvt_pk_bf16_f32 v189, v154, v155
    v_mfma_f32_16x16x32_bf16 v[128:131], a[76:79], a[12:15], v[128:131]
    s_waitcnt vmcnt(24) lgkmcnt(0)
    v_exp_f32 v156, v156
    v_mfma_f32_16x16x32_bf16 v[132:135], a[80:83], a[0:3], v[160:163]
    s_barrier
    v_mfma_f32_16x16x32_bf16 v[132:135], a[84:87], a[4:7], v[132:135]
    s_add_u32 m0, s55, 16384
    v_exp_f32 v157, v157
    v_mfma_f32_16x16x32_bf16 v[132:135], a[88:91], a[8:11], v[132:135]
    v_cvt_pk_bf16_f32 v190, v156, v157
    v_mfma_f32_16x16x32_bf16 v[132:135], a[92:95], a[12:15], v[132:135]
    v_exp_f32 v158, v158
    v_mfma_f32_16x16x32_bf16 v[136:139], a[64:67], a[16:19], v[164:167]
    buffer_load_dwordx4 v224, s[40:43], s60 offen lds
    v_mfma_f32_16x16x32_bf16 v[136:139], a[68:71], a[20:23], v[136:139]
    v_exp_f32 v159, v159
    v_mfma_f32_16x16x32_bf16 v[136:139], a[72:75], a[24:27], v[136:139]
    v_cvt_pk_bf16_f32 v191, v158, v159
    v_mfma_f32_16x16x32_bf16 v[136:139], a[76:79], a[28:31], v[136:139]
    v_exp_f32 v128, v128
    v_mfma_f32_16x16x32_bf16 v[140:143], a[80:83], a[16:19], v[164:167]
    buffer_load_dwordx4 v225, s[40:43], s60 offen offset:1024 lds
    v_mfma_f32_16x16x32_bf16 v[140:143], a[84:87], a[20:23], v[140:143]
    v_exp_f32 v129, v129
    v_mfma_f32_16x16x32_bf16 v[140:143], a[88:91], a[24:27], v[140:143]
    v_cvt_pk_bf16_f32 v176, v128, v129
    v_mfma_f32_16x16x32_bf16 v[140:143], a[92:95], a[28:31], v[140:143]
    v_exp_f32 v130, v130
    v_mfma_f32_16x16x32_bf16 v[8:11], a[96:99], v[184:187], v[8:11]
    buffer_load_dwordx4 v226, s[44:47], s60 offen offset:2048 lds
    v_mfma_f32_16x16x32_bf16 v[12:15], a[96:99], v[188:191], v[12:15]
    v_exp_f32 v131, v131
    v_mfma_f32_16x16x32_bf16 v[24:27], a[100:103], v[184:187], v[24:27]
    ds_read_b64_tr_b16 a[96:97], v216 offset:14336
    v_cvt_pk_bf16_f32 v177, v130, v131
    v_mfma_f32_16x16x32_bf16 v[28:31], a[100:103], v[188:191], v[28:31]
    v_exp_f32 v132, v132
    v_mfma_f32_16x16x32_bf16 v[40:43], a[104:107], v[184:187], v[40:43]
    buffer_load_dwordx4 v227, s[44:47], s60 offen offset:3072 lds
    ds_read_b64_tr_b16 a[98:99], v216 offset:63488
    v_mfma_f32_16x16x32_bf16 v[44:47], a[104:107], v[188:191], v[44:47]
    s_add_u32 s60, s60, s61
    v_exp_f32 v133, v133
    v_mfma_f32_16x16x32_bf16 v[56:59], a[108:111], v[184:187], v[56:59]
    ds_read_b64_tr_b16 a[100:101], v217 offset:14336
    v_cvt_pk_bf16_f32 v178, v132, v133
    v_mfma_f32_16x16x32_bf16 v[60:63], a[108:111], v[188:191], v[60:63]
    v_exp_f32 v134, v134
    v_mfma_f32_16x16x32_bf16 v[72:75], a[112:115], v[184:187], v[72:75]
    buffer_load_dword v251, off, s[48:51], s77
    ds_read_b64_tr_b16 a[102:103], v217 offset:63488
    v_mfma_f32_16x16x32_bf16 v[76:79], a[112:115], v[188:191], v[76:79]
    v_exp_f32 v135, v135
    v_mfma_f32_16x16x32_bf16 v[88:91], a[116:119], v[184:187], v[88:91]
    ds_read_b64_tr_b16 a[104:105], v218 offset:14336
    v_cvt_pk_bf16_f32 v179, v134, v135
    v_mfma_f32_16x16x32_bf16 v[92:95], a[116:119], v[188:191], v[92:95]
    v_exp_f32 v136, v136
    v_mfma_f32_16x16x32_bf16 v[104:107], a[120:123], v[184:187], v[104:107]
    buffer_load_dword v251, off, s[48:51], s77
    ds_read_b64_tr_b16 a[106:107], v218 offset:63488
    v_mfma_f32_16x16x32_bf16 v[108:111], a[120:123], v[188:191], v[108:111]
    v_exp_f32 v137, v137
    v_mfma_f32_16x16x32_bf16 v[120:123], a[124:127], v[184:187], v[120:123]
    ds_read_b64_tr_b16 a[108:109], v219 offset:14336
    v_cvt_pk_bf16_f32 v180, v136, v137
    v_mfma_f32_16x16x32_bf16 v[124:127], a[124:127], v[188:191], v[124:127]
    v_exp_f32 v138, v138
    v_smfmac_f32_16x16x64_bf16 v[196:199], v[208:211], v[184:191], v207
    ds_read_b64_tr_b16 a[110:111], v219 offset:63488
    v_mfma_f32_16x16x32_bf16 v[144:147], a[64:67], a[32:35], v[168:171]
    buffer_load_dword v251, off, s[48:51], s77
    ds_read_b64_tr_b16 a[112:113], v220 offset:14336
    v_mfma_f32_16x16x32_bf16 v[144:147], a[68:71], a[36:39], v[144:147]
    v_exp_f32 v139, v139
    v_mfma_f32_16x16x32_bf16 v[144:147], a[72:75], a[40:43], v[144:147]
    ds_read_b64_tr_b16 a[114:115], v220 offset:63488
    v_cvt_pk_bf16_f32 v181, v138, v139
    v_mfma_f32_16x16x32_bf16 v[144:147], a[76:79], a[44:47], v[144:147]
    v_exp_f32 v140, v140
    v_mfma_f32_16x16x32_bf16 v[148:151], a[80:83], a[32:35], v[168:171]
    buffer_load_dword v251, off, s[48:51], s77
    ds_read_b64_tr_b16 a[116:117], v221 offset:14336
    v_mfma_f32_16x16x32_bf16 v[148:151], a[84:87], a[36:39], v[148:151]
    v_exp_f32 v141, v141
    v_mfma_f32_16x16x32_bf16 v[148:151], a[88:91], a[40:43], v[148:151]
    ds_read_b64_tr_b16 a[118:119], v221 offset:63488
    v_cvt_pk_bf16_f32 v182, v140, v141
    v_mfma_f32_16x16x32_bf16 v[148:151], a[92:95], a[44:47], v[148:151]
    v_exp_f32 v142, v142
    v_mfma_f32_16x16x32_bf16 v[152:155], a[64:67], a[48:51], v[172:175]
    ds_read_b64_tr_b16 a[120:121], v222 offset:14336
    v_mfma_f32_16x16x32_bf16 v[152:155], a[68:71], a[52:55], v[152:155]
    v_exp_f32 v143, v143
    v_mfma_f32_16x16x32_bf16 v[152:155], a[72:75], a[56:59], v[152:155]
    ds_read_b64_tr_b16 a[122:123], v222 offset:63488
    v_cvt_pk_bf16_f32 v183, v142, v143
    v_mfma_f32_16x16x32_bf16 v[152:155], a[76:79], a[60:63], v[152:155]
    v_exp_f32 v144, v144
    v_mfma_f32_16x16x32_bf16 v[156:159], a[80:83], a[48:51], v[172:175]
    ds_read_b64_tr_b16 a[124:125], v223 offset:14336
    v_mfma_f32_16x16x32_bf16 v[156:159], a[84:87], a[52:55], v[156:159]
    v_exp_f32 v145, v145
    v_mfma_f32_16x16x32_bf16 v[156:159], a[88:91], a[56:59], v[156:159]
    ds_read_b64_tr_b16 a[126:127], v223 offset:63488
    v_cvt_pk_bf16_f32 v184, v144, v145
    v_mfma_f32_16x16x32_bf16 v[156:159], a[92:95], a[60:63], v[156:159]
    s_waitcnt lgkmcnt(8)
    v_exp_f32 v146, v146
    v_mfma_f32_16x16x32_bf16 v[0:3], a[96:99], v[176:179], v[0:3]
    ds_read_b128 a[64:67], v212 offset:12288
    v_mfma_f32_16x16x32_bf16 v[4:7], a[96:99], v[180:183], v[4:7]
    v_exp_f32 v147, v147
    v_mfma_f32_16x16x32_bf16 v[16:19], a[100:103], v[176:179], v[16:19]
    ds_read_b128 a[68:71], v213 offset:12288
    v_cvt_pk_bf16_f32 v185, v146, v147
    v_mfma_f32_16x16x32_bf16 v[20:23], a[100:103], v[180:183], v[20:23]
    v_exp_f32 v148, v148
    v_mfma_f32_16x16x32_bf16 v[32:35], a[104:107], v[176:179], v[32:35]
    ds_read_b128 a[72:75], v214 offset:12288
    v_mfma_f32_16x16x32_bf16 v[36:39], a[104:107], v[180:183], v[36:39]
    v_exp_f32 v149, v149
    v_mfma_f32_16x16x32_bf16 v[48:51], a[108:111], v[176:179], v[48:51]
    ds_read_b128 a[76:79], v215 offset:12288
    v_cvt_pk_bf16_f32 v186, v148, v149
    v_mfma_f32_16x16x32_bf16 v[52:55], a[108:111], v[180:183], v[52:55]
    s_waitcnt lgkmcnt(4)
    v_exp_f32 v150, v150
    v_mfma_f32_16x16x32_bf16 v[64:67], a[112:115], v[176:179], v[64:67]
    ds_read_b128 a[80:83], v212 offset:61440
    v_mfma_f32_16x16x32_bf16 v[68:71], a[112:115], v[180:183], v[68:71]
    v_exp_f32 v151, v151
    v_mfma_f32_16x16x32_bf16 v[80:83], a[116:119], v[176:179], v[80:83]
    ds_read_b128 a[84:87], v213 offset:61440
    v_cvt_pk_bf16_f32 v187, v150, v151
    v_mfma_f32_16x16x32_bf16 v[84:87], a[116:119], v[180:183], v[84:87]
    v_exp_f32 v152, v152
    v_mfma_f32_16x16x32_bf16 v[96:99], a[120:123], v[176:179], v[96:99]
    ds_read_b128 a[88:91], v214 offset:61440
    v_mfma_f32_16x16x32_bf16 v[100:103], a[120:123], v[180:183], v[100:103]
    v_exp_f32 v153, v153
    v_mfma_f32_16x16x32_bf16 v[112:115], a[124:127], v[176:179], v[112:115]
    ds_read_b128 a[92:95], v215 offset:61440
    v_cvt_pk_bf16_f32 v188, v152, v153
    v_mfma_f32_16x16x32_bf16 v[116:119], a[124:127], v[180:183], v[116:119]
    v_exp_f32 v154, v154
    v_smfmac_f32_16x16x64_bf16 v[192:195], v[208:211], v[176:183], v207
    s_waitcnt vmcnt(20) lgkmcnt(4)
    v_mfma_f32_16x16x32_bf16 a[192:195], a[160:163], a[176:179], 0
    v_mfma_f32_16x16x32_bf16 a[196:199], a[160:163], a[180:183], 0
    v_mfma_f32_16x16x32_bf16 a[208:211], a[164:167], a[176:179], 0
    v_mfma_f32_16x16x32_bf16 a[212:215], a[164:167], a[180:183], 0
    v_mfma_f32_16x16x32_bf16 a[224:227], a[168:171], a[176:179], 0
    v_mfma_f32_16x16x32_bf16 a[228:231], a[168:171], a[180:183], 0
    v_mfma_f32_16x16x32_bf16 a[240:243], a[172:175], a[176:179], 0
    buffer_load_dwordx4 a[176:179], v245, s[48:51], s87 offen offset:0 sc1
    v_mfma_f32_16x16x32_bf16 a[244:247], a[172:175], a[180:183], 0
    v_mfma_f32_16x16x32_bf16 a[200:203], a[160:163], a[184:187], 0
    v_mfma_f32_16x16x32_bf16 a[204:207], a[160:163], a[188:191], 0
    buffer_load_dwordx4 a[180:183], v245, s[48:51], s87 offen offset:1024 sc1
    v_mfma_f32_16x16x32_bf16 a[216:219], a[164:167], a[184:187], 0
    v_mfma_f32_16x16x32_bf16 a[220:223], a[164:167], a[188:191], 0
    v_mfma_f32_16x16x32_bf16 a[232:235], a[168:171], a[184:187], 0
    buffer_load_dwordx4 a[160:163], v245, s[48:51], s88 offen offset:0 sc1
    v_mfma_f32_16x16x32_bf16 a[236:239], a[168:171], a[188:191], 0
    v_mfma_f32_16x16x32_bf16 a[248:251], a[172:175], a[184:187], 0
    v_mfma_f32_16x16x32_bf16 a[252:255], a[172:175], a[188:191], 0
    buffer_load_dwordx4 a[164:167], v245, s[48:51], s88 offen offset:1024 sc1
    v_mfma_f32_16x16x32_bf16 v[128:131], a[64:67], a[0:3], v[160:163]
    v_mfma_f32_16x16x32_bf16 v[128:131], a[68:71], a[4:7], v[128:131]
    v_exp_f32 v155, v155
    v_mfma_f32_16x16x32_bf16 v[128:131], a[72:75], a[8:11], v[128:131]
    v_cvt_pk_bf16_f32 v189, v154, v155
    v_mfma_f32_16x16x32_bf16 v[128:131], a[76:79], a[12:15], v[128:131]
    s_waitcnt vmcnt(32) lgkmcnt(0)
    v_exp_f32 v156, v156
    v_mfma_f32_16x16x32_bf16 v[132:135], a[80:83], a[0:3], v[160:163]
    s_barrier
    v_mfma_f32_16x16x32_bf16 v[132:135], a[84:87], a[4:7], v[132:135]
    s_add_u32 m0, s55, 20480
    v_exp_f32 v157, v157
    v_mfma_f32_16x16x32_bf16 v[132:135], a[88:91], a[8:11], v[132:135]
    v_cvt_pk_bf16_f32 v190, v156, v157
    v_mfma_f32_16x16x32_bf16 v[132:135], a[92:95], a[12:15], v[132:135]
    v_exp_f32 v158, v158
    v_mfma_f32_16x16x32_bf16 v[136:139], a[64:67], a[16:19], v[164:167]
    buffer_load_dwordx4 v224, s[40:43], s60 offen lds
    v_mfma_f32_16x16x32_bf16 v[136:139], a[68:71], a[20:23], v[136:139]
    v_exp_f32 v159, v159
    v_mfma_f32_16x16x32_bf16 v[136:139], a[72:75], a[24:27], v[136:139]
    v_cvt_pk_bf16_f32 v191, v158, v159
    v_mfma_f32_16x16x32_bf16 v[136:139], a[76:79], a[28:31], v[136:139]
    v_exp_f32 v128, v128
    v_mfma_f32_16x16x32_bf16 v[140:143], a[80:83], a[16:19], v[164:167]
    buffer_load_dwordx4 v225, s[40:43], s60 offen offset:1024 lds
    v_mfma_f32_16x16x32_bf16 v[140:143], a[84:87], a[20:23], v[140:143]
    v_exp_f32 v129, v129
    v_mfma_f32_16x16x32_bf16 v[140:143], a[88:91], a[24:27], v[140:143]
    v_cvt_pk_bf16_f32 v176, v128, v129
    v_mfma_f32_16x16x32_bf16 v[140:143], a[92:95], a[28:31], v[140:143]
    v_exp_f32 v130, v130
    v_mfma_f32_16x16x32_bf16 v[8:11], a[96:99], v[184:187], v[8:11]
    buffer_load_dwordx4 v226, s[44:47], s60 offen offset:2048 lds
    v_mfma_f32_16x16x32_bf16 v[12:15], a[96:99], v[188:191], v[12:15]
    v_exp_f32 v131, v131
    v_mfma_f32_16x16x32_bf16 v[24:27], a[100:103], v[184:187], v[24:27]
    ds_read_b64_tr_b16 a[96:97], v216 offset:2048
    v_cvt_pk_bf16_f32 v177, v130, v131
    v_mfma_f32_16x16x32_bf16 v[28:31], a[100:103], v[188:191], v[28:31]
    v_exp_f32 v132, v132
    v_mfma_f32_16x16x32_bf16 v[40:43], a[104:107], v[184:187], v[40:43]
    buffer_load_dwordx4 v227, s[44:47], s60 offen offset:3072 lds
    ds_read_b64_tr_b16 a[98:99], v216 offset:51200
    v_mfma_f32_16x16x32_bf16 v[44:47], a[104:107], v[188:191], v[44:47]
    s_add_u32 s60, s60, s61
    v_exp_f32 v133, v133
    v_mfma_f32_16x16x32_bf16 v[56:59], a[108:111], v[184:187], v[56:59]
    ds_read_b64_tr_b16 a[100:101], v217 offset:2048
    v_cvt_pk_bf16_f32 v178, v132, v133
    v_mfma_f32_16x16x32_bf16 v[60:63], a[108:111], v[188:191], v[60:63]
    v_exp_f32 v134, v134
    v_mfma_f32_16x16x32_bf16 v[72:75], a[112:115], v[184:187], v[72:75]
    buffer_load_dwordx4 a[168:171], v245, s[48:51], s88 offen offset:2048 sc1
    ds_read_b64_tr_b16 a[102:103], v217 offset:51200
    v_mfma_f32_16x16x32_bf16 v[76:79], a[112:115], v[188:191], v[76:79]
    v_exp_f32 v135, v135
    v_mfma_f32_16x16x32_bf16 v[88:91], a[116:119], v[184:187], v[88:91]
    ds_read_b64_tr_b16 a[104:105], v218 offset:2048
    v_cvt_pk_bf16_f32 v179, v134, v135
    v_mfma_f32_16x16x32_bf16 v[92:95], a[116:119], v[188:191], v[92:95]
    v_exp_f32 v136, v136
    v_mfma_f32_16x16x32_bf16 v[104:107], a[120:123], v[184:187], v[104:107]
    buffer_load_dwordx4 a[172:175], v245, s[48:51], s88 offen offset:3072 sc1
    ds_read_b64_tr_b16 a[106:107], v218 offset:51200
    v_mfma_f32_16x16x32_bf16 v[108:111], a[120:123], v[188:191], v[108:111]
    v_exp_f32 v137, v137
    v_mfma_f32_16x16x32_bf16 v[120:123], a[124:127], v[184:187], v[120:123]
    ds_read_b64_tr_b16 a[108:109], v219 offset:2048
    v_cvt_pk_bf16_f32 v180, v136, v137
    v_mfma_f32_16x16x32_bf16 v[124:127], a[124:127], v[188:191], v[124:127]
    v_exp_f32 v138, v138
    v_smfmac_f32_16x16x64_bf16 v[196:199], v[208:211], v[184:191], v207
    ds_read_b64_tr_b16 a[110:111], v219 offset:51200
    v_mfma_f32_16x16x32_bf16 v[144:147], a[64:67], a[32:35], v[168:171]
    buffer_load_dwordx4 a[184:187], v245, s[48:51], s87 offen offset:2048 sc1
    ds_read_b64_tr_b16 a[112:113], v220 offset:2048
    v_mfma_f32_16x16x32_bf16 v[144:147], a[68:71], a[36:39], v[144:147]
    v_exp_f32 v139, v139
    v_mfma_f32_16x16x32_bf16 v[144:147], a[72:75], a[40:43], v[144:147]
    ds_read_b64_tr_b16 a[114:115], v220 offset:51200
    v_cvt_pk_bf16_f32 v181, v138, v139
    v_mfma_f32_16x16x32_bf16 v[144:147], a[76:79], a[44:47], v[144:147]
    v_exp_f32 v140, v140
    v_mfma_f32_16x16x32_bf16 v[148:151], a[80:83], a[32:35], v[168:171]
    buffer_load_dwordx4 a[188:191], v245, s[48:51], s87 offen offset:3072 sc1
    ds_read_b64_tr_b16 a[116:117], v221 offset:2048
    v_mfma_f32_16x16x32_bf16 v[148:151], a[84:87], a[36:39], v[148:151]
    v_exp_f32 v141, v141
    v_mfma_f32_16x16x32_bf16 v[148:151], a[88:91], a[40:43], v[148:151]
    ds_read_b64_tr_b16 a[118:119], v221 offset:51200
    v_cvt_pk_bf16_f32 v182, v140, v141
    v_mfma_f32_16x16x32_bf16 v[148:151], a[92:95], a[44:47], v[148:151]
    s_mov_b32 s87, s89
    v_exp_f32 v142, v142
    v_mfma_f32_16x16x32_bf16 v[152:155], a[64:67], a[48:51], v[172:175]
    ds_read_b64_tr_b16 a[120:121], v222 offset:2048
    v_mfma_f32_16x16x32_bf16 v[152:155], a[68:71], a[52:55], v[152:155]
    s_mov_b32 s88, s76
    v_exp_f32 v143, v143
    v_mfma_f32_16x16x32_bf16 v[152:155], a[72:75], a[56:59], v[152:155]
    ds_read_b64_tr_b16 a[122:123], v222 offset:51200
    v_cvt_pk_bf16_f32 v183, v142, v143
    v_mfma_f32_16x16x32_bf16 v[152:155], a[76:79], a[60:63], v[152:155]
    s_add_u32 s89, s89, 4096
    v_exp_f32 v144, v144
    v_mfma_f32_16x16x32_bf16 v[156:159], a[80:83], a[48:51], v[172:175]
    ds_read_b64_tr_b16 a[124:125], v223 offset:2048
    v_mfma_f32_16x16x32_bf16 v[156:159], a[84:87], a[52:55], v[156:159]
    s_add_u32 s76, s76, 4096
    v_exp_f32 v145, v145
    v_mfma_f32_16x16x32_bf16 v[156:159], a[88:91], a[56:59], v[156:159]
    ds_read_b64_tr_b16 a[126:127], v223 offset:51200
    v_cvt_pk_bf16_f32 v184, v144, v145
    v_mfma_f32_16x16x32_bf16 v[156:159], a[92:95], a[60:63], v[156:159]
    s_waitcnt lgkmcnt(8)
    v_exp_f32 v146, v146
    v_mfma_f32_16x16x32_bf16 v[0:3], a[96:99], v[176:179], v[0:3]
    ds_read_b128 a[64:67], v212 offset:0
    v_mfma_f32_16x16x32_bf16 v[4:7], a[96:99], v[180:183], v[4:7]
    v_exp_f32 v147, v147
    v_mfma_f32_16x16x32_bf16 v[16:19], a[100:103], v[176:179], v[16:19]
    ds_read_b128 a[68:71], v213 offset:0
    v_cvt_pk_bf16_f32 v185, v146, v147
    v_mfma_f32_16x16x32_bf16 v[20:23], a[100:103], v[180:183], v[20:23]
    v_exp_f32 v148, v148
    v_mfma_f32_16x16x32_bf16 v[32:35], a[104:107], v[176:179], v[32:35]
    ds_read_b128 a[72:75], v214 offset:0
    v_mfma_f32_16x16x32_bf16 v[36:39], a[104:107], v[180:183], v[36:39]
    v_exp_f32 v149, v149
    v_mfma_f32_16x16x32_bf16 v[48:51], a[108:111], v[176:179], v[48:51]
    ds_read_b128 a[76:79], v215 offset:0
    v_cvt_pk_bf16_f32 v186, v148, v149
    v_mfma_f32_16x16x32_bf16 v[52:55], a[108:111], v[180:183], v[52:55]
    s_waitcnt lgkmcnt(4)
    v_exp_f32 v150, v150
    v_mfma_f32_16x16x32_bf16 v[64:67], a[112:115], v[176:179], v[64:67]
    ds_read_b128 a[80:83], v212 offset:49152
    v_mfma_f32_16x16x32_bf16 v[68:71], a[112:115], v[180:183], v[68:71]
    v_exp_f32 v151, v151
    v_mfma_f32_16x16x32_bf16 v[80:83], a[116:119], v[176:179], v[80:83]
    ds_read_b128 a[84:87], v213 offset:49152
    v_cvt_pk_bf16_f32 v187, v150, v151
    v_mfma_f32_16x16x32_bf16 v[84:87], a[116:119], v[180:183], v[84:87]
    v_exp_f32 v152, v152
    v_mfma_f32_16x16x32_bf16 v[96:99], a[120:123], v[176:179], v[96:99]
    ds_read_b128 a[88:91], v214 offset:49152
    v_mfma_f32_16x16x32_bf16 v[100:103], a[120:123], v[180:183], v[100:103]
    s_sub_u32 s59, s59, 1
    v_exp_f32 v153, v153
    v_mfma_f32_16x16x32_bf16 v[112:115], a[124:127], v[176:179], v[112:115]
    ds_read_b128 a[92:95], v215 offset:49152
    v_cvt_pk_bf16_f32 v188, v152, v153
    v_mfma_f32_16x16x32_bf16 v[116:119], a[124:127], v[180:183], v[116:119]
    v_exp_f32 v154, v154
    v_smfmac_f32_16x16x64_bf16 v[192:195], v[208:211], v[176:183], v207
    s_waitcnt vmcnt(20) lgkmcnt(4)
    v_mfma_f32_16x16x32_bf16 a[192:195], a[128:131], a[144:147], a[192:195]
    v_mfma_f32_16x16x32_bf16 a[196:199], a[128:131], a[148:151], a[196:199]
    v_mfma_f32_16x16x32_bf16 a[208:211], a[132:135], a[144:147], a[208:211]
    v_mfma_f32_16x16x32_bf16 a[212:215], a[132:135], a[148:151], a[212:215]
    v_mfma_f32_16x16x32_bf16 a[224:227], a[136:139], a[144:147], a[224:227]
    v_mfma_f32_16x16x32_bf16 a[228:231], a[136:139], a[148:151], a[228:231]
    v_mfma_f32_16x16x32_bf16 a[240:243], a[140:143], a[144:147], a[240:243]
    buffer_load_dwordx4 a[144:147], v245, s[48:51], s87 offen offset:0 sc1
    v_mfma_f32_16x16x32_bf16 a[244:247], a[140:143], a[148:151], a[244:247]
    v_mfma_f32_16x16x32_bf16 a[200:203], a[128:131], a[152:155], a[200:203]
    v_mfma_f32_16x16x32_bf16 a[204:207], a[128:131], a[156:159], a[204:207]
    buffer_load_dwordx4 a[148:151], v245, s[48:51], s87 offen offset:1024 sc1
    v_mfma_f32_16x16x32_bf16 a[216:219], a[132:135], a[152:155], a[216:219]
    v_mfma_f32_16x16x32_bf16 a[220:223], a[132:135], a[156:159], a[220:223]
    v_mfma_f32_16x16x32_bf16 a[232:235], a[136:139], a[152:155], a[232:235]
    buffer_load_dwordx4 a[128:131], v245, s[48:51], s88 offen offset:0 sc1
    v_mfma_f32_16x16x32_bf16 a[236:239], a[136:139], a[156:159], a[236:239]
    v_mfma_f32_16x16x32_bf16 a[248:251], a[140:143], a[152:155], a[248:251]
    v_mfma_f32_16x16x32_bf16 a[252:255], a[140:143], a[156:159], a[252:255]
    buffer_load_dwordx4 a[132:135], v245, s[48:51], s88 offen offset:1024 sc1
L_ATT2:
    v_mfma_f32_16x16x32_bf16 v[128:131], a[64:67], a[0:3], v[160:163]
    v_mfma_f32_16x16x32_bf16 v[128:131], a[68:71], a[4:7], v[128:131]
    v_exp_f32 v155, v155
    v_mfma_f32_16x16x32_bf16 v[128:131], a[72:75], a[8:11], v[128:131]
    v_cvt_pk_bf16_f32 v189, v154, v155
    v_mfma_f32_16x16x32_bf16 v[128:131], a[76:79], a[12:15], v[128:131]
    s_waitcnt vmcnt(32) lgkmcnt(0)
    v_exp_f32 v156, v156
    v_mfma_f32_16x16x32_bf16 v[132:135], a[80:83], a[0:3], v[160:163]
    s_barrier
    v_mfma_f32_16x16x32_bf16 v[132:135], a[84:87], a[4:7], v[132:135]
    s_add_u32 m0, s55, 8192
    v_exp_f32 v157, v157
    v_mfma_f32_16x16x32_bf16 v[132:135], a[88:91], a[8:11], v[132:135]
    v_cvt_pk_bf16_f32 v190, v156, v157
    v_mfma_f32_16x16x32_bf16 v[132:135], a[92:95], a[12:15], v[132:135]
    v_exp_f32 v158, v158
    v_mfma_f32_16x16x32_bf16 v[136:139], a[64:67], a[16:19], v[164:167]
    buffer_load_dwordx4 v224, s[40:43], s60 offen lds
    v_mfma_f32_16x16x32_bf16 v[136:139], a[68:71], a[20:23], v[136:139]
    v_exp_f32 v159, v159
    v_mfma_f32_16x16x32_bf16 v[136:139], a[72:75], a[24:27], v[136:139]
    v_cvt_pk_bf16_f32 v191, v158, v159
    v_mfma_f32_16x16x32_bf16 v[136:139], a[76:79], a[28:31], v[136:139]
    v_exp_f32 v128, v128
    v_mfma_f32_16x16x32_bf16 v[140:143], a[80:83], a[16:19], v[164:167]
    buffer_load_dwordx4 v225, s[40:43], s60 offen offset:1024 lds
    v_mfma_f32_16x16x32_bf16 v[140:143], a[84:87], a[20:23], v[140:143]
    v_exp_f32 v129, v129
    v_mfma_f32_16x16x32_bf16 v[140:143], a[88:91], a[24:27], v[140:143]
    v_cvt_pk_bf16_f32 v176, v128, v129
    v_mfma_f32_16x16x32_bf16 v[140:143], a[92:95], a[28:31], v[140:143]
    v_exp_f32 v130, v130
    v_mfma_f32_16x16x32_bf16 v[8:11], a[96:99], v[184:187], v[8:11]
    buffer_load_dwordx4 v226, s[44:47], s60 offen offset:2048 lds
    v_mfma_f32_16x16x32_bf16 v[12:15], a[96:99], v[188:191], v[12:15]
    v_exp_f32 v131, v131
    v_mfma_f32_16x16x32_bf16 v[24:27], a[100:103], v[184:187], v[24:27]
    ds_read_b64_tr_b16 a[96:97], v216 offset:6144
    v_cvt_pk_bf16_f32 v177, v130, v131
    v_mfma_f32_16x16x32_bf16 v[28:31], a[100:103], v[188:191], v[28:31]
    v_exp_f32 v132, v132
    v_mfma_f32_16x16x32_bf16 v[40:43], a[104:107], v[184:187], v[40:43]
    buffer_load_dwordx4 v227, s[44:47], s60 offen offset:3072 lds
    ds_read_b64_tr_b16 a[98:99], v216 offset:55296
    v_mfma_f32_16x16x32_bf16 v[44:47], a[104:107], v[188:191], v[44:47]
    s_add_u32 s60, s60, s61
    v_exp_f32 v133, v133
    v_mfma_f32_16x16x32_bf16 v[56:59], a[108:111], v[184:187], v[56:59]
    ds_read_b64_tr_b16 a[100:101], v217 offset:6144
    v_cvt_pk_bf16_f32 v178, v132, v133
    v_mfma_f32_16x16x32_bf16 v[60:63], a[108:111], v[188:191], v[60:63]
    v_exp_f32 v134, v134
    v_mfma_f32_16x16x32_bf16 v[72:75], a[112:115], v[184:187], v[72:75]
    buffer_load_dwordx4 a[136:139], v245, s[48:51], s88 offen offset:2048 sc1
    ds_read_b64_tr_b16 a[102:103], v217 offset:55296
    v_mfma_f32_16x16x32_bf16 v[76:79], a[112:115], v[188:191], v[76:79]
    v_exp_f32 v135, v135
    v_mfma_f32_16x16x32_bf16 v[88:91], a[116:119], v[184:187], v[88:91]
    ds_read_b64_tr_b16 a[104:105], v218 offset:6144
    v_cvt_pk_bf16_f32 v179, v134, v135
    v_mfma_f32_16x16x32_bf16 v[92:95], a[116:119], v[188:191], v[92:95]
    v_exp_f32 v136, v136
    v_mfma_f32_16x16x32_bf16 v[104:107], a[120:123], v[184:187], v[104:107]
    buffer_load_dwordx4 a[140:143], v245, s[48:51], s88 offen offset:3072 sc1
    ds_read_b64_tr_b16 a[106:107], v218 offset:55296
    v_mfma_f32_16x16x32_bf16 v[108:111], a[120:123], v[188:191], v[108:111]
    v_exp_f32 v137, v137
    v_mfma_f32_16x16x32_bf16 v[120:123], a[124:127], v[184:187], v[120:123]
    ds_read_b64_tr_b16 a[108:109], v219 offset:6144
    v_cvt_pk_bf16_f32 v180, v136, v137
    v_mfma_f32_16x16x32_bf16 v[124:127], a[124:127], v[188:191], v[124:127]
    v_exp_f32 v138, v138
    v_smfmac_f32_16x16x64_bf16 v[196:199], v[208:211], v[184:191], v207
    ds_read_b64_tr_b16 a[110:111], v219 offset:55296
    v_mfma_f32_16x16x32_bf16 v[144:147], a[64:67], a[32:35], v[168:171]
    buffer_load_dwordx4 a[152:155], v245, s[48:51], s87 offen offset:2048 sc1
    ds_read_b64_tr_b16 a[112:113], v220 offset:6144
    v_mfma_f32_16x16x32_bf16 v[144:147], a[68:71], a[36:39], v[144:147]
    v_exp_f32 v139, v139
    v_mfma_f32_16x16x32_bf16 v[144:147], a[72:75], a[40:43], v[144:147]
    ds_read_b64_tr_b16 a[114:115], v220 offset:55296
    v_cvt_pk_bf16_f32 v181, v138, v139
    v_mfma_f32_16x16x32_bf16 v[144:147], a[76:79], a[44:47], v[144:147]
    v_exp_f32 v140, v140
    v_mfma_f32_16x16x32_bf16 v[148:151], a[80:83], a[32:35], v[168:171]
    buffer_load_dwordx4 a[156:159], v245, s[48:51], s87 offen offset:3072 sc1
    ds_read_b64_tr_b16 a[116:117], v221 offset:6144
    v_mfma_f32_16x16x32_bf16 v[148:151], a[84:87], a[36:39], v[148:151]
    v_exp_f32 v141, v141
    v_mfma_f32_16x16x32_bf16 v[148:151], a[88:91], a[40:43], v[148:151]
    ds_read_b64_tr_b16 a[118:119], v221 offset:55296
    v_cvt_pk_bf16_f32 v182, v140, v141
    v_mfma_f32_16x16x32_bf16 v[148:151], a[92:95], a[44:47], v[148:151]
    s_mov_b32 s87, s89
    v_exp_f32 v142, v142
    v_mfma_f32_16x16x32_bf16 v[152:155], a[64:67], a[48:51], v[172:175]
    ds_read_b64_tr_b16 a[120:121], v222 offset:6144
    v_mfma_f32_16x16x32_bf16 v[152:155], a[68:71], a[52:55], v[152:155]
    s_mov_b32 s88, s76
    v_exp_f32 v143, v143
    v_mfma_f32_16x16x32_bf16 v[152:155], a[72:75], a[56:59], v[152:155]
    ds_read_b64_tr_b16 a[122:123], v222 offset:55296
    v_cvt_pk_bf16_f32 v183, v142, v143
    v_mfma_f32_16x16x32_bf16 v[152:155], a[76:79], a[60:63], v[152:155]
    s_add_u32 s89, s89, 4096
    v_exp_f32 v144, v144
    v_mfma_f32_16x16x32_bf16 v[156:159], a[80:83], a[48:51], v[172:175]
    ds_read_b64_tr_b16 a[124:125], v223 offset:6144
    v_mfma_f32_16x16x32_bf16 v[156:159], a[84:87], a[52:55], v[156:159]
    s_add_u32 s76, s76, 4096
    v_exp_f32 v145, v145
    v_mfma_f32_16x16x32_bf16 v[156:159], a[88:91], a[56:59], v[156:159]
    ds_read_b64_tr_b16 a[126:127], v223 offset:55296
    v_cvt_pk_bf16_f32 v184, v144, v145
    v_mfma_f32_16x16x32_bf16 v[156:159], a[92:95], a[60:63], v[156:159]
    s_waitcnt lgkmcnt(8)
    v_exp_f32 v146, v146
    v_mfma_f32_16x16x32_bf16 v[0:3], a[96:99], v[176:179], v[0:3]
    ds_read_b128 a[64:67], v212 offset:4096
    v_mfma_f32_16x16x32_bf16 v[4:7], a[96:99], v[180:183], v[4:7]
    v_exp_f32 v147, v147
    v_mfma_f32_16x16x32_bf16 v[16:19], a[100:103], v[176:179], v[16:19]
    ds_read_b128 a[68:71], v213 offset:4096
    v_cvt_pk_bf16_f32 v185, v146, v147
    v_mfma_f32_16x16x32_bf16 v[20:23], a[100:103], v[180:183], v[20:23]
    v_exp_f32 v148, v148
    v_mfma_f32_16x16x32_bf16 v[32:35], a[104:107], v[176:179], v[32:35]
    ds_read_b128 a[72:75], v214 offset:4096
    v_mfma_f32_16x16x32_bf16 v[36:39], a[104:107], v[180:183], v[36:39]
    v_exp_f32 v149, v149
    v_mfma_f32_16x16x32_bf16 v[48:51], a[108:111], v[176:179], v[48:51]
    ds_read_b128 a[76:79], v215 offset:4096
    v_cvt_pk_bf16_f32 v186, v148, v149
    v_mfma_f32_16x16x32_bf16 v[52:55], a[108:111], v[180:183], v[52:55]
    s_waitcnt lgkmcnt(4)
    v_exp_f32 v150, v150
    v_mfma_f32_16x16x32_bf16 v[64:67], a[112:115], v[176:179], v[64:67]
    ds_read_b128 a[80:83], v212 offset:53248
    v_mfma_f32_16x16x32_bf16 v[68:71], a[112:115], v[180:183], v[68:71]
    v_exp_f32 v151, v151
    v_mfma_f32_16x16x32_bf16 v[80:83], a[116:119], v[176:179], v[80:83]
    ds_read_b128 a[84:87], v213 offset:53248
    v_cvt_pk_bf16_f32 v187, v150, v151
    v_mfma_f32_16x16x32_bf16 v[84:87], a[116:119], v[180:183], v[84:87]
    v_exp_f32 v152, v152
    v_mfma_f32_16x16x32_bf16 v[96:99], a[120:123], v[176:179], v[96:99]
    ds_read_b128 a[88:91], v214 offset:53248
    v_mfma_f32_16x16x32_bf16 v[100:103], a[120:123], v[180:183], v[100:103]
    v_exp_f32 v153, v153
    v_mfma_f32_16x16x32_bf16 v[112:115], a[124:127], v[176:179], v[112:115]
    ds_read_b128 a[92:95], v215 offset:53248
    v_cvt_pk_bf16_f32 v188, v152, v153
    v_mfma_f32_16x16x32_bf16 v[116:119], a[124:127], v[180:183], v[116:119]
    v_exp_f32 v154, v154
    v_smfmac_f32_16x16x64_bf16 v[192:195], v[208:211], v[176:183], v207
    s_waitcnt vmcnt(12) lgkmcnt(4)
    v_mfma_f32_16x16x32_bf16 a[192:195], a[160:163], a[176:179], a[192:195]
    v_mfma_f32_16x16x32_bf16 a[196:199], a[160:163], a[180:183], a[196:199]
    v_mfma_f32_16x16x32_bf16 a[208:211], a[164:167], a[176:179], a[208:211]
    v_mfma_f32_16x16x32_bf16 a[212:215], a[164:167], a[180:183], a[212:215]
    v_mfma_f32_16x16x32_bf16 a[224:227], a[168:171], a[176:179], a[224:227]
    v_mfma_f32_16x16x32_bf16 a[228:231], a[168:171], a[180:183], a[228:231]
    v_mfma_f32_16x16x32_bf16 a[240:243], a[172:175], a[176:179], a[240:243]
    buffer_load_dwordx4 a[176:179], v245, s[48:51], s87 offen offset:0 sc1
    v_mfma_f32_16x16x32_bf16 a[244:247], a[172:175], a[180:183], a[244:247]
    v_mfma_f32_16x16x32_bf16 a[200:203], a[160:163], a[184:187], a[200:203]
    v_mfma_f32_16x16x32_bf16 a[204:207], a[160:163], a[188:191], a[204:207]
    buffer_load_dwordx4 a[180:183], v245, s[48:51], s87 offen offset:1024 sc1
    v_mfma_f32_16x16x32_bf16 a[216:219], a[164:167], a[184:187], a[216:219]
    v_mfma_f32_16x16x32_bf16 a[220:223], a[164:167], a[188:191], a[220:223]
    v_mfma_f32_16x16x32_bf16 a[232:235], a[168:171], a[184:187], a[232:235]
    buffer_load_dwordx4 a[160:163], v245, s[48:51], s88 offen offset:0 sc1
    v_mfma_f32_16x16x32_bf16 a[236:239], a[168:171], a[188:191], a[236:239]
    v_mfma_f32_16x16x32_bf16 a[248:251], a[172:175], a[184:187], a[248:251]
    v_mfma_f32_16x16x32_bf16 a[252:255], a[172:175], a[188:191], a[252:255]
    buffer_load_dwordx4 a[164:167], v245, s[48:51], s88 offen offset:1024 sc1
    v_mfma_f32_16x16x32_bf16 v[128:131], a[64:67], a[0:3], v[160:163]
    v_mfma_f32_16x16x32_bf16 v[128:131], a[68:71], a[4:7], v[128:131]
    v_exp_f32 v155, v155
    v_mfma_f32_16x16x32_bf16 v[128:131], a[72:75], a[8:11], v[128:131]
    v_cvt_pk_bf16_f32 v189, v154, v155
    v_mfma_f32_16x16x32_bf16 v[128:131], a[76:79], a[12:15], v[128:131]
    s_waitcnt vmcnt(32) lgkmcnt(0)
    v_exp_f32 v156, v156
    v_mfma_f32_16x16x32_bf16 v[132:135], a[80:83], a[0:3], v[160:163]
    s_barrier
    v_mfma_f32_16x16x32_bf16 v[132:135], a[84:87], a[4:7], v[132:135]
    s_add_u32 m0, s55, 12288
    v_exp_f32 v157, v157
    v_mfma_f32_16x16x32_bf16 v[132:135], a[88:91], a[8:11], v[132:135]
    v_cvt_pk_bf16_f32 v190, v156, v157
    v_mfma_f32_16x16x32_bf16 v[132:135], a[92:95], a[12:15], v[132:135]
    v_exp_f32 v158, v158
    v_mfma_f32_16x16x32_bf16 v[136:139], a[64:67], a[16:19], v[164:167]
    buffer_load_dwordx4 v224, s[40:43], s60 offen lds
    v_mfma_f32_16x16x32_bf16 v[136:139], a[68:71], a[20:23], v[136:139]
    v_exp_f32 v159, v159
    v_mfma_f32_16x16x32_bf16 v[136:139], a[72:75], a[24:27], v[136:139]
    v_cvt_pk_bf16_f32 v191, v158, v159
    v_mfma_f32_16x16x32_bf16 v[136:139], a[76:79], a[28:31], v[136:139]
    v_exp_f32 v128, v128
    v_mfma_f32_16x16x32_bf16 v[140:143], a[80:83], a[16:19], v[164:167]
    buffer_load_dwordx4 v225, s[40:43], s60 offen offset:1024 lds
    v_mfma_f32_16x16x32_bf16 v[140:143], a[84:87], a[20:23], v[140:143]
    v_exp_f32 v129, v129
    v_mfma_f32_16x16x32_bf16 v[140:143], a[88:91], a[24:27], v[140:143]
    v_cvt_pk_bf16_f32 v176, v128, v129
    v_mfma_f32_16x16x32_bf16 v[140:143], a[92:95], a[28:31], v[140:143]
    v_exp_f32 v130, v130
    v_mfma_f32_16x16x32_bf16 v[8:11], a[96:99], v[184:187], v[8:11]
    buffer_load_dwordx4 v226, s[44:47], s60 offen offset:2048 lds
    v_mfma_f32_16x16x32_bf16 v[12:15], a[96:99], v[188:191], v[12:15]
    v_exp_f32 v131, v131
    v_mfma_f32_16x16x32_bf16 v[24:27], a[100:103], v[184:187], v[24:27]
    ds_read_b64_tr_b16 a[96:97], v216 offset:10240
    v_cvt_pk_bf16_f32 v177, v130, v131
    v_mfma_f32_16x16x32_bf16 v[28:31], a[100:103], v[188:191], v[28:31]
    v_exp_f32 v132, v132
    v_mfma_f32_16x16x32_bf16 v[40:43], a[104:107], v[184:187], v[40:43]
    buffer_load_dwordx4 v227, s[44:47], s60 offen offset:3072 lds
    ds_read_b64_tr_b16 a[98:99], v216 offset:59392
    v_mfma_f32_16x16x32_bf16 v[44:47], a[104:107], v[188:191], v[44:47]
    s_add_u32 s60, s60, s61
    v_exp_f32 v133, v133
    v_mfma_f32_16x16x32_bf16 v[56:59], a[108:111], v[184:187], v[56:59]
    ds_read_b64_tr_b16 a[100:101], v217 offset:10240
    v_cvt_pk_bf16_f32 v178, v132, v133
    v_mfma_f32_16x16x32_bf16 v[60:63], a[108:111], v[188:191], v[60:63]
    v_exp_f32 v134, v134
    v_mfma_f32_16x16x32_bf16 v[72:75], a[112:115], v[184:187], v[72:75]
    buffer_load_dwordx4 a[168:171], v245, s[48:51], s88 offen offset:2048 sc1
    ds_read_b64_tr_b16 a[102:103], v217 offset:59392
    v_mfma_f32_16x16x32_bf16 v[76:79], a[112:115], v[188:191], v[76:79]
    v_exp_f32 v135, v135
    v_mfma_f32_16x16x32_bf16 v[88:91], a[116:119], v[184:187], v[88:91]
    ds_read_b64_tr_b16 a[104:105], v218 offset:10240
    v_cvt_pk_bf16_f32 v179, v134, v135
    v_mfma_f32_16x16x32_bf16 v[92:95], a[116:119], v[188:191], v[92:95]
    v_exp_f32 v136, v136
    v_mfma_f32_16x16x32_bf16 v[104:107], a[120:123], v[184:187], v[104:107]
    buffer_load_dwordx4 a[172:175], v245, s[48:51], s88 offen offset:3072 sc1
    ds_read_b64_tr_b16 a[106:107], v218 offset:59392
    v_mfma_f32_16x16x32_bf16 v[108:111], a[120:123], v[188:191], v[108:111]
    v_exp_f32 v137, v137
    v_mfma_f32_16x16x32_bf16 v[120:123], a[124:127], v[184:187], v[120:123]
    ds_read_b64_tr_b16 a[108:109], v219 offset:10240
    v_cvt_pk_bf16_f32 v180, v136, v137
    v_mfma_f32_16x16x32_bf16 v[124:127], a[124:127], v[188:191], v[124:127]
    v_exp_f32 v138, v138
    v_smfmac_f32_16x16x64_bf16 v[196:199], v[208:211], v[184:191], v207
    ds_read_b64_tr_b16 a[110:111], v219 offset:59392
    v_mfma_f32_16x16x32_bf16 v[144:147], a[64:67], a[32:35], v[168:171]
    buffer_load_dwordx4 a[184:187], v245, s[48:51], s87 offen offset:2048 sc1
    ds_read_b64_tr_b16 a[112:113], v220 offset:10240
    v_mfma_f32_16x16x32_bf16 v[144:147], a[68:71], a[36:39], v[144:147]
    v_exp_f32 v139, v139
    v_mfma_f32_16x16x32_bf16 v[144:147], a[72:75], a[40:43], v[144:147]
    ds_read_b64_tr_b16 a[114:115], v220 offset:59392
    v_cvt_pk_bf16_f32 v181, v138, v139
    v_mfma_f32_16x16x32_bf16 v[144:147], a[76:79], a[44:47], v[144:147]
    v_exp_f32 v140, v140
    v_mfma_f32_16x16x32_bf16 v[148:151], a[80:83], a[32:35], v[168:171]
    buffer_load_dwordx4 a[188:191], v245, s[48:51], s87 offen offset:3072 sc1
    ds_read_b64_tr_b16 a[116:117], v221 offset:10240
    v_mfma_f32_16x16x32_bf16 v[148:151], a[84:87], a[36:39], v[148:151]
    v_exp_f32 v141, v141
    v_mfma_f32_16x16x32_bf16 v[148:151], a[88:91], a[40:43], v[148:151]
    ds_read_b64_tr_b16 a[118:119], v221 offset:59392
    v_cvt_pk_bf16_f32 v182, v140, v141
    v_mfma_f32_16x16x32_bf16 v[148:151], a[92:95], a[44:47], v[148:151]
    s_mov_b32 s87, s89
    v_exp_f32 v142, v142
    v_mfma_f32_16x16x32_bf16 v[152:155], a[64:67], a[48:51], v[172:175]
    ds_read_b64_tr_b16 a[120:121], v222 offset:10240
    v_mfma_f32_16x16x32_bf16 v[152:155], a[68:71], a[52:55], v[152:155]
    s_mov_b32 s88, s76
    v_exp_f32 v143, v143
    v_mfma_f32_16x16x32_bf16 v[152:155], a[72:75], a[56:59], v[152:155]
    ds_read_b64_tr_b16 a[122:123], v222 offset:59392
    v_cvt_pk_bf16_f32 v183, v142, v143
    v_mfma_f32_16x16x32_bf16 v[152:155], a[76:79], a[60:63], v[152:155]
    s_add_u32 s89, s89, 4096
    v_exp_f32 v144, v144
    v_mfma_f32_16x16x32_bf16 v[156:159], a[80:83], a[48:51], v[172:175]
    ds_read_b64_tr_b16 a[124:125], v223 offset:10240
    v_mfma_f32_16x16x32_bf16 v[156:159], a[84:87], a[52:55], v[156:159]
    s_add_u32 s76, s76, 4096
    v_exp_f32 v145, v145
    v_mfma_f32_16x16x32_bf16 v[156:159], a[88:91], a[56:59], v[156:159]
    ds_read_b64_tr_b16 a[126:127], v223 offset:59392
    v_cvt_pk_bf16_f32 v184, v144, v145
    v_mfma_f32_16x16x32_bf16 v[156:159], a[92:95], a[60:63], v[156:159]
    s_waitcnt lgkmcnt(8)
    v_exp_f32 v146, v146
    v_mfma_f32_16x16x32_bf16 v[0:3], a[96:99], v[176:179], v[0:3]
    ds_read_b128 a[64:67], v212 offset:8192
    v_mfma_f32_16x16x32_bf16 v[4:7], a[96:99], v[180:183], v[4:7]
    v_exp_f32 v147, v147
    v_mfma_f32_16x16x32_bf16 v[16:19], a[100:103], v[176:179], v[16:19]
    ds_read_b128 a[68:71], v213 offset:8192
    v_cvt_pk_bf16_f32 v185, v146, v147
    v_mfma_f32_16x16x32_bf16 v[20:23], a[100:103], v[180:183], v[20:23]
    v_exp_f32 v148, v148
    v_mfma_f32_16x16x32_bf16 v[32:35], a[104:107], v[176:179], v[32:35]
    ds_read_b128 a[72:75], v214 offset:8192
    v_mfma_f32_16x16x32_bf16 v[36:39], a[104:107], v[180:183], v[36:39]
    v_exp_f32 v149, v149
    v_mfma_f32_16x16x32_bf16 v[48:51], a[108:111], v[176:179], v[48:51]
    ds_read_b128 a[76:79], v215 offset:8192
    v_cvt_pk_bf16_f32 v186, v148, v149
    v_mfma_f32_16x16x32_bf16 v[52:55], a[108:111], v[180:183], v[52:55]
    s_waitcnt lgkmcnt(4)
    v_exp_f32 v150, v150
    v_mfma_f32_16x16x32_bf16 v[64:67], a[112:115], v[176:179], v[64:67]
    ds_read_b128 a[80:83], v212 offset:57344
    v_mfma_f32_16x16x32_bf16 v[68:71], a[112:115], v[180:183], v[68:71]
    v_exp_f32 v151, v151
    v_mfma_f32_16x16x32_bf16 v[80:83], a[116:119], v[176:179], v[80:83]
    ds_read_b128 a[84:87], v213 offset:57344
    v_cvt_pk_bf16_f32 v187, v150, v151
    v_mfma_f32_16x16x32_bf16 v[84:87], a[116:119], v[180:183], v[84:87]
    v_exp_f32 v152, v152
    v_mfma_f32_16x16x32_bf16 v[96:99], a[120:123], v[176:179], v[96:99]
    ds_read_b128 a[88:91], v214 offset:57344
    v_mfma_f32_16x16x32_bf16 v[100:103], a[120:123], v[180:183], v[100:103]
    v_exp_f32 v153, v153
    v_mfma_f32_16x16x32_bf16 v[112:115], a[124:127], v[176:179], v[112:115]
    ds_read_b128 a[92:95], v215 offset:57344
    v_cvt_pk_bf16_f32 v188, v152, v153
    v_mfma_f32_16x16x32_bf16 v[116:119], a[124:127], v[180:183], v[116:119]
    v_exp_f32 v154, v154
    v_smfmac_f32_16x16x64_bf16 v[192:195], v[208:211], v[176:183], v207
    s_waitcnt vmcnt(12) lgkmcnt(4)
    v_mfma_f32_16x16x32_bf16 a[192:195], a[128:131], a[144:147], a[192:195]
    v_mfma_f32_16x16x32_bf16 a[196:199], a[128:131], a[148:151], a[196:199]
    v_mfma_f32_16x16x32_bf16 a[208:211], a[132:135], a[144:147], a[208:211]
    v_mfma_f32_16x16x32_bf16 a[212:215], a[132:135], a[148:151], a[212:215]
    v_mfma_f32_16x16x32_bf16 a[224:227], a[136:139], a[144:147], a[224:227]
    v_mfma_f32_16x16x32_bf16 a[228:231], a[136:139], a[148:151], a[228:231]
    v_mfma_f32_16x16x32_bf16 a[240:243], a[140:143], a[144:147], a[240:243]
    buffer_load_dwordx4 a[144:147], v245, s[48:51], s87 offen offset:0 sc1
    v_mfma_f32_16x16x32_bf16 a[244:247], a[140:143], a[148:151], a[244:247]
    v_mfma_f32_16x16x32_bf16 a[200:203], a[128:131], a[152:155], a[200:203]
    v_mfma_f32_16x16x32_bf16 a[204:207], a[128:131], a[156:159], a[204:207]
    buffer_load_dwordx4 a[148:151], v245, s[48:51], s87 offen offset:1024 sc1
    v_mfma_f32_16x16x32_bf16 a[216:219], a[132:135], a[152:155], a[216:219]
    v_mfma_f32_16x16x32_bf16 a[220:223], a[132:135], a[156:159], a[220:223]
    v_mfma_f32_16x16x32_bf16 a[232:235], a[136:139], a[152:155], a[232:235]
    buffer_load_dwordx4 a[128:131], v245, s[48:51], s88 offen offset:0 sc1
    v_mfma_f32_16x16x32_bf16 a[236:239], a[136:139], a[156:159], a[236:239]
    v_mfma_f32_16x16x32_bf16 a[248:251], a[140:143], a[152:155], a[248:251]
    v_mfma_f32_16x16x32_bf16 a[252:255], a[140:143], a[156:159], a[252:255]
    buffer_load_dwordx4 a[132:135], v245, s[48:51], s88 offen offset:1024 sc1
    v_mfma_f32_16x16x32_bf16 v[128:131], a[64:67], a[0:3], v[160:163]
    v_mfma_f32_16x16x32_bf16 v[128:131], a[68:71], a[4:7], v[128:131]
    v_exp_f32 v155, v155
    v_mfma_f32_16x16x32_bf16 v[128:131], a[72:75], a[8:11], v[128:131]
    v_cvt_pk_bf16_f32 v189, v154, v155
    v_mfma_f32_16x16x32_bf16 v[128:131], a[76:79], a[12:15], v[128:131]
    s_waitcnt vmcnt(32) lgkmcnt(0)
    v_exp_f32 v156, v156
    v_mfma_f32_16x16x32_bf16 v[132:135], a[80:83], a[0:3], v[160:163]
    s_barrier
    v_mfma_f32_16x16x32_bf16 v[132:135], a[84:87], a[4:7], v[132:135]
    s_add_u32 m0, s55, 16384
    v_exp_f32 v157, v157
    v_mfma_f32_16x16x32_bf16 v[132:135], a[88:91], a[8:11], v[132:135]
    v_cvt_pk_bf16_f32 v190, v156, v157
    v_mfma_f32_16x16x32_bf16 v[132:135], a[92:95], a[12:15], v[132:135]
    v_exp_f32 v158, v158
    v_mfma_f32_16x16x32_bf16 v[136:139], a[64:67], a[16:19], v[164:167]
    buffer_load_dwordx4 v224, s[40:43], s60 offen lds
    v_mfma_f32_16x16x32_bf16 v[136:139], a[68:71], a[20:23], v[136:139]
    v_exp_f32 v159, v159
    v_mfma_f32_16x16x32_bf16 v[136:139], a[72:75], a[24:27], v[136:139]
    v_cvt_pk_bf16_f32 v191, v158, v159
    v_mfma_f32_16x16x32_bf16 v[136:139], a[76:79], a[28:31], v[136:139]
    v_exp_f32 v128, v128
    v_mfma_f32_16x16x32_bf16 v[140:143], a[80:83], a[16:19], v[164:167]
    buffer_load_dwordx4 v225, s[40:43], s60 offen offset:1024 lds
    v_mfma_f32_16x16x32_bf16 v[140:143], a[84:87], a[20:23], v[140:143]
    v_exp_f32 v129, v129
    v_mfma_f32_16x16x32_bf16 v[140:143], a[88:91], a[24:27], v[140:143]
    v_cvt_pk_bf16_f32 v176, v128, v129
    v_mfma_f32_16x16x32_bf16 v[140:143], a[92:95], a[28:31], v[140:143]
    v_exp_f32 v130, v130
    v_mfma_f32_16x16x32_bf16 v[8:11], a[96:99], v[184:187], v[8:11]
    buffer_load_dwordx4 v226, s[44:47], s60 offen offset:2048 lds
    v_mfma_f32_16x16x32_bf16 v[12:15], a[96:99], v[188:191], v[12:15]
    v_exp_f32 v131, v131
    v_mfma_f32_16x16x32_bf16 v[24:27], a[100:103], v[184:187], v[24:27]
    ds_read_b64_tr_b16 a[96:97], v216 offset:14336
    v_cvt_pk_bf16_f32 v177, v130, v131
    v_mfma_f32_16x16x32_bf16 v[28:31], a[100:103], v[188:191], v[28:31]
    v_exp_f32 v132, v132
    v_mfma_f32_16x16x32_bf16 v[40:43], a[104:107], v[184:187], v[40:43]
    buffer_load_dwordx4 v227, s[44:47], s60 offen offset:3072 lds
    ds_read_b64_tr_b16 a[98:99], v216 offset:63488
    v_mfma_f32_16x16x32_bf16 v[44:47], a[104:107], v[188:191], v[44:47]
    s_add_u32 s60, s60, s61
    v_exp_f32 v133, v133
    v_mfma_f32_16x16x32_bf16 v[56:59], a[108:111], v[184:187], v[56:59]
    ds_read_b64_tr_b16 a[100:101], v217 offset:14336
    v_cvt_pk_bf16_f32 v178, v132, v133
    v_mfma_f32_16x16x32_bf16 v[60:63], a[108:111], v[188:191], v[60:63]
    v_exp_f32 v134, v134
    v_mfma_f32_16x16x32_bf16 v[72:75], a[112:115], v[184:187], v[72:75]
    buffer_load_dwordx4 a[136:139], v245, s[48:51], s88 offen offset:2048 sc1
    ds_read_b64_tr_b16 a[102:103], v217 offset:63488
    v_mfma_f32_16x16x32_bf16 v[76:79], a[112:115], v[188:191], v[76:79]
    v_exp_f32 v135, v135
    v_mfma_f32_16x16x32_bf16 v[88:91], a[116:119], v[184:187], v[88:91]
    ds_read_b64_tr_b16 a[104:105], v218 offset:14336
    v_cvt_pk_bf16_f32 v179, v134, v135
    v_mfma_f32_16x16x32_bf16 v[92:95], a[116:119], v[188:191], v[92:95]
    v_exp_f32 v136, v136
    v_mfma_f32_16x16x32_bf16 v[104:107], a[120:123], v[184:187], v[104:107]
    buffer_load_dwordx4 a[140:143], v245, s[48:51], s88 offen offset:3072 sc1
    ds_read_b64_tr_b16 a[106:107], v218 offset:63488
    v_mfma_f32_16x16x32_bf16 v[108:111], a[120:123], v[188:191], v[108:111]
    v_exp_f32 v137, v137
    v_mfma_f32_16x16x32_bf16 v[120:123], a[124:127], v[184:187], v[120:123]
    ds_read_b64_tr_b16 a[108:109], v219 offset:14336
    v_cvt_pk_bf16_f32 v180, v136, v137
    v_mfma_f32_16x16x32_bf16 v[124:127], a[124:127], v[188:191], v[124:127]
    v_exp_f32 v138, v138
    v_smfmac_f32_16x16x64_bf16 v[196:199], v[208:211], v[184:191], v207
    ds_read_b64_tr_b16 a[110:111], v219 offset:63488
    v_mfma_f32_16x16x32_bf16 v[144:147], a[64:67], a[32:35], v[168:171]
    buffer_load_dwordx4 a[152:155], v245, s[48:51], s87 offen offset:2048 sc1
    ds_read_b64_tr_b16 a[112:113], v220 offset:14336
    v_mfma_f32_16x16x32_bf16 v[144:147], a[68:71], a[36:39], v[144:147]
    s_cmp_eq_u32 s59, 2
    v_exp_f32 v139, v139
    v_mfma_f32_16x16x32_bf16 v[144:147], a[72:75], a[40:43], v[144:147]
    ds_read_b64_tr_b16 a[114:115], v220 offset:63488
    v_cvt_pk_bf16_f32 v181, v138, v139
    v_mfma_f32_16x16x32_bf16 v[144:147], a[76:79], a[44:47], v[144:147]
    s_cselect_b32 s89, 268435456, s89
    v_exp_f32 v140, v140
    v_mfma_f32_16x16x32_bf16 v[148:151], a[80:83], a[32:35], v[168:171]
    buffer_load_dwordx4 a[156:159], v245, s[48:51], s87 offen offset:3072 sc1
    ds_read_b64_tr_b16 a[116:117], v221 offset:14336
    v_mfma_f32_16x16x32_bf16 v[148:151], a[84:87], a[36:39], v[148:151]
    s_cselect_b32 s76, 268435456, s76
    v_exp_f32 v141, v141
    v_mfma_f32_16x16x32_bf16 v[148:151], a[88:91], a[40:43], v[148:151]
    ds_read_b64_tr_b16 a[118:119], v221 offset:63488
    v_cvt_pk_bf16_f32 v182, v140, v141
    v_mfma_f32_16x16x32_bf16 v[148:151], a[92:95], a[44:47], v[148:151]
    s_mov_b32 s87, s89
    v_exp_f32 v142, v142
    v_mfma_f32_16x16x32_bf16 v[152:155], a[64:67], a[48:51], v[172:175]
    ds_read_b64_tr_b16 a[120:121], v222 offset:14336
    v_mfma_f32_16x16x32_bf16 v[152:155], a[68:71], a[52:55], v[152:155]
    s_mov_b32 s88, s76
    v_exp_f32 v143, v143
    v_mfma_f32_16x16x32_bf16 v[152:155], a[72:75], a[56:59], v[152:155]
    ds_read_b64_tr_b16 a[122:123], v222 offset:63488
    v_cvt_pk_bf16_f32 v183, v142, v143
    v_mfma_f32_16x16x32_bf16 v[152:155], a[76:79], a[60:63], v[152:155]
    s_add_u32 s89, s89, 4096
    v_exp_f32 v144, v144
    v_mfma_f32_16x16x32_bf16 v[156:159], a[80:83], a[48:51], v[172:175]
    ds_read_b64_tr_b16 a[124:125], v223 offset:14336
    v_mfma_f32_16x16x32_bf16 v[156:159], a[84:87], a[52:55], v[156:159]
    s_add_u32 s76, s76, 4096
    v_exp_f32 v145, v145
    v_mfma_f32_16x16x32_bf16 v[156:159], a[88:91], a[56:59], v[156:159]
    ds_read_b64_tr_b16 a[126:127], v223 offset:63488
    v_cvt_pk_bf16_f32 v184, v144, v145
    v_mfma_f32_16x16x32_bf16 v[156:159], a[92:95], a[60:63], v[156:159]
    s_waitcnt lgkmcnt(8)
    v_exp_f32 v146, v146
    v_mfma_f32_16x16x32_bf16 v[0:3], a[96:99], v[176:179], v[0:3]
    ds_read_b128 a[64:67], v212 offset:12288
    v_mfma_f32_16x16x32_bf16 v[4:7], a[96:99], v[180:183], v[4:7]
    v_exp_f32 v147, v147
    v_mfma_f32_16x16x32_bf16 v[16:19], a[100:103], v[176:179], v[16:19]
    ds_read_b128 a[68:71], v213 offset:12288
    v_cvt_pk_bf16_f32 v185, v146, v147
    v_mfma_f32_16x16x32_bf16 v[20:23], a[100:103], v[180:183], v[20:23]
    v_exp_f32 v148, v148
    v_mfma_f32_16x16x32_bf16 v[32:35], a[104:107], v[176:179], v[32:35]
    ds_read_b128 a[72:75], v214 offset:12288
    v_mfma_f32_16x16x32_bf16 v[36:39], a[104:107], v[180:183], v[36:39]
    v_exp_f32 v149, v149
    v_mfma_f32_16x16x32_bf16 v[48:51], a[108:111], v[176:179], v[48:51]
    ds_read_b128 a[76:79], v215 offset:12288
    v_cvt_pk_bf16_f32 v186, v148, v149
    v_mfma_f32_16x16x32_bf16 v[52:55], a[108:111], v[180:183], v[52:55]
    s_waitcnt lgkmcnt(4)
    v_exp_f32 v150, v150
    v_mfma_f32_16x16x32_bf16 v[64:67], a[112:115], v[176:179], v[64:67]
    ds_read_b128 a[80:83], v212 offset:61440
    v_mfma_f32_16x16x32_bf16 v[68:71], a[112:115], v[180:183], v[68:71]
    v_exp_f32 v151, v151
    v_mfma_f32_16x16x32_bf16 v[80:83], a[116:119], v[176:179], v[80:83]
    ds_read_b128 a[84:87], v213 offset:61440
    v_cvt_pk_bf16_f32 v187, v150, v151
    v_mfma_f32_16x16x32_bf16 v[84:87], a[116:119], v[180:183], v[84:87]
    v_exp_f32 v152, v152
    v_mfma_f32_16x16x32_bf16 v[96:99], a[120:123], v[176:179], v[96:99]
    ds_read_b128 a[88:91], v214 offset:61440
    v_mfma_f32_16x16x32_bf16 v[100:103], a[120:123], v[180:183], v[100:103]
    v_exp_f32 v153, v153
    v_mfma_f32_16x16x32_bf16 v[112:115], a[124:127], v[176:179], v[112:115]
    ds_read_b128 a[92:95], v215 offset:61440
    v_cvt_pk_bf16_f32 v188, v152, v153
    v_mfma_f32_16x16x32_bf16 v[116:119], a[124:127], v[180:183], v[116:119]
    v_exp_f32 v154, v154
    v_smfmac_f32_16x16x64_bf16 v[192:195], v[208:211], v[176:183], v207
    s_waitcnt vmcnt(12) lgkmcnt(4)
    v_mfma_f32_16x16x32_bf16 a[192:195], a[160:163], a[176:179], a[192:195]
    v_mfma_f32_16x16x32_bf16 a[196:199], a[160:163], a[180:183], a[196:199]
    v_mfma_f32_16x16x32_bf16 a[208:211], a[164:167], a[176:179], a[208:211]
    v_mfma_f32_16x16x32_bf16 a[212:215], a[164:167], a[180:183], a[212:215]
    v_mfma_f32_16x16x32_bf16 a[224:227], a[168:171], a[176:179], a[224:227]
    v_mfma_f32_16x16x32_bf16 a[228:231], a[168:171], a[180:183], a[228:231]
    v_mfma_f32_16x16x32_bf16 a[240:243], a[172:175], a[176:179], a[240:243]
    buffer_load_dwordx4 a[176:179], v245, s[48:51], s87 offen offset:0 sc1
    v_mfma_f32_16x16x32_bf16 a[244:247], a[172:175], a[180:183], a[244:247]
    v_mfma_f32_16x16x32_bf16 a[200:203], a[160:163], a[184:187], a[200:203]
    v_mfma_f32_16x16x32_bf16 a[204:207], a[160:163], a[188:191], a[204:207]
    buffer_load_dwordx4 a[180:183], v245, s[48:51], s87 offen offset:1024 sc1
    v_mfma_f32_16x16x32_bf16 a[216:219], a[164:167], a[184:187], a[216:219]
    v_mfma_f32_16x16x32_bf16 a[220:223], a[164:167], a[188:191], a[220:223]
    v_mfma_f32_16x16x32_bf16 a[232:235], a[168:171], a[184:187], a[232:235]
    buffer_load_dwordx4 a[160:163], v245, s[48:51], s88 offen offset:0 sc1
    v_mfma_f32_16x16x32_bf16 a[236:239], a[168:171], a[188:191], a[236:239]
    v_mfma_f32_16x16x32_bf16 a[248:251], a[172:175], a[184:187], a[248:251]
    v_mfma_f32_16x16x32_bf16 a[252:255], a[172:175], a[188:191], a[252:255]
    buffer_load_dwordx4 a[164:167], v245, s[48:51], s88 offen offset:1024 sc1
    v_mfma_f32_16x16x32_bf16 v[128:131], a[64:67], a[0:3], v[160:163]
    v_mfma_f32_16x16x32_bf16 v[128:131], a[68:71], a[4:7], v[128:131]
    v_exp_f32 v155, v155
    v_mfma_f32_16x16x32_bf16 v[128:131], a[72:75], a[8:11], v[128:131]
    v_cvt_pk_bf16_f32 v189, v154, v155
    v_mfma_f32_16x16x32_bf16 v[128:131], a[76:79], a[12:15], v[128:131]
    s_waitcnt vmcnt(32) lgkmcnt(0)
    v_exp_f32 v156, v156
    v_mfma_f32_16x16x32_bf16 v[132:135], a[80:83], a[0:3], v[160:163]
    s_barrier
    v_mfma_f32_16x16x32_bf16 v[132:135], a[84:87], a[4:7], v[132:135]
    s_add_u32 m0, s55, 20480
    v_exp_f32 v157, v157
    v_mfma_f32_16x16x32_bf16 v[132:135], a[88:91], a[8:11], v[132:135]
    v_cvt_pk_bf16_f32 v190, v156, v157
    v_mfma_f32_16x16x32_bf16 v[132:135], a[92:95], a[12:15], v[132:135]
    v_exp_f32 v158, v158
    v_mfma_f32_16x16x32_bf16 v[136:139], a[64:67], a[16:19], v[164:167]
    buffer_load_dwordx4 v224, s[40:43], s60 offen lds
    v_mfma_f32_16x16x32_bf16 v[136:139], a[68:71], a[20:23], v[136:139]
    v_exp_f32 v159, v159
    v_mfma_f32_16x16x32_bf16 v[136:139], a[72:75], a[24:27], v[136:139]
    v_cvt_pk_bf16_f32 v191, v158, v159
    v_mfma_f32_16x16x32_bf16 v[136:139], a[76:79], a[28:31], v[136:139]
    v_exp_f32 v128, v128
    v_mfma_f32_16x16x32_bf16 v[140:143], a[80:83], a[16:19], v[164:167]
    buffer_load_dwordx4 v225, s[40:43], s60 offen offset:1024 lds
    v_mfma_f32_16x16x32_bf16 v[140:143], a[84:87], a[20:23], v[140:143]
    v_exp_f32 v129, v129
    v_mfma_f32_16x16x32_bf16 v[140:143], a[88:91], a[24:27], v[140:143]
    v_cvt_pk_bf16_f32 v176, v128, v129
    v_mfma_f32_16x16x32_bf16 v[140:143], a[92:95], a[28:31], v[140:143]
    v_exp_f32 v130, v130
    v_mfma_f32_16x16x32_bf16 v[8:11], a[96:99], v[184:187], v[8:11]
    buffer_load_dwordx4 v226, s[44:47], s60 offen offset:2048 lds
    v_mfma_f32_16x16x32_bf16 v[12:15], a[96:99], v[188:191], v[12:15]
    v_exp_f32 v131, v131
    v_mfma_f32_16x16x32_bf16 v[24:27], a[100:103], v[184:187], v[24:27]
    ds_read_b64_tr_b16 a[96:97], v216 offset:2048
    v_cvt_pk_bf16_f32 v177, v130, v131
    v_mfma_f32_16x16x32_bf16 v[28:31], a[100:103], v[188:191], v[28:31]
    v_exp_f32 v132, v132
    v_mfma_f32_16x16x32_bf16 v[40:43], a[104:107], v[184:187], v[40:43]
    buffer_load_dwordx4 v227, s[44:47], s60 offen offset:3072 lds
    ds_read_b64_tr_b16 a[98:99], v216 offset:51200
    v_mfma_f32_16x16x32_bf16 v[44:47], a[104:107], v[188:191], v[44:47]
    s_add_u32 s60, s60, s61
    v_exp_f32 v133, v133
    v_mfma_f32_16x16x32_bf16 v[56:59], a[108:111], v[184:187], v[56:59]
    ds_read_b64_tr_b16 a[100:101], v217 offset:2048
    v_cvt_pk_bf16_f32 v178, v132, v133
    v_mfma_f32_16x16x32_bf16 v[60:63], a[108:111], v[188:191], v[60:63]
    v_exp_f32 v134, v134
    v_mfma_f32_16x16x32_bf16 v[72:75], a[112:115], v[184:187], v[72:75]
    buffer_load_dwordx4 a[168:171], v245, s[48:51], s88 offen offset:2048 sc1
    ds_read_b64_tr_b16 a[102:103], v217 offset:51200
    v_mfma_f32_16x16x32_bf16 v[76:79], a[112:115], v[188:191], v[76:79]
    v_exp_f32 v135, v135
    v_mfma_f32_16x16x32_bf16 v[88:91], a[116:119], v[184:187], v[88:91]
    ds_read_b64_tr_b16 a[104:105], v218 offset:2048
    v_cvt_pk_bf16_f32 v179, v134, v135
    v_mfma_f32_16x16x32_bf16 v[92:95], a[116:119], v[188:191], v[92:95]
    v_exp_f32 v136, v136
    v_mfma_f32_16x16x32_bf16 v[104:107], a[120:123], v[184:187], v[104:107]
    buffer_load_dwordx4 a[172:175], v245, s[48:51], s88 offen offset:3072 sc1
    ds_read_b64_tr_b16 a[106:107], v218 offset:51200
    v_mfma_f32_16x16x32_bf16 v[108:111], a[120:123], v[188:191], v[108:111]
    v_exp_f32 v137, v137
    v_mfma_f32_16x16x32_bf16 v[120:123], a[124:127], v[184:187], v[120:123]
    ds_read_b64_tr_b16 a[108:109], v219 offset:2048
    v_cvt_pk_bf16_f32 v180, v136, v137
    v_mfma_f32_16x16x32_bf16 v[124:127], a[124:127], v[188:191], v[124:127]
    v_exp_f32 v138, v138
    v_smfmac_f32_16x16x64_bf16 v[196:199], v[208:211], v[184:191], v207
    ds_read_b64_tr_b16 a[110:111], v219 offset:51200
    v_mfma_f32_16x16x32_bf16 v[144:147], a[64:67], a[32:35], v[168:171]
    buffer_load_dwordx4 a[184:187], v245, s[48:51], s87 offen offset:2048 sc1
    ds_read_b64_tr_b16 a[112:113], v220 offset:2048
    v_mfma_f32_16x16x32_bf16 v[144:147], a[68:71], a[36:39], v[144:147]
    v_exp_f32 v139, v139
    v_mfma_f32_16x16x32_bf16 v[144:147], a[72:75], a[40:43], v[144:147]
    ds_read_b64_tr_b16 a[114:115], v220 offset:51200
    v_cvt_pk_bf16_f32 v181, v138, v139
    v_mfma_f32_16x16x32_bf16 v[144:147], a[76:79], a[44:47], v[144:147]
    v_exp_f32 v140, v140
    v_mfma_f32_16x16x32_bf16 v[148:151], a[80:83], a[32:35], v[168:171]
    buffer_load_dwordx4 a[188:191], v245, s[48:51], s87 offen offset:3072 sc1
    ds_read_b64_tr_b16 a[116:117], v221 offset:2048
    v_mfma_f32_16x16x32_bf16 v[148:151], a[84:87], a[36:39], v[148:151]
    v_exp_f32 v141, v141
    v_mfma_f32_16x16x32_bf16 v[148:151], a[88:91], a[40:43], v[148:151]
    ds_read_b64_tr_b16 a[118:119], v221 offset:51200
    v_cvt_pk_bf16_f32 v182, v140, v141
    v_mfma_f32_16x16x32_bf16 v[148:151], a[92:95], a[44:47], v[148:151]
    s_mov_b32 s87, s89
    v_exp_f32 v142, v142
    v_mfma_f32_16x16x32_bf16 v[152:155], a[64:67], a[48:51], v[172:175]
    ds_read_b64_tr_b16 a[120:121], v222 offset:2048
    v_mfma_f32_16x16x32_bf16 v[152:155], a[68:71], a[52:55], v[152:155]
    s_mov_b32 s88, s76
    v_exp_f32 v143, v143
    v_mfma_f32_16x16x32_bf16 v[152:155], a[72:75], a[56:59], v[152:155]
    ds_read_b64_tr_b16 a[122:123], v222 offset:51200
    v_cvt_pk_bf16_f32 v183, v142, v143
    v_mfma_f32_16x16x32_bf16 v[152:155], a[76:79], a[60:63], v[152:155]
    s_add_u32 s89, s89, 4096
    v_exp_f32 v144, v144
    v_mfma_f32_16x16x32_bf16 v[156:159], a[80:83], a[48:51], v[172:175]
    ds_read_b64_tr_b16 a[124:125], v223 offset:2048
    v_mfma_f32_16x16x32_bf16 v[156:159], a[84:87], a[52:55], v[156:159]
    s_add_u32 s76, s76, 4096
    v_exp_f32 v145, v145
    v_mfma_f32_16x16x32_bf16 v[156:159], a[88:91], a[56:59], v[156:159]
    ds_read_b64_tr_b16 a[126:127], v223 offset:51200
    v_cvt_pk_bf16_f32 v184, v144, v145
    v_mfma_f32_16x16x32_bf16 v[156:159], a[92:95], a[60:63], v[156:159]
    s_waitcnt lgkmcnt(8)
    v_exp_f32 v146, v146
    v_mfma_f32_16x16x32_bf16 v[0:3], a[96:99], v[176:179], v[0:3]
    ds_read_b128 a[64:67], v212 offset:0
    v_mfma_f32_16x16x32_bf16 v[4:7], a[96:99], v[180:183], v[4:7]
    v_exp_f32 v147, v147
    v_mfma_f32_16x16x32_bf16 v[16:19], a[100:103], v[176:179], v[16:19]
    ds_read_b128 a[68:71], v213 offset:0
    v_cvt_pk_bf16_f32 v185, v146, v147
    v_mfma_f32_16x16x32_bf16 v[20:23], a[100:103], v[180:183], v[20:23]
    v_exp_f32 v148, v148
    v_mfma_f32_16x16x32_bf16 v[32:35], a[104:107], v[176:179], v[32:35]
    ds_read_b128 a[72:75], v214 offset:0
    v_mfma_f32_16x16x32_bf16 v[36:39], a[104:107], v[180:183], v[36:39]
    v_exp_f32 v149, v149
    v_mfma_f32_16x16x32_bf16 v[48:51], a[108:111], v[176:179], v[48:51]
    ds_read_b128 a[76:79], v215 offset:0
    v_cvt_pk_bf16_f32 v186, v148, v149
    v_mfma_f32_16x16x32_bf16 v[52:55], a[108:111], v[180:183], v[52:55]
    s_waitcnt lgkmcnt(4)
    v_exp_f32 v150, v150
    v_mfma_f32_16x16x32_bf16 v[64:67], a[112:115], v[176:179], v[64:67]
    ds_read_b128 a[80:83], v212 offset:49152
    v_mfma_f32_16x16x32_bf16 v[68:71], a[112:115], v[180:183], v[68:71]
    v_exp_f32 v151, v151
    v_mfma_f32_16x16x32_bf16 v[80:83], a[116:119], v[176:179], v[80:83]
    ds_read_b128 a[84:87], v213 offset:49152
    v_cvt_pk_bf16_f32 v187, v150, v151
    v_mfma_f32_16x16x32_bf16 v[84:87], a[116:119], v[180:183], v[84:87]
    v_exp_f32 v152, v152
    v_mfma_f32_16x16x32_bf16 v[96:99], a[120:123], v[176:179], v[96:99]
    ds_read_b128 a[88:91], v214 offset:49152
    v_mfma_f32_16x16x32_bf16 v[100:103], a[120:123], v[180:183], v[100:103]
    s_sub_u32 s59, s59, 1
    v_exp_f32 v153, v153
    v_mfma_f32_16x16x32_bf16 v[112:115], a[124:127], v[176:179], v[112:115]
    ds_read_b128 a[92:95], v215 offset:49152
    v_cvt_pk_bf16_f32 v188, v152, v153
    v_mfma_f32_16x16x32_bf16 v[116:119], a[124:127], v[180:183], v[116:119]
    v_exp_f32 v154, v154
    v_smfmac_f32_16x16x64_bf16 v[192:195], v[208:211], v[176:183], v207
    s_waitcnt vmcnt(12) lgkmcnt(4)
    v_mfma_f32_16x16x32_bf16 a[192:195], a[128:131], a[144:147], a[192:195]
    v_mfma_f32_16x16x32_bf16 a[196:199], a[128:131], a[148:151], a[196:199]
    s_cmp_lg_u32 s59, 1
    v_mfma_f32_16x16x32_bf16 a[208:211], a[132:135], a[144:147], a[208:211]
    v_mfma_f32_16x16x32_bf16 a[212:215], a[132:135], a[148:151], a[212:215]
    v_mfma_f32_16x16x32_bf16 a[224:227], a[136:139], a[144:147], a[224:227]
    v_mfma_f32_16x16x32_bf16 a[228:231], a[136:139], a[148:151], a[228:231]
    v_mfma_f32_16x16x32_bf16 a[240:243], a[140:143], a[144:147], a[240:243]
    buffer_load_dwordx4 a[144:147], v245, s[48:51], s87 offen offset:0 sc1
    v_mfma_f32_16x16x32_bf16 a[244:247], a[140:143], a[148:151], a[244:247]
    v_mfma_f32_16x16x32_bf16 a[200:203], a[128:131], a[152:155], a[200:203]
    v_mfma_f32_16x16x32_bf16 a[204:207], a[128:131], a[156:159], a[204:207]
    buffer_load_dwordx4 a[148:151], v245, s[48:51], s87 offen offset:1024 sc1
    v_mfma_f32_16x16x32_bf16 a[216:219], a[132:135], a[152:155], a[216:219]
    v_mfma_f32_16x16x32_bf16 a[220:223], a[132:135], a[156:159], a[220:223]
    v_mfma_f32_16x16x32_bf16 a[232:235], a[136:139], a[152:155], a[232:235]
    buffer_load_dwordx4 a[128:131], v245, s[48:51], s88 offen offset:0 sc1
    v_mfma_f32_16x16x32_bf16 a[236:239], a[136:139], a[156:159], a[236:239]
    v_mfma_f32_16x16x32_bf16 a[248:251], a[140:143], a[152:155], a[248:251]
    v_mfma_f32_16x16x32_bf16 a[252:255], a[140:143], a[156:159], a[252:255]
    buffer_load_dwordx4 a[132:135], v245, s[48:51], s88 offen offset:1024 sc1
    s_cbranch_scc1 L_ATT2
    s_lshl_b32 s66, s63, 13
    s_lshl_b32 s67, s53, 19
    s_add_u32 s66, s66, s67
    buffer_load_dword v251, v252, s[32:35], s66 offen
    s_add_u32 s66, s66, 8192
    s_branch L_ATT
M_DRAIN:
    v_exp_f32 v155, v155
    v_exp_f32 v156, v156
    v_exp_f32 v157, v157
    v_exp_f32 v158, v158
    v_exp_f32 v159, v159
    v_mfma_f32_16x16x32_bf16 v[8:11], a[96:99], v[184:187], v[8:11]
    v_cvt_pk_bf16_f32 v189, v154, v155
    v_mfma_f32_16x16x32_bf16 v[24:27], a[100:103], v[184:187], v[24:27]
    v_cvt_pk_bf16_f32 v190, v156, v157
    v_mfma_f32_16x16x32_bf16 v[40:43], a[104:107], v[184:187], v[40:43]
    v_cvt_pk_bf16_f32 v191, v158, v159
    v_mfma_f32_16x16x32_bf16 v[56:59], a[108:111], v[184:187], v[56:59]
    v_mfma_f32_16x16x32_bf16 v[72:75], a[112:115], v[184:187], v[72:75]
    v_smfmac_f32_16x16x64_bf16 v[196:199], v[208:211], v[184:191], v207
    v_mfma_f32_16x16x32_bf16 v[88:91], a[116:119], v[184:187], v[88:91]
    v_mfma_f32_16x16x32_bf16 v[104:107], a[120:123], v[184:187], v[104:107]
    v_mfma_f32_16x16x32_bf16 v[120:123], a[124:127], v[184:187], v[120:123]
    v_mfma_f32_16x16x32_bf16 v[12:15], a[96:99], v[188:191], v[12:15]
    v_mfma_f32_16x16x32_bf16 v[28:31], a[100:103], v[188:191], v[28:31]
    v_mfma_f32_16x16x32_bf16 v[44:47], a[104:107], v[188:191], v[44:47]
    v_mfma_f32_16x16x32_bf16 v[60:63], a[108:111], v[188:191], v[60:63]
    v_mfma_f32_16x16x32_bf16 v[76:79], a[112:115], v[188:191], v[76:79]
    v_mfma_f32_16x16x32_bf16 v[92:95], a[116:119], v[188:191], v[92:95]
    v_mfma_f32_16x16x32_bf16 v[108:111], a[120:123], v[188:191], v[108:111]
    v_mfma_f32_16x16x32_bf16 v[124:127], a[124:127], v[188:191], v[124:127]
    v_add_f32 v192, v192, v193
    v_add_f32 v194, v194, v195
    v_add_f32 v196, v196, v197
    v_add_f32 v198, v198, v199
    v_mov_b32 v128, v192
    v_mov_b32 v129, v194
    v_mov_b32 v130, v196
    v_mov_b32 v131, v198
    v_permlane16_swap_b32 v128, v192
    v_permlane16_swap_b32 v129, v194
    v_permlane16_swap_b32 v130, v196
    v_permlane16_swap_b32 v131, v198
    v_add_f32 v192, v192, v128
    v_add_f32 v194, v194, v129
    v_add_f32 v196, v196, v130
    v_add_f32 v198, v198, v131
    v_mov_b32 v128, v192
    v_mov_b32 v129, v194
    v_mov_b32 v130, v196
    v_mov_b32 v131, v198
    v_permlane32_swap_b32 v128, v192
    v_permlane32_swap_b32 v129, v194
    v_permlane32_swap_b32 v130, v196
    v_permlane32_swap_b32 v131, v198
    v_add_f32 v192, v192, v128
    v_add_f32 v194, v194, v129
    v_add_f32 v196, v196, v130
    v_add_f32 v198, v198, v131
    v_add_f32 v128, v192, v194
    v_add_f32 v129, v196, v198
    v_add_f32 v128, v128, v129
    s_mov_b32 s64, 0x5f800000
    v_cmp_nge_f32 vcc, s64, v128
    s_mov_b32 s56, s60
    s_add_u32 s57, s56, 14336
    s_add_u32 s92, s92, 3
    s_mov_b32 s76, 0
    v_add_u32 v244, s76, v245
    s_cbranch_vccnz M_SLOW
M_NORM:
    v_rcp_f32 v132, v192
    v_rcp_f32 v134, v194
    v_rcp_f32 v136, v196
    v_rcp_f32 v138, v198
    s_lshl_b32 s64, s52, 14
    v_add_u32 v140, s64, v245
    v_pk_mul_f32 v[0:1], v[0:1], v[132:133] op_sel_hi:[1,0]
    v_pk_mul_f32 v[2:3], v[2:3], v[132:133] op_sel_hi:[1,0]
    v_pk_mul_f32 v[16:17], v[16:17], v[132:133] op_sel_hi:[1,0]
    v_pk_mul_f32 v[18:19], v[18:19], v[132:133] op_sel_hi:[1,0]
    v_cvt_pk_bf16_f32 v144, v0, v1
    v_cvt_pk_bf16_f32 v145, v2, v3
    v_cvt_pk_bf16_f32 v146, v16, v17
    v_cvt_pk_bf16_f32 v147, v18, v19
    ds_write_b128 v140, v[144:147] offset:0
    v_pk_mul_f32 v[4:5], v[4:5], v[134:135] op_sel_hi:[1,0]
    v_pk_mul_f32 v[6:7], v[6:7], v[134:135] op_sel_hi:[1,0]
    v_pk_mul_f32 v[20:21], v[20:21], v[134:135] op_sel_hi:[1,0]
    v_pk_mul_f32 v[22:23], v[22:23], v[134:135] op_sel_hi:[1,0]
    v_cvt_pk_bf16_f32 v148, v4, v5
    v_cvt_pk_bf16_f32 v149, v6, v7
    v_cvt_pk_bf16_f32 v150, v20, v21
    v_cvt_pk_bf16_f32 v151, v22, v23
    ds_write_b128 v140, v[148:151] offset:1024
    v_pk_mul_f32 v[8:9], v[8:9], v[136:137] op_sel_hi:[1,0]
    v_pk_mul_f32 v[10:11], v[10:11], v[136:137] op_sel_hi:[1,0]
    v_pk_mul_f32 v[24:25], v[24:25], v[136:137] op_sel_hi:[1,0]
    v_pk_mul_f32 v[26:27], v[26:27], v[136:137] op_sel_hi:[1,0]
    v_cvt_pk_bf16_f32 v152, v8, v9
    v_cvt_pk_bf16_f32 v153, v10, v11
    v_cvt_pk_bf16_f32 v154, v24, v25
    v_cvt_pk_bf16_f32 v155, v26, v27
    ds_write_b128 v140, v[152:155] offset:2048
    v_pk_mul_f32 v[12:13], v[12:13], v[138:139] op_sel_hi:[1,0]
    v_pk_mul_f32 v[14:15], v[14:15], v[138:139] op_sel_hi:[1,0]
    v_pk_mul_f32 v[28:29], v[28:29], v[138:139] op_sel_hi:[1,0]
    v_pk_mul_f32 v[30:31], v[30:31], v[138:139] op_sel_hi:[1,0]
    v_cvt_pk_bf16_f32 v156, v12, v13
    v_cvt_pk_bf16_f32 v157, v14, v15
    v_cvt_pk_bf16_f32 v158, v28, v29
    v_cvt_pk_bf16_f32 v159, v30, v31
    ds_write_b128 v140, v[156:159] offset:3072
    v_pk_mul_f32 v[32:33], v[32:33], v[132:133] op_sel_hi:[1,0]
    v_pk_mul_f32 v[34:35], v[34:35], v[132:133] op_sel_hi:[1,0]
    v_pk_mul_f32 v[48:49], v[48:49], v[132:133] op_sel_hi:[1,0]
    v_pk_mul_f32 v[50:51], v[50:51], v[132:133] op_sel_hi:[1,0]
    v_cvt_pk_bf16_f32 v144, v32, v33
    v_cvt_pk_bf16_f32 v145, v34, v35
    v_cvt_pk_bf16_f32 v146, v48, v49
    v_cvt_pk_bf16_f32 v147, v50, v51
    ds_write_b128 v140, v[144:147] offset:4096
    v_pk_mul_f32 v[36:37], v[36:37], v[134:135] op_sel_hi:[1,0]
    v_pk_mul_f32 v[38:39], v[38:39], v[134:135] op_sel_hi:[1,0]
    v_pk_mul_f32 v[52:53], v[52:53], v[134:135] op_sel_hi:[1,0]
    v_pk_mul_f32 v[54:55], v[54:55], v[134:135] op_sel_hi:[1,0]
    v_cvt_pk_bf16_f32 v148, v36, v37
    v_cvt_pk_bf16_f32 v149, v38, v39
    v_cvt_pk_bf16_f32 v150, v52, v53
    v_cvt_pk_bf16_f32 v151, v54, v55
    ds_write_b128 v140, v[148:151] offset:5120
    v_pk_mul_f32 v[40:41], v[40:41], v[136:137] op_sel_hi:[1,0]
    v_pk_mul_f32 v[42:43], v[42:43], v[136:137] op_sel_hi:[1,0]
    v_pk_mul_f32 v[56:57], v[56:57], v[136:137] op_sel_hi:[1,0]
    v_pk_mul_f32 v[58:59], v[58:59], v[136:137] op_sel_hi:[1,0]
    v_cvt_pk_bf16_f32 v152, v40, v41
    v_cvt_pk_bf16_f32 v153, v42, v43
    v_cvt_pk_bf16_f32 v154, v56, v57
    v_cvt_pk_bf16_f32 v155, v58, v59
    ds_write_b128 v140, v[152:155] offset:6144
    v_pk_mul_f32 v[44:45], v[44:45], v[138:139] op_sel_hi:[1,0]
    v_pk_mul_f32 v[46:47], v[46:47], v[138:139] op_sel_hi:[1,0]
    v_pk_mul_f32 v[60:61], v[60:61], v[138:139] op_sel_hi:[1,0]
    v_pk_mul_f32 v[62:63], v[62:63], v[138:139] op_sel_hi:[1,0]
    v_cvt_pk_bf16_f32 v156, v44, v45
    v_cvt_pk_bf16_f32 v157, v46, v47
    v_cvt_pk_bf16_f32 v158, v60, v61
    v_cvt_pk_bf16_f32 v159, v62, v63
    ds_write_b128 v140, v[156:159] offset:7168
    v_pk_mul_f32 v[64:65], v[64:65], v[132:133] op_sel_hi:[1,0]
    v_pk_mul_f32 v[66:67], v[66:67], v[132:133] op_sel_hi:[1,0]
    v_pk_mul_f32 v[80:81], v[80:81], v[132:133] op_sel_hi:[1,0]
    v_pk_mul_f32 v[82:83], v[82:83], v[132:133] op_sel_hi:[1,0]
    v_cvt_pk_bf16_f32 v144, v64, v65
    v_cvt_pk_bf16_f32 v145, v66, v67
    v_cvt_pk_bf16_f32 v146, v80, v81
    v_cvt_pk_bf16_f32 v147, v82, v83
    ds_write_b128 v140, v[144:147] offset:8192
    v_pk_mul_f32 v[68:69], v[68:69], v[134:135] op_sel_hi:[1,0]
    v_pk_mul_f32 v[70:71], v[70:71], v[134:135] op_sel_hi:[1,0]
    v_pk_mul_f32 v[84:85], v[84:85], v[134:135] op_sel_hi:[1,0]
    v_pk_mul_f32 v[86:87], v[86:87], v[134:135] op_sel_hi:[1,0]
    v_cvt_pk_bf16_f32 v148, v68, v69
    v_cvt_pk_bf16_f32 v149, v70, v71
    v_cvt_pk_bf16_f32 v150, v84, v85
    v_cvt_pk_bf16_f32 v151, v86, v87
    ds_write_b128 v140, v[148:151] offset:9216
    v_pk_mul_f32 v[72:73], v[72:73], v[136:137] op_sel_hi:[1,0]
    v_pk_mul_f32 v[74:75], v[74:75], v[136:137] op_sel_hi:[1,0]
    v_pk_mul_f32 v[88:89], v[88:89], v[136:137] op_sel_hi:[1,0]
    v_pk_mul_f32 v[90:91], v[90:91], v[136:137] op_sel_hi:[1,0]
    v_cvt_pk_bf16_f32 v152, v72, v73
    v_cvt_pk_bf16_f32 v153, v74, v75
    v_cvt_pk_bf16_f32 v154, v88, v89
    v_cvt_pk_bf16_f32 v155, v90, v91
    ds_write_b128 v140, v[152:155] offset:10240
    v_pk_mul_f32 v[76:77], v[76:77], v[138:139] op_sel_hi:[1,0]
    v_pk_mul_f32 v[78:79], v[78:79], v[138:139] op_sel_hi:[1,0]
    v_pk_mul_f32 v[92:93], v[92:93], v[138:139] op_sel_hi:[1,0]
    v_pk_mul_f32 v[94:95], v[94:95], v[138:139] op_sel_hi:[1,0]
    v_cvt_pk_bf16_f32 v156, v76, v77
    v_cvt_pk_bf16_f32 v157, v78, v79
    v_cvt_pk_bf16_f32 v158, v92, v93
    v_cvt_pk_bf16_f32 v159, v94, v95
    ds_write_b128 v140, v[156:159] offset:11264
    v_pk_mul_f32 v[96:97], v[96:97], v[132:133] op_sel_hi:[1,0]
    v_pk_mul_f32 v[98:99], v[98:99], v[132:133] op_sel_hi:[1,0]
    v_pk_mul_f32 v[112:113], v[112:113], v[132:133] op_sel_hi:[1,0]
    v_pk_mul_f32 v[114:115], v[114:115], v[132:133] op_sel_hi:[1,0]
    v_cvt_pk_bf16_f32 v144, v96, v97
    v_cvt_pk_bf16_f32 v145, v98, v99
    v_cvt_pk_bf16_f32 v146, v112, v113
    v_cvt_pk_bf16_f32 v147, v114, v115
    ds_write_b128 v140, v[144:147] offset:12288
    v_pk_mul_f32 v[100:101], v[100:101], v[134:135] op_sel_hi:[1,0]
    v_pk_mul_f32 v[102:103], v[102:103], v[134:135] op_sel_hi:[1,0]
    v_pk_mul_f32 v[116:117], v[116:117], v[134:135] op_sel_hi:[1,0]
    v_pk_mul_f32 v[118:119], v[118:119], v[134:135] op_sel_hi:[1,0]
    v_cvt_pk_bf16_f32 v148, v100, v101
    v_cvt_pk_bf16_f32 v149, v102, v103
    v_cvt_pk_bf16_f32 v150, v116, v117
    v_cvt_pk_bf16_f32 v151, v118, v119
    ds_write_b128 v140, v[148:151] offset:13312
    v_pk_mul_f32 v[104:105], v[104:105], v[136:137] op_sel_hi:[1,0]
    v_pk_mul_f32 v[106:107], v[106:107], v[136:137] op_sel_hi:[1,0]
    v_pk_mul_f32 v[120:121], v[120:121], v[136:137] op_sel_hi:[1,0]
    v_pk_mul_f32 v[122:123], v[122:123], v[136:137] op_sel_hi:[1,0]
    v_cvt_pk_bf16_f32 v152, v104, v105
    v_cvt_pk_bf16_f32 v153, v106, v107
    v_cvt_pk_bf16_f32 v154, v120, v121
    v_cvt_pk_bf16_f32 v155, v122, v123
    ds_write_b128 v140, v[152:155] offset:14336
    v_pk_mul_f32 v[108:109], v[108:109], v[138:139] op_sel_hi:[1,0]
    v_pk_mul_f32 v[110:111], v[110:111], v[138:139] op_sel_hi:[1,0]
    v_pk_mul_f32 v[124:125], v[124:125], v[138:139] op_sel_hi:[1,0]
    v_pk_mul_f32 v[126:127], v[126:127], v[138:139] op_sel_hi:[1,0]
    v_cvt_pk_bf16_f32 v156, v108, v109
    v_cvt_pk_bf16_f32 v157, v110, v111
    v_cvt_pk_bf16_f32 v158, v124, v125
    v_cvt_pk_bf16_f32 v159, v126, v127
    ds_write_b128 v140, v[156:159] offset:15360
    s_waitcnt lgkmcnt(0)
    s_barrier
    ds_read_b128 a[160:163], v244 offset:0
    ds_read_b128 a[164:167], v244 offset:1024
    ds_read_b128 a[168:171], v244 offset:2048
    ds_read_b128 a[172:175], v244 offset:3072
    ds_read_b64_tr_b16 a[128:129], v240 offset:0
    ds_read_b64_tr_b16 a[130:131], v240 offset:2048
    ds_read_b64_tr_b16 a[132:133], v241 offset:0
    ds_read_b64_tr_b16 a[134:135], v241 offset:2048
    ds_read_b64_tr_b16 a[136:137], v242 offset:0
    ds_read_b64_tr_b16 a[138:139], v242 offset:2048
    ds_read_b64_tr_b16 a[140:141], v243 offset:0
    ds_read_b64_tr_b16 a[142:143], v243 offset:2048
    s_add_u32 m0, s55, 20480
    s_nop 0
    buffer_load_dwordx4 v232, s[32:35], s56 offen lds
    buffer_load_dwordx4 v233, s[32:35], s56 offen offset:1024 lds
    buffer_load_dwordx4 v232, s[32:35], s57 offen offset:2048 lds
    buffer_load_dwordx4 v233, s[32:35], s57 offen offset:3072 lds
    s_add_u32 s56, s56, 32768
    s_add_u32 s57, s57, 32768
    s_waitcnt vmcnt(63) lgkmcnt(0)
    v_mfma_f32_16x16x32_bf16 v[0:3], a[128:131], a[160:163], 0
    ds_read_b64_tr_b16 a[144:145], v240 offset:4096
    v_mfma_f32_16x16x32_bf16 v[4:7], a[128:131], a[164:167], 0
    ds_read_b64_tr_b16 a[146:147], v240 offset:6144
    v_mfma_f32_16x16x32_bf16 v[16:19], a[132:135], a[160:163], 0
    ds_read_b64_tr_b16 a[148:149], v241 offset:4096
    v_mfma_f32_16x16x32_bf16 v[20:23], a[132:135], a[164:167], 0
    ds_read_b64_tr_b16 a[150:151], v241 offset:6144
    v_mfma_f32_16x16x32_bf16 v[32:35], a[136:139], a[160:163], 0
    ds_read_b64_tr_b16 a[152:153], v242 offset:4096
    v_mfma_f32_16x16x32_bf16 v[36:39], a[136:139], a[164:167], 0
    ds_read_b64_tr_b16 a[154:155], v242 offset:6144
    v_mfma_f32_16x16x32_bf16 v[48:51], a[140:143], a[160:163], 0
    ds_read_b64_tr_b16 a[156:157], v243 offset:4096
    v_mfma_f32_16x16x32_bf16 v[52:55], a[140:143], a[164:167], 0
    ds_read_b64_tr_b16 a[158:159], v243 offset:6144
    v_mfma_f32_16x16x32_bf16 v[8:11], a[128:131], a[168:171], 0
    ds_read_b128 a[176:179], v244 offset:4096
    v_mfma_f32_16x16x32_bf16 v[12:15], a[128:131], a[172:175], 0
    ds_read_b128 a[180:183], v244 offset:5120
    v_mfma_f32_16x16x32_bf16 v[24:27], a[132:135], a[168:171], 0
    ds_read_b128 a[184:187], v244 offset:6144
    v_mfma_f32_16x16x32_bf16 v[28:31], a[132:135], a[172:175], 0
    s_add_u32 m0, s55, 0
    ds_read_b128 a[188:191], v244 offset:7168
    v_mfma_f32_16x16x32_bf16 v[40:43], a[136:139], a[168:171], 0
    buffer_load_dwordx4 v232, s[32:35], s56 offen lds
    v_mfma_f32_16x16x32_bf16 v[44:47], a[136:139], a[172:175], 0
    buffer_load_dwordx4 v233, s[32:35], s56 offen offset:1024 lds
    v_mfma_f32_16x16x32_bf16 v[56:59], a[140:143], a[168:171], 0
    buffer_load_dwordx4 v232, s[32:35], s57 offen offset:2048 lds
    v_mfma_f32_16x16x32_bf16 v[60:63], a[140:143], a[172:175], 0
    buffer_load_dwordx4 v233, s[32:35], s57 offen offset:3072 lds
    s_waitcnt vmcnt(16) lgkmcnt(0)
    v_mfma_f32_16x16x32_bf16 v[0:3], a[144:147], a[176:179], v[0:3]
    s_add_u32 s56, s56, 32768
    ds_read_b64_tr_b16 a[128:129], v240 offset:8192
    v_mfma_f32_16x16x32_bf16 v[4:7], a[144:147], a[180:183], v[4:7]
    s_add_u32 s57, s57, 32768
    ds_read_b64_tr_b16 a[130:131], v240 offset:10240
    v_mfma_f32_16x16x32_bf16 v[16:19], a[148:151], a[176:179], v[16:19]
    s_lshl_b32 s68, s54, 19
    ds_read_b64_tr_b16 a[132:133], v241 offset:8192
    v_mfma_f32_16x16x32_bf16 v[20:23], a[148:151], a[180:183], v[20:23]
    s_lshl_b32 s69, s52, 17
    ds_read_b64_tr_b16 a[134:135], v241 offset:10240
    v_mfma_f32_16x16x32_bf16 v[32:35], a[152:155], a[176:179], v[32:35]
    s_add_u32 s68, s68, s69
    ds_read_b64_tr_b16 a[136:137], v242 offset:8192
    v_mfma_f32_16x16x32_bf16 v[36:39], a[152:155], a[180:183], v[36:39]
    s_lshl_b32 s69, s53, 13
    ds_read_b64_tr_b16 a[138:139], v242 offset:10240
    v_mfma_f32_16x16x32_bf16 v[48:51], a[156:159], a[176:179], v[48:51]
    s_add_u32 s68, s68, s69
    ds_read_b64_tr_b16 a[140:141], v243 offset:8192
    v_mfma_f32_16x16x32_bf16 v[52:55], a[156:159], a[180:183], v[52:55]
    s_add_u32 s68, s68, 16777216
    ds_read_b64_tr_b16 a[142:143], v243 offset:10240
    v_mfma_f32_16x16x32_bf16 v[8:11], a[144:147], a[184:187], v[8:11]
    s_add_u32 s69, s68, 4096
    ds_read_b128 a[160:163], v244 offset:8192
    v_mfma_f32_16x16x32_bf16 v[12:15], a[144:147], a[188:191], v[12:15]
    s_add_u32 s70, s68, 65536
    ds_read_b128 a[164:167], v244 offset:9216
    v_mfma_f32_16x16x32_bf16 v[24:27], a[148:151], a[184:187], v[24:27]
    s_add_u32 s71, s68, 69632
    ds_read_b128 a[168:171], v244 offset:10240
    v_mfma_f32_16x16x32_bf16 v[28:31], a[148:151], a[188:191], v[28:31]
    s_add_u32 m0, s55, 4096
    ds_read_b128 a[172:175], v244 offset:11264
    v_mfma_f32_16x16x32_bf16 v[40:43], a[152:155], a[184:187], v[40:43]
    buffer_load_dwordx4 v232, s[32:35], s56 offen lds
    v_mfma_f32_16x16x32_bf16 v[44:47], a[152:155], a[188:191], v[44:47]
    buffer_load_dwordx4 v233, s[32:35], s56 offen offset:1024 lds
    v_mfma_f32_16x16x32_bf16 v[56:59], a[156:159], a[184:187], v[56:59]
    buffer_load_dwordx4 v232, s[32:35], s57 offen offset:2048 lds
    v_mfma_f32_16x16x32_bf16 v[60:63], a[156:159], a[188:191], v[60:63]
    buffer_load_dwordx4 v233, s[32:35], s57 offen offset:3072 lds
    s_waitcnt vmcnt(16) lgkmcnt(0)
    v_mfma_f32_16x16x32_bf16 v[0:3], a[128:131], a[160:163], v[0:3]
    s_add_u32 s56, s56, 32768
    ds_read_b64_tr_b16 a[144:145], v240 offset:12288
    v_mfma_f32_16x16x32_bf16 v[4:7], a[128:131], a[164:167], v[4:7]
    s_add_u32 s57, s57, 32768
    ds_read_b64_tr_b16 a[146:147], v240 offset:14336
    v_mfma_f32_16x16x32_bf16 v[16:19], a[132:135], a[160:163], v[16:19]
    s_mov_b32 s28, s4
    ds_read_b64_tr_b16 a[148:149], v241 offset:12288
    v_mfma_f32_16x16x32_bf16 v[20:23], a[132:135], a[164:167], v[20:23]
    s_mov_b32 s29, s5
    ds_read_b64_tr_b16 a[150:151], v241 offset:14336
    v_mfma_f32_16x16x32_bf16 v[32:35], a[136:139], a[160:163], v[32:35]
    s_mov_b32 s30, 2097152
    ds_read_b64_tr_b16 a[152:153], v242 offset:12288
    v_mfma_f32_16x16x32_bf16 v[36:39], a[136:139], a[164:167], v[36:39]
    s_mov_b32 s31, 0x20000
    ds_read_b64_tr_b16 a[154:155], v242 offset:14336
    v_mfma_f32_16x16x32_bf16 v[48:51], a[140:143], a[160:163], v[48:51]
    s_mov_b32 s36, s22
    ds_read_b64_tr_b16 a[156:157], v243 offset:12288
    v_mfma_f32_16x16x32_bf16 v[52:55], a[140:143], a[164:167], v[52:55]
    s_mov_b32 s37, s23
    ds_read_b64_tr_b16 a[158:159], v243 offset:14336
    v_mfma_f32_16x16x32_bf16 v[8:11], a[128:131], a[168:171], v[8:11]
    s_mov_b32 s38, 2097152
    ds_read_b128 a[176:179], v244 offset:12288
    v_mfma_f32_16x16x32_bf16 v[12:15], a[128:131], a[172:175], v[12:15]
    s_mov_b32 s39, 0x20000
    ds_read_b128 a[180:183], v244 offset:13312
    v_mfma_f32_16x16x32_bf16 v[24:27], a[132:135], a[168:171], v[24:27]
    s_lshl_b32 s72, s84, 3
    ds_read_b128 a[184:187], v244 offset:14336
    v_mfma_f32_16x16x32_bf16 v[28:31], a[132:135], a[172:175], v[28:31]
    s_add_u32 m0, s55, 8192
    ds_read_b128 a[188:191], v244 offset:15360
    v_mfma_f32_16x16x32_bf16 v[40:43], a[136:139], a[168:171], v[40:43]
    buffer_load_dwordx4 v232, s[32:35], s56 offen lds
    v_mfma_f32_16x16x32_bf16 v[44:47], a[136:139], a[172:175], v[44:47]
    buffer_load_dwordx4 v233, s[32:35], s56 offen offset:1024 lds
    v_mfma_f32_16x16x32_bf16 v[56:59], a[140:143], a[168:171], v[56:59]
    buffer_load_dwordx4 v232, s[32:35], s57 offen offset:2048 lds
    v_mfma_f32_16x16x32_bf16 v[60:63], a[140:143], a[172:175], v[60:63]
    buffer_load_dwordx4 v233, s[32:35], s57 offen offset:3072 lds
    s_waitcnt vmcnt(16) lgkmcnt(0)
    v_mfma_f32_16x16x32_bf16 v[0:3], a[144:147], a[176:179], v[0:3]
    s_add_u32 s56, s56, 32768
    ds_read_b64_tr_b16 a[128:129], v240 offset:16384
    v_mfma_f32_16x16x32_bf16 v[4:7], a[144:147], a[180:183], v[4:7]
    s_add_u32 s57, s57, 32768
    ds_read_b64_tr_b16 a[130:131], v240 offset:18432
    v_mfma_f32_16x16x32_bf16 v[16:19], a[148:151], a[176:179], v[16:19]
    s_add_u32 s72, s72, s85
    ds_read_b64_tr_b16 a[132:133], v241 offset:16384
    v_mfma_f32_16x16x32_bf16 v[20:23], a[148:151], a[180:183], v[20:23]
    s_lshl_b32 s72, s72, 16
    ds_read_b64_tr_b16 a[134:135], v241 offset:18432
    v_mfma_f32_16x16x32_bf16 v[32:35], a[152:155], a[176:179], v[32:35]
    s_lshl_b32 s64, s52, 11
    ds_read_b64_tr_b16 a[136:137], v242 offset:16384
    v_mfma_f32_16x16x32_bf16 v[36:39], a[152:155], a[180:183], v[36:39]
    s_add_u32 s72, s72, s64
    ds_read_b64_tr_b16 a[138:139], v242 offset:18432
    v_mfma_f32_16x16x32_bf16 v[48:51], a[156:159], a[176:179], v[48:51]
    s_add_u32 s72, s72, 16777216
    ds_read_b64_tr_b16 a[140:141], v243 offset:16384
    v_mfma_f32_16x16x32_bf16 v[52:55], a[156:159], a[180:183], v[52:55]
    ds_read_b64_tr_b16 a[142:143], v243 offset:18432
    v_lshrrev_b32 v224, 3, v246
    v_mfma_f32_16x16x32_bf16 v[8:11], a[144:147], a[184:187], v[8:11]
    ds_read_b128 a[160:163], v244 offset:16384
    v_and_b32 v201, 7, v246
    v_mfma_f32_16x16x32_bf16 v[12:15], a[144:147], a[188:191], v[12:15]
    ds_read_b128 a[164:167], v244 offset:17408
    v_lshlrev_b32 v200, 10, v224
    v_mfma_f32_16x16x32_bf16 v[24:27], a[148:151], a[184:187], v[24:27]
    ds_read_b128 a[168:171], v244 offset:18432
    v_lshl_add_u32 v200, v201, 4, v200
    v_mfma_f32_16x16x32_bf16 v[28:31], a[148:151], a[188:191], v[28:31]
    s_add_u32 m0, s55, 12288
    ds_read_b128 a[172:175], v244 offset:19456
    v_mfma_f32_16x16x32_bf16 v[40:43], a[152:155], a[184:187], v[40:43]
    buffer_load_dwordx4 v232, s[32:35], s56 offen lds
    v_mfma_f32_16x16x32_bf16 v[44:47], a[152:155], a[188:191], v[44:47]
    buffer_load_dwordx4 v233, s[32:35], s56 offen offset:1024 lds
    v_mfma_f32_16x16x32_bf16 v[56:59], a[156:159], a[184:187], v[56:59]
    buffer_load_dwordx4 v232, s[32:35], s57 offen offset:2048 lds
    v_mfma_f32_16x16x32_bf16 v[60:63], a[156:159], a[188:191], v[60:63]
    buffer_load_dwordx4 v233, s[32:35], s57 offen offset:3072 lds
    s_waitcnt vmcnt(16) lgkmcnt(0)
    v_mfma_f32_16x16x32_bf16 v[0:3], a[128:131], a[160:163], v[0:3]
    s_add_u32 s56, s56, 32768
    ds_read_b64_tr_b16 a[144:145], v240 offset:20480
    v_mfma_f32_16x16x32_bf16 v[4:7], a[128:131], a[164:167], v[4:7]
    s_add_u32 s57, s57, 32768
    ds_read_b64_tr_b16 a[146:147], v240 offset:22528
    v_mfma_f32_16x16x32_bf16 v[16:19], a[132:135], a[160:163], v[16:19]
    ds_read_b64_tr_b16 a[148:149], v241 offset:20480
    v_mul_u32_u24 v224, 272, v224
    v_mfma_f32_16x16x32_bf16 v[20:23], a[132:135], a[164:167], v[20:23]
    ds_read_b64_tr_b16 a[150:151], v241 offset:22528
    v_lshl_add_u32 v224, v201, 5, v224
    v_mfma_f32_16x16x32_bf16 v[32:35], a[136:139], a[160:163], v[32:35]
    ds_read_b64_tr_b16 a[152:153], v242 offset:20480
    v_add_u32 v224, s55, v224
    v_mfma_f32_16x16x32_bf16 v[36:39], a[136:139], a[164:167], v[36:39]
    ds_read_b64_tr_b16 a[154:155], v242 offset:22528
    v_and_b32 v206, 15, v246
    v_mfma_f32_16x16x32_bf16 v[48:51], a[140:143], a[160:163], v[48:51]
    ds_read_b64_tr_b16 a[156:157], v243 offset:20480
    v_mul_u32_u24 v206, 272, v206
    v_mfma_f32_16x16x32_bf16 v[52:55], a[140:143], a[164:167], v[52:55]
    ds_read_b64_tr_b16 a[158:159], v243 offset:22528
    v_and_b32 v201, 48, v246
    v_mfma_f32_16x16x32_bf16 v[8:11], a[128:131], a[168:171], v[8:11]
    ds_read_b128 a[176:179], v244 offset:20480
    v_add3_u32 v206, v206, v201, s55
    v_mfma_f32_16x16x32_bf16 v[12:15], a[128:131], a[172:175], v[12:15]
    s_lshl_b32 s65, s84, 16
    ds_read_b128 a[180:183], v244 offset:21504
    v_mfma_f32_16x16x32_bf16 v[24:27], a[132:135], a[168:171], v[24:27]
    s_lshl_b32 s64, s52, 14
    ds_read_b128 a[184:187], v244 offset:22528
    v_mfma_f32_16x16x32_bf16 v[28:31], a[132:135], a[172:175], v[28:31]
    s_add_u32 m0, s55, 16384
    ds_read_b128 a[188:191], v244 offset:23552
    v_mfma_f32_16x16x32_bf16 v[40:43], a[136:139], a[168:171], v[40:43]
    buffer_load_dwordx4 v232, s[32:35], s56 offen lds
    v_mfma_f32_16x16x32_bf16 v[44:47], a[136:139], a[172:175], v[44:47]
    buffer_load_dwordx4 v233, s[32:35], s56 offen offset:1024 lds
    v_mfma_f32_16x16x32_bf16 v[56:59], a[140:143], a[168:171], v[56:59]
    buffer_load_dwordx4 v232, s[32:35], s57 offen offset:2048 lds
    v_mfma_f32_16x16x32_bf16 v[60:63], a[140:143], a[172:175], v[60:63]
    buffer_load_dwordx4 v233, s[32:35], s57 offen offset:3072 lds
    s_waitcnt vmcnt(16) lgkmcnt(0)
    v_mfma_f32_16x16x32_bf16 v[0:3], a[144:147], a[176:179], v[0:3]
    s_add_u32 s56, s56, 32768
    ds_read_b64_tr_b16 a[128:129], v240 offset:0
    v_mfma_f32_16x16x32_bf16 v[4:7], a[144:147], a[180:183], v[4:7]
    s_add_u32 s57, s57, 32768
    ds_read_b64_tr_b16 a[130:131], v240 offset:2048
    v_mfma_f32_16x16x32_bf16 v[16:19], a[148:151], a[176:179], v[16:19]
    s_add_u32 s65, s65, s64
    ds_read_b64_tr_b16 a[132:133], v241 offset:0
    v_mfma_f32_16x16x32_bf16 v[20:23], a[148:151], a[180:183], v[20:23]
    ds_read_b64_tr_b16 a[134:135], v241 offset:2048
    v_add_u32 v204, s64, v245
    v_mfma_f32_16x16x32_bf16 v[32:35], a[152:155], a[176:179], v[32:35]
    s_lshl_b32 s64, s85, 7
    ds_read_b64_tr_b16 a[136:137], v242 offset:0
    v_mfma_f32_16x16x32_bf16 v[36:39], a[152:155], a[180:183], v[36:39]
    s_add_u32 s65, s65, s64
    ds_read_b64_tr_b16 a[138:139], v242 offset:2048
    v_mfma_f32_16x16x32_bf16 v[48:51], a[156:159], a[176:179], v[48:51]
    s_add_u32 s75, s65, 8192
    ds_read_b64_tr_b16 a[140:141], v243 offset:0
    v_mfma_f32_16x16x32_bf16 v[52:55], a[156:159], a[180:183], v[52:55]
    ds_read_b64_tr_b16 a[142:143], v243 offset:2048
    v_and_b32 v201, 31, v246
    v_mfma_f32_16x16x32_bf16 v[8:11], a[144:147], a[184:187], v[8:11]
    ds_read_b128 a[160:163], v244 offset:24576
    v_lshlrev_b32 v201, 2, v201
    v_mfma_f32_16x16x32_bf16 v[12:15], a[144:147], a[188:191], v[12:15]
    s_lshl_b32 s66, s84, 7
    ds_read_b128 a[164:167], v244 offset:25600
    v_mfma_f32_16x16x32_bf16 v[24:27], a[148:151], a[184:187], v[24:27]
    s_add_u32 s66, s66, 50331648
    ds_read_b128 a[168:171], v244 offset:26624
    v_mfma_f32_16x16x32_bf16 v[28:31], a[148:151], a[188:191], v[28:31]
    s_add_u32 m0, s55, 20480
    ds_read_b128 a[172:175], v244 offset:27648
    v_mfma_f32_16x16x32_bf16 v[40:43], a[152:155], a[184:187], v[40:43]
    buffer_load_dwordx4 v232, s[32:35], s56 offen lds
    v_mfma_f32_16x16x32_bf16 v[44:47], a[152:155], a[188:191], v[44:47]
    buffer_load_dwordx4 v233, s[32:35], s56 offen offset:1024 lds
    v_mfma_f32_16x16x32_bf16 v[56:59], a[156:159], a[184:187], v[56:59]
    buffer_load_dwordx4 v232, s[32:35], s57 offen offset:2048 lds
    v_mfma_f32_16x16x32_bf16 v[60:63], a[156:159], a[188:191], v[60:63]
    buffer_load_dwordx4 v233, s[32:35], s57 offen offset:3072 lds
    s_waitcnt vmcnt(16) lgkmcnt(0)
    v_mfma_f32_16x16x32_bf16 v[0:3], a[128:131], a[160:163], v[0:3]
    s_add_u32 s56, s56, 32768
    ds_read_b64_tr_b16 a[144:145], v240 offset:4096
    v_mfma_f32_16x16x32_bf16 v[4:7], a[128:131], a[164:167], v[4:7]
    s_add_u32 s57, s57, 32768
    ds_read_b64_tr_b16 a[146:147], v240 offset:6144
    v_mfma_f32_16x16x32_bf16 v[16:19], a[132:135], a[160:163], v[16:19]
    s_lshl_b32 s64, s52, 12
    ds_read_b64_tr_b16 a[148:149], v241 offset:4096
    v_mfma_f32_16x16x32_bf16 v[20:23], a[132:135], a[164:167], v[20:23]
    ds_read_b64_tr_b16 a[150:151], v241 offset:6144
    v_add_u32 v203, s64, v245
    v_mfma_f32_16x16x32_bf16 v[32:35], a[136:139], a[160:163], v[32:35]
    s_mov_b32 s67, 0xffff0000
    ds_read_b64_tr_b16 a[152:153], v242 offset:4096
    v_mfma_f32_16x16x32_bf16 v[36:39], a[136:139], a[164:167], v[36:39]
    ds_read_b64_tr_b16 a[154:155], v242 offset:6144
    v_mfma_f32_16x16x32_bf16 v[48:51], a[140:143], a[160:163], v[48:51]
    ds_read_b64_tr_b16 a[156:157], v243 offset:4096
    v_mfma_f32_16x16x32_bf16 v[52:55], a[140:143], a[164:167], v[52:55]
    ds_read_b64_tr_b16 a[158:159], v243 offset:6144
    v_mfma_f32_16x16x32_bf16 v[8:11], a[128:131], a[168:171], v[8:11]
    ds_read_b128 a[176:179], v244 offset:28672
    v_mfma_f32_16x16x32_bf16 v[12:15], a[128:131], a[172:175], v[12:15]
    ds_read_b128 a[180:183], v244 offset:29696
    v_mfma_f32_16x16x32_bf16 v[24:27], a[132:135], a[168:171], v[24:27]
    ds_read_b128 a[184:187], v244 offset:30720
    v_mfma_f32_16x16x32_bf16 v[28:31], a[132:135], a[172:175], v[28:31]
    s_add_u32 m0, s55, 0
    ds_read_b128 a[188:191], v244 offset:31744
    v_mfma_f32_16x16x32_bf16 v[40:43], a[136:139], a[168:171], v[40:43]
    buffer_load_dwordx4 v232, s[32:35], s56 offen lds
    v_mfma_f32_16x16x32_bf16 v[44:47], a[136:139], a[172:175], v[44:47]
    buffer_load_dwordx4 v233, s[32:35], s56 offen offset:1024 lds
    v_mfma_f32_16x16x32_bf16 v[56:59], a[140:143], a[168:171], v[56:59]
    buffer_load_dwordx4 v232, s[32:35], s57 offen offset:2048 lds
    v_mfma_f32_16x16x32_bf16 v[60:63], a[140:143], a[172:175], v[60:63]
    buffer_load_dwordx4 v233, s[32:35], s57 offen offset:3072 lds
    s_waitcnt vmcnt(16) lgkmcnt(0)
    v_mfma_f32_16x16x32_bf16 v[0:3], a[144:147], a[176:179], v[0:3]
    s_add_u32 s56, s56, 32768
    ds_read_b64_tr_b16 a[128:129], v240 offset:8192
    v_mfma_f32_16x16x32_bf16 v[4:7], a[144:147], a[180:183], v[4:7]
    s_add_u32 s57, s57, 32768
    ds_read_b64_tr_b16 a[130:131], v240 offset:10240
    v_mfma_f32_16x16x32_bf16 v[16:19], a[148:151], a[176:179], v[16:19]
    ds_read_b64_tr_b16 a[132:133], v241 offset:8192
    v_mfma_f32_16x16x32_bf16 v[20:23], a[148:151], a[180:183], v[20:23]
    ds_read_b64_tr_b16 a[134:135], v241 offset:10240
    v_mfma_f32_16x16x32_bf16 v[32:35], a[152:155], a[176:179], v[32:35]
    ds_read_b64_tr_b16 a[136:137], v242 offset:8192
    v_mfma_f32_16x16x32_bf16 v[36:39], a[152:155], a[180:183], v[36:39]
    ds_read_b64_tr_b16 a[138:139], v242 offset:10240
    v_mfma_f32_16x16x32_bf16 v[48:51], a[156:159], a[176:179], v[48:51]
    ds_read_b64_tr_b16 a[140:141], v243 offset:8192
    v_mfma_f32_16x16x32_bf16 v[52:55], a[156:159], a[180:183], v[52:55]
    ds_read_b64_tr_b16 a[142:143], v243 offset:10240
    v_mfma_f32_16x16x32_bf16 v[8:11], a[144:147], a[184:187], v[8:11]
    ds_read_b128 a[160:163], v244 offset:32768
    v_mfma_f32_16x16x32_bf16 v[12:15], a[144:147], a[188:191], v[12:15]
    ds_read_b128 a[164:167], v244 offset:33792
    v_mfma_f32_16x16x32_bf16 v[24:27], a[148:151], a[184:187], v[24:27]
    ds_read_b128 a[168:171], v244 offset:34816
    v_mfma_f32_16x16x32_bf16 v[28:31], a[148:151], a[188:191], v[28:31]
    s_add_u32 m0, s55, 4096
    ds_read_b128 a[172:175], v244 offset:35840
    v_mfma_f32_16x16x32_bf16 v[40:43], a[152:155], a[184:187], v[40:43]
    buffer_load_dwordx4 v232, s[32:35], s56 offen lds
    v_mfma_f32_16x16x32_bf16 v[44:47], a[152:155], a[188:191], v[44:47]
    buffer_load_dwordx4 v233, s[32:35], s56 offen offset:1024 lds
    v_mfma_f32_16x16x32_bf16 v[56:59], a[156:159], a[184:187], v[56:59]
    buffer_load_dwordx4 v232, s[32:35], s57 offen offset:2048 lds
    v_mfma_f32_16x16x32_bf16 v[60:63], a[156:159], a[188:191], v[60:63]
    buffer_load_dwordx4 v233, s[32:35], s57 offen offset:3072 lds
    s_waitcnt vmcnt(16) lgkmcnt(0)
    v_mfma_f32_16x16x32_bf16 v[0:3], a[128:131], a[160:163], v[0:3]
    s_add_u32 s56, s56, 32768
    ds_read_b64_tr_b16 a[144:145], v240 offset:12288
    v_mfma_f32_16x16x32_bf16 v[4:7], a[128:131], a[164:167], v[4:7]
    s_add_u32 s57, s57, 32768
    ds_read_b64_tr_b16 a[146:147], v240 offset:14336
    v_mfma_f32_16x16x32_bf16 v[16:19], a[132:135], a[160:163], v[16:19]
    ds_read_b64_tr_b16 a[148:149], v241 offset:12288
    v_mfma_f32_16x16x32_bf16 v[20:23], a[132:135], a[164:167], v[20:23]
    ds_read_b64_tr_b16 a[150:151], v241 offset:14336
    v_mfma_f32_16x16x32_bf16 v[32:35], a[136:139], a[160:163], v[32:35]
    ds_read_b64_tr_b16 a[152:153], v242 offset:12288
    v_mfma_f32_16x16x32_bf16 v[36:39], a[136:139], a[164:167], v[36:39]
    ds_read_b64_tr_b16 a[154:155], v242 offset:14336
    v_mfma_f32_16x16x32_bf16 v[48:51], a[140:143], a[160:163], v[48:51]
    ds_read_b64_tr_b16 a[156:157], v243 offset:12288
    v_mfma_f32_16x16x32_bf16 v[52:55], a[140:143], a[164:167], v[52:55]
    ds_read_b64_tr_b16 a[158:159], v243 offset:14336
    v_mfma_f32_16x16x32_bf16 v[8:11], a[128:131], a[168:171], v[8:11]
    ds_read_b128 a[176:179], v244 offset:36864
    v_mfma_f32_16x16x32_bf16 v[12:15], a[128:131], a[172:175], v[12:15]
    ds_read_b128 a[180:183], v244 offset:37888
    v_mfma_f32_16x16x32_bf16 v[24:27], a[132:135], a[168:171], v[24:27]
    ds_read_b128 a[184:187], v244 offset:38912
    v_mfma_f32_16x16x32_bf16 v[28:31], a[132:135], a[172:175], v[28:31]
    s_add_u32 m0, s55, 8192
    ds_read_b128 a[188:191], v244 offset:39936
    v_mfma_f32_16x16x32_bf16 v[40:43], a[136:139], a[168:171], v[40:43]
    buffer_load_dwordx4 v232, s[32:35], s56 offen lds
    v_mfma_f32_16x16x32_bf16 v[44:47], a[136:139], a[172:175], v[44:47]
    buffer_load_dwordx4 v233, s[32:35], s56 offen offset:1024 lds
    v_mfma_f32_16x16x32_bf16 v[56:59], a[140:143], a[168:171], v[56:59]
    buffer_load_dwordx4 v232, s[32:35], s57 offen offset:2048 lds
    v_mfma_f32_16x16x32_bf16 v[60:63], a[140:143], a[172:175], v[60:63]
    buffer_load_dwordx4 v233, s[32:35], s57 offen offset:3072 lds
    s_waitcnt vmcnt(16) lgkmcnt(0)
    v_mfma_f32_16x16x32_bf16 v[0:3], a[144:147], a[176:179], v[0:3]
    s_add_u32 s56, s56, 32768
    ds_read_b64_tr_b16 a[128:129], v240 offset:16384
    v_mfma_f32_16x16x32_bf16 v[4:7], a[144:147], a[180:183], v[4:7]
    s_add_u32 s57, s57, 32768
    ds_read_b64_tr_b16 a[130:131], v240 offset:18432
    v_mfma_f32_16x16x32_bf16 v[16:19], a[148:151], a[176:179], v[16:19]
    ds_read_b64_tr_b16 a[132:133], v241 offset:16384
    v_mfma_f32_16x16x32_bf16 v[20:23], a[148:151], a[180:183], v[20:23]
    ds_read_b64_tr_b16 a[134:135], v241 offset:18432
    v_mfma_f32_16x16x32_bf16 v[32:35], a[152:155], a[176:179], v[32:35]
    ds_read_b64_tr_b16 a[136:137], v242 offset:16384
    v_mfma_f32_16x16x32_bf16 v[36:39], a[152:155], a[180:183], v[36:39]
    ds_read_b64_tr_b16 a[138:139], v242 offset:18432
    v_mfma_f32_16x16x32_bf16 v[48:51], a[156:159], a[176:179], v[48:51]
    ds_read_b64_tr_b16 a[140:141], v243 offset:16384
    v_mfma_f32_16x16x32_bf16 v[52:55], a[156:159], a[180:183], v[52:55]
    ds_read_b64_tr_b16 a[142:143], v243 offset:18432
    v_mfma_f32_16x16x32_bf16 v[8:11], a[144:147], a[184:187], v[8:11]
    ds_read_b128 a[160:163], v244 offset:40960
    v_mfma_f32_16x16x32_bf16 v[12:15], a[144:147], a[188:191], v[12:15]
    ds_read_b128 a[164:167], v244 offset:41984
    v_mfma_f32_16x16x32_bf16 v[24:27], a[148:151], a[184:187], v[24:27]
    ds_read_b128 a[168:171], v244 offset:43008
    v_mfma_f32_16x16x32_bf16 v[28:31], a[148:151], a[188:191], v[28:31]
    s_add_u32 m0, s55, 12288
    ds_read_b128 a[172:175], v244 offset:44032
    v_mfma_f32_16x16x32_bf16 v[40:43], a[152:155], a[184:187], v[40:43]
    buffer_load_dwordx4 v232, s[32:35], s56 offen lds
    v_mfma_f32_16x16x32_bf16 v[44:47], a[152:155], a[188:191], v[44:47]
    buffer_load_dwordx4 v233, s[32:35], s56 offen offset:1024 lds
    v_mfma_f32_16x16x32_bf16 v[56:59], a[156:159], a[184:187], v[56:59]
    buffer_load_dwordx4 v232, s[32:35], s57 offen offset:2048 lds
    v_mfma_f32_16x16x32_bf16 v[60:63], a[156:159], a[188:191], v[60:63]
    buffer_load_dwordx4 v233, s[32:35], s57 offen offset:3072 lds
    s_waitcnt vmcnt(16) lgkmcnt(0)
    v_mfma_f32_16x16x32_bf16 v[0:3], a[128:131], a[160:163], v[0:3]
    s_add_u32 s56, s56, -491392
    ds_read_b64_tr_b16 a[144:145], v240 offset:20480
    v_mfma_f32_16x16x32_bf16 v[4:7], a[128:131], a[164:167], v[4:7]
    s_add_u32 s57, s57, -491392
    ds_read_b64_tr_b16 a[146:147], v240 offset:22528
    v_mfma_f32_16x16x32_bf16 v[16:19], a[132:135], a[160:163], v[16:19]
    ds_read_b64_tr_b16 a[148:149], v241 offset:20480
    v_mfma_f32_16x16x32_bf16 v[20:23], a[132:135], a[164:167], v[20:23]
    ds_read_b64_tr_b16 a[150:151], v241 offset:22528
    v_mfma_f32_16x16x32_bf16 v[32:35], a[136:139], a[160:163], v[32:35]
    ds_read_b64_tr_b16 a[152:153], v242 offset:20480
    v_mfma_f32_16x16x32_bf16 v[36:39], a[136:139], a[164:167], v[36:39]
    ds_read_b64_tr_b16 a[154:155], v242 offset:22528
    v_mfma_f32_16x16x32_bf16 v[48:51], a[140:143], a[160:163], v[48:51]
    ds_read_b64_tr_b16 a[156:157], v243 offset:20480
    v_mfma_f32_16x16x32_bf16 v[52:55], a[140:143], a[164:167], v[52:55]
    ds_read_b64_tr_b16 a[158:159], v243 offset:22528
    v_mfma_f32_16x16x32_bf16 v[8:11], a[128:131], a[168:171], v[8:11]
    ds_read_b128 a[176:179], v244 offset:45056
    v_mfma_f32_16x16x32_bf16 v[12:15], a[128:131], a[172:175], v[12:15]
    ds_read_b128 a[180:183], v244 offset:46080
    v_mfma_f32_16x16x32_bf16 v[24:27], a[132:135], a[168:171], v[24:27]
    ds_read_b128 a[184:187], v244 offset:47104
    v_mfma_f32_16x16x32_bf16 v[28:31], a[132:135], a[172:175], v[28:31]
    s_add_u32 m0, s55, 16384
    ds_read_b128 a[188:191], v244 offset:48128
    v_mfma_f32_16x16x32_bf16 v[40:43], a[136:139], a[168:171], v[40:43]
    buffer_load_dwordx4 v232, s[32:35], s56 offen lds
    v_mfma_f32_16x16x32_bf16 v[44:47], a[136:139], a[172:175], v[44:47]
    buffer_load_dwordx4 v233, s[32:35], s56 offen offset:1024 lds
    v_mfma_f32_16x16x32_bf16 v[56:59], a[140:143], a[168:171], v[56:59]
    buffer_load_dwordx4 v232, s[32:35], s57 offen offset:2048 lds
    v_mfma_f32_16x16x32_bf16 v[60:63], a[140:143], a[172:175], v[60:63]
    buffer_load_dwordx4 v233, s[32:35], s57 offen offset:3072 lds
    s_waitcnt vmcnt(16) lgkmcnt(0)
    v_mfma_f32_16x16x32_bf16 v[0:3], a[144:147], a[176:179], v[0:3]
    s_add_u32 s56, s56, 32768
    ds_read_b64_tr_b16 a[128:129], v240 offset:0
    v_mfma_f32_16x16x32_bf16 v[4:7], a[144:147], a[180:183], v[4:7]
    s_add_u32 s57, s57, 32768
    ds_read_b64_tr_b16 a[130:131], v240 offset:2048
    v_mfma_f32_16x16x32_bf16 v[16:19], a[148:151], a[176:179], v[16:19]
    ds_read_b64_tr_b16 a[132:133], v241 offset:0
    v_mfma_f32_16x16x32_bf16 v[20:23], a[148:151], a[180:183], v[20:23]
    ds_read_b64_tr_b16 a[134:135], v241 offset:2048
    v_mfma_f32_16x16x32_bf16 v[32:35], a[152:155], a[176:179], v[32:35]
    ds_read_b64_tr_b16 a[136:137], v242 offset:0
    v_mfma_f32_16x16x32_bf16 v[36:39], a[152:155], a[180:183], v[36:39]
    ds_read_b64_tr_b16 a[138:139], v242 offset:2048
    v_mfma_f32_16x16x32_bf16 v[48:51], a[156:159], a[176:179], v[48:51]
    ds_read_b64_tr_b16 a[140:141], v243 offset:0
    v_mfma_f32_16x16x32_bf16 v[52:55], a[156:159], a[180:183], v[52:55]
    ds_read_b64_tr_b16 a[142:143], v243 offset:2048
    v_mfma_f32_16x16x32_bf16 v[8:11], a[144:147], a[184:187], v[8:11]
    ds_read_b128 a[160:163], v244 offset:49152
    v_mfma_f32_16x16x32_bf16 v[12:15], a[144:147], a[188:191], v[12:15]
    ds_read_b128 a[164:167], v244 offset:50176
    v_mfma_f32_16x16x32_bf16 v[24:27], a[148:151], a[184:187], v[24:27]
    ds_read_b128 a[168:171], v244 offset:51200
    v_mfma_f32_16x16x32_bf16 v[28:31], a[148:151], a[188:191], v[28:31]
    s_add_u32 m0, s55, 20480
    ds_read_b128 a[172:175], v244 offset:52224
    v_mfma_f32_16x16x32_bf16 v[40:43], a[152:155], a[184:187], v[40:43]
    buffer_load_dwordx4 v232, s[32:35], s56 offen lds
    v_mfma_f32_16x16x32_bf16 v[44:47], a[152:155], a[188:191], v[44:47]
    buffer_load_dwordx4 v233, s[32:35], s56 offen offset:1024 lds
    v_mfma_f32_16x16x32_bf16 v[56:59], a[156:159], a[184:187], v[56:59]
    buffer_load_dwordx4 v232, s[32:35], s57 offen offset:2048 lds
    v_mfma_f32_16x16x32_bf16 v[60:63], a[156:159], a[188:191], v[60:63]
    buffer_load_dwordx4 v233, s[32:35], s57 offen offset:3072 lds
    s_waitcnt vmcnt(16) lgkmcnt(0)
    v_mfma_f32_16x16x32_bf16 v[0:3], a[128:131], a[160:163], v[0:3]
    s_add_u32 s56, s56, 32768
    ds_read_b64_tr_b16 a[144:145], v240 offset:4096
    v_mfma_f32_16x16x32_bf16 v[4:7], a[128:131], a[164:167], v[4:7]
    s_add_u32 s57, s57, 32768
    ds_read_b64_tr_b16 a[146:147], v240 offset:6144
    v_mfma_f32_16x16x32_bf16 v[16:19], a[132:135], a[160:163], v[16:19]
    ds_read_b64_tr_b16 a[148:149], v241 offset:4096
    v_mfma_f32_16x16x32_bf16 v[20:23], a[132:135], a[164:167], v[20:23]
    ds_read_b64_tr_b16 a[150:151], v241 offset:6144
    v_mfma_f32_16x16x32_bf16 v[32:35], a[136:139], a[160:163], v[32:35]
    ds_read_b64_tr_b16 a[152:153], v242 offset:4096
    v_mfma_f32_16x16x32_bf16 v[36:39], a[136:139], a[164:167], v[36:39]
    ds_read_b64_tr_b16 a[154:155], v242 offset:6144
    v_mfma_f32_16x16x32_bf16 v[48:51], a[140:143], a[160:163], v[48:51]
    ds_read_b64_tr_b16 a[156:157], v243 offset:4096
    v_mfma_f32_16x16x32_bf16 v[52:55], a[140:143], a[164:167], v[52:55]
    ds_read_b64_tr_b16 a[158:159], v243 offset:6144
    v_mfma_f32_16x16x32_bf16 v[8:11], a[128:131], a[168:171], v[8:11]
    ds_read_b128 a[176:179], v244 offset:53248
    v_mfma_f32_16x16x32_bf16 v[12:15], a[128:131], a[172:175], v[12:15]
    ds_read_b128 a[180:183], v244 offset:54272
    v_mfma_f32_16x16x32_bf16 v[24:27], a[132:135], a[168:171], v[24:27]
    ds_read_b128 a[184:187], v244 offset:55296
    v_mfma_f32_16x16x32_bf16 v[28:31], a[132:135], a[172:175], v[28:31]
    s_add_u32 m0, s55, 0
    ds_read_b128 a[188:191], v244 offset:56320
    v_mfma_f32_16x16x32_bf16 v[40:43], a[136:139], a[168:171], v[40:43]
    buffer_load_dwordx4 v232, s[32:35], s56 offen lds
    v_mfma_f32_16x16x32_bf16 v[44:47], a[136:139], a[172:175], v[44:47]
    buffer_load_dwordx4 v233, s[32:35], s56 offen offset:1024 lds
    v_mfma_f32_16x16x32_bf16 v[56:59], a[140:143], a[168:171], v[56:59]
    buffer_load_dwordx4 v232, s[32:35], s57 offen offset:2048 lds
    v_mfma_f32_16x16x32_bf16 v[60:63], a[140:143], a[172:175], v[60:63]
    buffer_load_dwordx4 v233, s[32:35], s57 offen offset:3072 lds
    s_waitcnt vmcnt(16) lgkmcnt(0)
    v_mfma_f32_16x16x32_bf16 v[0:3], a[144:147], a[176:179], v[0:3]
    s_add_u32 s56, s56, 32768
    ds_read_b64_tr_b16 a[128:129], v240 offset:8192
    v_mfma_f32_16x16x32_bf16 v[4:7], a[144:147], a[180:183], v[4:7]
    s_add_u32 s57, s57, 32768
    ds_read_b64_tr_b16 a[130:131], v240 offset:10240
    v_mfma_f32_16x16x32_bf16 v[16:19], a[148:151], a[176:179], v[16:19]
    ds_read_b64_tr_b16 a[132:133], v241 offset:8192
    v_mfma_f32_16x16x32_bf16 v[20:23], a[148:151], a[180:183], v[20:23]
    ds_read_b64_tr_b16 a[134:135], v241 offset:10240
    v_mfma_f32_16x16x32_bf16 v[32:35], a[152:155], a[176:179], v[32:35]
    ds_read_b64_tr_b16 a[136:137], v242 offset:8192
    v_mfma_f32_16x16x32_bf16 v[36:39], a[152:155], a[180:183], v[36:39]
    ds_read_b64_tr_b16 a[138:139], v242 offset:10240
    v_mfma_f32_16x16x32_bf16 v[48:51], a[156:159], a[176:179], v[48:51]
    ds_read_b64_tr_b16 a[140:141], v243 offset:8192
    v_mfma_f32_16x16x32_bf16 v[52:55], a[156:159], a[180:183], v[52:55]
    ds_read_b64_tr_b16 a[142:143], v243 offset:10240
    v_mfma_f32_16x16x32_bf16 v[8:11], a[144:147], a[184:187], v[8:11]
    ds_read_b128 a[160:163], v244 offset:57344
    v_mfma_f32_16x16x32_bf16 v[12:15], a[144:147], a[188:191], v[12:15]
    ds_read_b128 a[164:167], v244 offset:58368
    v_mfma_f32_16x16x32_bf16 v[24:27], a[148:151], a[184:187], v[24:27]
    ds_read_b128 a[168:171], v244 offset:59392
    v_mfma_f32_16x16x32_bf16 v[28:31], a[148:151], a[188:191], v[28:31]
    s_add_u32 m0, s55, 4096
    ds_read_b128 a[172:175], v244 offset:60416
    v_mfma_f32_16x16x32_bf16 v[40:43], a[152:155], a[184:187], v[40:43]
    buffer_load_dwordx4 v232, s[32:35], s56 offen lds
    v_mfma_f32_16x16x32_bf16 v[44:47], a[152:155], a[188:191], v[44:47]
    buffer_load_dwordx4 v233, s[32:35], s56 offen offset:1024 lds
    v_mfma_f32_16x16x32_bf16 v[56:59], a[156:159], a[184:187], v[56:59]
    buffer_load_dwordx4 v232, s[32:35], s57 offen offset:2048 lds
    v_mfma_f32_16x16x32_bf16 v[60:63], a[156:159], a[188:191], v[60:63]
    buffer_load_dwordx4 v233, s[32:35], s57 offen offset:3072 lds
    s_waitcnt vmcnt(16) lgkmcnt(0)
    v_mfma_f32_16x16x32_bf16 v[0:3], a[128:131], a[160:163], v[0:3]
    s_add_u32 s56, s56, 32768
    ds_read_b64_tr_b16 a[144:145], v240 offset:12288
    v_mfma_f32_16x16x32_bf16 v[4:7], a[128:131], a[164:167], v[4:7]
    s_add_u32 s57, s57, 32768
    ds_read_b64_tr_b16 a[146:147], v240 offset:14336
    v_mfma_f32_16x16x32_bf16 v[16:19], a[132:135], a[160:163], v[16:19]
    ds_read_b64_tr_b16 a[148:149], v241 offset:12288
    v_mfma_f32_16x16x32_bf16 v[20:23], a[132:135], a[164:167], v[20:23]
    ds_read_b64_tr_b16 a[150:151], v241 offset:14336
    v_mfma_f32_16x16x32_bf16 v[32:35], a[136:139], a[160:163], v[32:35]
    ds_read_b64_tr_b16 a[152:153], v242 offset:12288
    v_mfma_f32_16x16x32_bf16 v[36:39], a[136:139], a[164:167], v[36:39]
    ds_read_b64_tr_b16 a[154:155], v242 offset:14336
    v_mfma_f32_16x16x32_bf16 v[48:51], a[140:143], a[160:163], v[48:51]
    ds_read_b64_tr_b16 a[156:157], v243 offset:12288
    v_mfma_f32_16x16x32_bf16 v[52:55], a[140:143], a[164:167], v[52:55]
    ds_read_b64_tr_b16 a[158:159], v243 offset:14336
    v_mfma_f32_16x16x32_bf16 v[8:11], a[128:131], a[168:171], v[8:11]
    ds_read_b128 a[176:179], v244 offset:61440
    v_mfma_f32_16x16x32_bf16 v[12:15], a[128:131], a[172:175], v[12:15]
    ds_read_b128 a[180:183], v244 offset:62464
    v_mfma_f32_16x16x32_bf16 v[24:27], a[132:135], a[168:171], v[24:27]
    ds_read_b128 a[184:187], v244 offset:63488
    v_mfma_f32_16x16x32_bf16 v[28:31], a[132:135], a[172:175], v[28:31]
    s_add_u32 m0, s55, 8192
    ds_read_b128 a[188:191], v244 offset:64512
    v_mfma_f32_16x16x32_bf16 v[40:43], a[136:139], a[168:171], v[40:43]
    buffer_load_dwordx4 v232, s[32:35], s56 offen lds
    v_mfma_f32_16x16x32_bf16 v[44:47], a[136:139], a[172:175], v[44:47]
    buffer_load_dwordx4 v233, s[32:35], s56 offen offset:1024 lds
    v_mfma_f32_16x16x32_bf16 v[56:59], a[140:143], a[168:171], v[56:59]
    buffer_load_dwordx4 v232, s[32:35], s57 offen offset:2048 lds
    v_mfma_f32_16x16x32_bf16 v[60:63], a[140:143], a[172:175], v[60:63]
    buffer_load_dwordx4 v233, s[32:35], s57 offen offset:3072 lds
    s_waitcnt vmcnt(16) lgkmcnt(0)
    v_mfma_f32_16x16x32_bf16 v[0:3], a[144:147], a[176:179], v[0:3]
    s_add_u32 s56, s56, 32768
    ds_read_b64_tr_b16 a[128:129], v240 offset:16384
    v_mfma_f32_16x16x32_bf16 v[4:7], a[144:147], a[180:183], v[4:7]
    s_add_u32 s57, s57, 32768
    ds_read_b64_tr_b16 a[130:131], v240 offset:18432
    v_mfma_f32_16x16x32_bf16 v[16:19], a[148:151], a[176:179], v[16:19]
    ds_read_b64_tr_b16 a[132:133], v241 offset:16384
    v_mfma_f32_16x16x32_bf16 v[20:23], a[148:151], a[180:183], v[20:23]
    ds_read_b64_tr_b16 a[134:135], v241 offset:18432
    v_mfma_f32_16x16x32_bf16 v[32:35], a[152:155], a[176:179], v[32:35]
    ds_read_b64_tr_b16 a[136:137], v242 offset:16384
    v_mfma_f32_16x16x32_bf16 v[36:39], a[152:155], a[180:183], v[36:39]
    ds_read_b64_tr_b16 a[138:139], v242 offset:18432
    v_mfma_f32_16x16x32_bf16 v[48:51], a[156:159], a[176:179], v[48:51]
    ds_read_b64_tr_b16 a[140:141], v243 offset:16384
    v_mfma_f32_16x16x32_bf16 v[52:55], a[156:159], a[180:183], v[52:55]
    ds_read_b64_tr_b16 a[142:143], v243 offset:18432
    v_mfma_f32_16x16x32_bf16 v[8:11], a[144:147], a[184:187], v[8:11]
    ds_read_b128 a[160:163], v244 offset:0
    v_mfma_f32_16x16x32_bf16 v[12:15], a[144:147], a[188:191], v[12:15]
    ds_read_b128 a[164:167], v244 offset:1024
    v_mfma_f32_16x16x32_bf16 v[24:27], a[148:151], a[184:187], v[24:27]
    ds_read_b128 a[168:171], v244 offset:2048
    v_mfma_f32_16x16x32_bf16 v[28:31], a[148:151], a[188:191], v[28:31]
    s_add_u32 m0, s55, 12288
    ds_read_b128 a[172:175], v244 offset:3072
    v_mfma_f32_16x16x32_bf16 v[40:43], a[152:155], a[184:187], v[40:43]
    buffer_load_dwordx4 v232, s[32:35], s56 offen lds
    v_mfma_f32_16x16x32_bf16 v[44:47], a[152:155], a[188:191], v[44:47]
    buffer_load_dwordx4 v233, s[32:35], s56 offen offset:1024 lds
    v_mfma_f32_16x16x32_bf16 v[56:59], a[156:159], a[184:187], v[56:59]
    buffer_load_dwordx4 v232, s[32:35], s57 offen offset:2048 lds
    v_mfma_f32_16x16x32_bf16 v[60:63], a[156:159], a[188:191], v[60:63]
    buffer_load_dwordx4 v233, s[32:35], s57 offen offset:3072 lds
    s_waitcnt vmcnt(16) lgkmcnt(0)
    v_mfma_f32_16x16x32_bf16 v[64:67], a[128:131], a[160:163], 0
    s_add_u32 s56, s56, 32768
    ds_read_b64_tr_b16 a[144:145], v240 offset:20480
    v_mfma_f32_16x16x32_bf16 v[68:71], a[128:131], a[164:167], 0
    s_add_u32 s57, s57, 32768
    ds_read_b64_tr_b16 a[146:147], v240 offset:22528
    v_mfma_f32_16x16x32_bf16 v[80:83], a[132:135], a[160:163], 0
    ds_read_b64_tr_b16 a[148:149], v241 offset:20480
    v_mfma_f32_16x16x32_bf16 v[84:87], a[132:135], a[164:167], 0
    ds_read_b64_tr_b16 a[150:151], v241 offset:22528
    v_mfma_f32_16x16x32_bf16 v[96:99], a[136:139], a[160:163], 0
    ds_read_b64_tr_b16 a[152:153], v242 offset:20480
    v_mfma_f32_16x16x32_bf16 v[100:103], a[136:139], a[164:167], 0
    ds_read_b64_tr_b16 a[154:155], v242 offset:22528
    v_mfma_f32_16x16x32_bf16 v[112:115], a[140:143], a[160:163], 0
    ds_read_b64_tr_b16 a[156:157], v243 offset:20480
    v_mfma_f32_16x16x32_bf16 v[116:119], a[140:143], a[164:167], 0
    ds_read_b64_tr_b16 a[158:159], v243 offset:22528
    v_mfma_f32_16x16x32_bf16 v[72:75], a[128:131], a[168:171], 0
    ds_read_b128 a[176:179], v244 offset:4096
    v_mfma_f32_16x16x32_bf16 v[76:79], a[128:131], a[172:175], 0
    ds_read_b128 a[180:183], v244 offset:5120
    v_mfma_f32_16x16x32_bf16 v[88:91], a[132:135], a[168:171], 0
    ds_read_b128 a[184:187], v244 offset:6144
    v_mfma_f32_16x16x32_bf16 v[92:95], a[132:135], a[172:175], 0
    s_add_u32 m0, s55, 16384
    ds_read_b128 a[188:191], v244 offset:7168
    v_mfma_f32_16x16x32_bf16 v[104:107], a[136:139], a[168:171], 0
    buffer_load_dwordx4 v232, s[32:35], s56 offen lds
    v_mfma_f32_16x16x32_bf16 v[108:111], a[136:139], a[172:175], 0
    buffer_load_dwordx4 v233, s[32:35], s56 offen offset:1024 lds
    v_mfma_f32_16x16x32_bf16 v[120:123], a[140:143], a[168:171], 0
    buffer_load_dwordx4 v232, s[32:35], s57 offen offset:2048 lds
    v_mfma_f32_16x16x32_bf16 v[124:127], a[140:143], a[172:175], 0
    buffer_load_dwordx4 v233, s[32:35], s57 offen offset:3072 lds
    s_waitcnt vmcnt(16) lgkmcnt(0)
    v_mfma_f32_16x16x32_bf16 v[64:67], a[144:147], a[176:179], v[64:67]
    s_add_u32 s56, s56, 32768
    ds_read_b64_tr_b16 a[128:129], v240 offset:0
    v_mfma_f32_16x16x32_bf16 v[68:71], a[144:147], a[180:183], v[68:71]
    s_add_u32 s57, s57, 32768
    ds_read_b64_tr_b16 a[130:131], v240 offset:2048
    v_mfma_f32_16x16x32_bf16 v[80:83], a[148:151], a[176:179], v[80:83]
    ds_read_b64_tr_b16 a[132:133], v241 offset:0
    v_mfma_f32_16x16x32_bf16 v[84:87], a[148:151], a[180:183], v[84:87]
    ds_read_b64_tr_b16 a[134:135], v241 offset:2048
    v_mfma_f32_16x16x32_bf16 v[96:99], a[152:155], a[176:179], v[96:99]
    ds_read_b64_tr_b16 a[136:137], v242 offset:0
    v_mfma_f32_16x16x32_bf16 v[100:103], a[152:155], a[180:183], v[100:103]
    ds_read_b64_tr_b16 a[138:139], v242 offset:2048
    v_mfma_f32_16x16x32_bf16 v[112:115], a[156:159], a[176:179], v[112:115]
    ds_read_b64_tr_b16 a[140:141], v243 offset:0
    v_mfma_f32_16x16x32_bf16 v[116:119], a[156:159], a[180:183], v[116:119]
    ds_read_b64_tr_b16 a[142:143], v243 offset:2048
    v_mfma_f32_16x16x32_bf16 v[72:75], a[144:147], a[184:187], v[72:75]
    ds_read_b128 a[160:163], v244 offset:8192
    v_mfma_f32_16x16x32_bf16 v[76:79], a[144:147], a[188:191], v[76:79]
    ds_read_b128 a[164:167], v244 offset:9216
    v_mfma_f32_16x16x32_bf16 v[88:91], a[148:151], a[184:187], v[88:91]
    ds_read_b128 a[168:171], v244 offset:10240
    v_mfma_f32_16x16x32_bf16 v[92:95], a[148:151], a[188:191], v[92:95]
    s_add_u32 m0, s55, 20480
    ds_read_b128 a[172:175], v244 offset:11264
    v_mfma_f32_16x16x32_bf16 v[104:107], a[152:155], a[184:187], v[104:107]
    buffer_load_dwordx4 v232, s[32:35], s56 offen lds
    v_mfma_f32_16x16x32_bf16 v[108:111], a[152:155], a[188:191], v[108:111]
    buffer_load_dwordx4 v233, s[32:35], s56 offen offset:1024 lds
    v_mfma_f32_16x16x32_bf16 v[120:123], a[156:159], a[184:187], v[120:123]
    buffer_load_dwordx4 v232, s[32:35], s57 offen offset:2048 lds
    v_mfma_f32_16x16x32_bf16 v[124:127], a[156:159], a[188:191], v[124:127]
    buffer_load_dwordx4 v233, s[32:35], s57 offen offset:3072 lds
    s_waitcnt vmcnt(16) lgkmcnt(0)
    v_mfma_f32_16x16x32_bf16 v[64:67], a[128:131], a[160:163], v[64:67]
    s_add_u32 s56, s56, 32768
    ds_read_b64_tr_b16 a[144:145], v240 offset:4096
    v_mfma_f32_16x16x32_bf16 v[68:71], a[128:131], a[164:167], v[68:71]
    s_add_u32 s57, s57, 32768
    ds_read_b64_tr_b16 a[146:147], v240 offset:6144
    v_mfma_f32_16x16x32_bf16 v[80:83], a[132:135], a[160:163], v[80:83]
    ds_read_b64_tr_b16 a[148:149], v241 offset:4096
    v_mfma_f32_16x16x32_bf16 v[84:87], a[132:135], a[164:167], v[84:87]
    ds_read_b64_tr_b16 a[150:151], v241 offset:6144
    v_mfma_f32_16x16x32_bf16 v[96:99], a[136:139], a[160:163], v[96:99]
    ds_read_b64_tr_b16 a[152:153], v242 offset:4096
    v_mfma_f32_16x16x32_bf16 v[100:103], a[136:139], a[164:167], v[100:103]
    ds_read_b64_tr_b16 a[154:155], v242 offset:6144
    v_mfma_f32_16x16x32_bf16 v[112:115], a[140:143], a[160:163], v[112:115]
    ds_read_b64_tr_b16 a[156:157], v243 offset:4096
    v_mfma_f32_16x16x32_bf16 v[116:119], a[140:143], a[164:167], v[116:119]
    ds_read_b64_tr_b16 a[158:159], v243 offset:6144
    v_mfma_f32_16x16x32_bf16 v[72:75], a[128:131], a[168:171], v[72:75]
    ds_read_b128 a[176:179], v244 offset:12288
    v_mfma_f32_16x16x32_bf16 v[76:79], a[128:131], a[172:175], v[76:79]
    ds_read_b128 a[180:183], v244 offset:13312
    v_mfma_f32_16x16x32_bf16 v[88:91], a[132:135], a[168:171], v[88:91]
    ds_read_b128 a[184:187], v244 offset:14336
    v_mfma_f32_16x16x32_bf16 v[92:95], a[132:135], a[172:175], v[92:95]
    s_add_u32 m0, s55, 0
    ds_read_b128 a[188:191], v244 offset:15360
    v_mfma_f32_16x16x32_bf16 v[104:107], a[136:139], a[168:171], v[104:107]
    buffer_load_dwordx4 v232, s[32:35], s56 offen lds
    v_mfma_f32_16x16x32_bf16 v[108:111], a[136:139], a[172:175], v[108:111]
    buffer_load_dwordx4 v233, s[32:35], s56 offen offset:1024 lds
    v_mfma_f32_16x16x32_bf16 v[120:123], a[140:143], a[168:171], v[120:123]
    buffer_load_dwordx4 v232, s[32:35], s57 offen offset:2048 lds
    v_mfma_f32_16x16x32_bf16 v[124:127], a[140:143], a[172:175], v[124:127]
    buffer_load_dwordx4 v233, s[32:35], s57 offen offset:3072 lds
    s_waitcnt vmcnt(16) lgkmcnt(0)
    v_mfma_f32_16x16x32_bf16 v[64:67], a[144:147], a[176:179], v[64:67]
    s_add_u32 s56, s56, 32768
    ds_read_b64_tr_b16 a[128:129], v240 offset:8192
    v_mfma_f32_16x16x32_bf16 v[68:71], a[144:147], a[180:183], v[68:71]
    s_add_u32 s57, s57, 32768
    ds_read_b64_tr_b16 a[130:131], v240 offset:10240
    v_mfma_f32_16x16x32_bf16 v[80:83], a[148:151], a[176:179], v[80:83]
    ds_read_b64_tr_b16 a[132:133], v241 offset:8192
    v_mfma_f32_16x16x32_bf16 v[84:87], a[148:151], a[180:183], v[84:87]
    ds_read_b64_tr_b16 a[134:135], v241 offset:10240
    v_mfma_f32_16x16x32_bf16 v[96:99], a[152:155], a[176:179], v[96:99]
    ds_read_b64_tr_b16 a[136:137], v242 offset:8192
    v_mfma_f32_16x16x32_bf16 v[100:103], a[152:155], a[180:183], v[100:103]
    ds_read_b64_tr_b16 a[138:139], v242 offset:10240
    v_mfma_f32_16x16x32_bf16 v[112:115], a[156:159], a[176:179], v[112:115]
    ds_read_b64_tr_b16 a[140:141], v243 offset:8192
    v_mfma_f32_16x16x32_bf16 v[116:119], a[156:159], a[180:183], v[116:119]
    ds_read_b64_tr_b16 a[142:143], v243 offset:10240
    v_mfma_f32_16x16x32_bf16 v[72:75], a[144:147], a[184:187], v[72:75]
    ds_read_b128 a[160:163], v244 offset:16384
    v_mfma_f32_16x16x32_bf16 v[76:79], a[144:147], a[188:191], v[76:79]
    ds_read_b128 a[164:167], v244 offset:17408
    v_mfma_f32_16x16x32_bf16 v[88:91], a[148:151], a[184:187], v[88:91]
    ds_read_b128 a[168:171], v244 offset:18432
    v_mfma_f32_16x16x32_bf16 v[92:95], a[148:151], a[188:191], v[92:95]
    s_add_u32 m0, s55, 4096
    ds_read_b128 a[172:175], v244 offset:19456
    v_mfma_f32_16x16x32_bf16 v[104:107], a[152:155], a[184:187], v[104:107]
    buffer_load_dwordx4 v232, s[32:35], s56 offen lds
    v_mfma_f32_16x16x32_bf16 v[108:111], a[152:155], a[188:191], v[108:111]
    buffer_load_dwordx4 v233, s[32:35], s56 offen offset:1024 lds
    v_mfma_f32_16x16x32_bf16 v[120:123], a[156:159], a[184:187], v[120:123]
    buffer_load_dwordx4 v232, s[32:35], s57 offen offset:2048 lds
    v_mfma_f32_16x16x32_bf16 v[124:127], a[156:159], a[188:191], v[124:127]
    buffer_load_dwordx4 v233, s[32:35], s57 offen offset:3072 lds
    s_waitcnt vmcnt(16) lgkmcnt(0)
    v_mfma_f32_16x16x32_bf16 v[64:67], a[128:131], a[160:163], v[64:67]
    s_add_u32 s56, s56, 32768
    ds_read_b64_tr_b16 a[144:145], v240 offset:12288
    v_mfma_f32_16x16x32_bf16 v[68:71], a[128:131], a[164:167], v[68:71]
    s_add_u32 s57, s57, 32768
    ds_read_b64_tr_b16 a[146:147], v240 offset:14336
    v_mfma_f32_16x16x32_bf16 v[80:83], a[132:135], a[160:163], v[80:83]
    ds_read_b64_tr_b16 a[148:149], v241 offset:12288
    v_mfma_f32_16x16x32_bf16 v[84:87], a[132:135], a[164:167], v[84:87]
    ds_read_b64_tr_b16 a[150:151], v241 offset:14336
    v_mfma_f32_16x16x32_bf16 v[96:99], a[136:139], a[160:163], v[96:99]
    ds_read_b64_tr_b16 a[152:153], v242 offset:12288
    v_mfma_f32_16x16x32_bf16 v[100:103], a[136:139], a[164:167], v[100:103]
    ds_read_b64_tr_b16 a[154:155], v242 offset:14336
    v_mfma_f32_16x16x32_bf16 v[112:115], a[140:143], a[160:163], v[112:115]
    ds_read_b64_tr_b16 a[156:157], v243 offset:12288
    v_mfma_f32_16x16x32_bf16 v[116:119], a[140:143], a[164:167], v[116:119]
    ds_read_b64_tr_b16 a[158:159], v243 offset:14336
    v_mfma_f32_16x16x32_bf16 v[72:75], a[128:131], a[168:171], v[72:75]
    ds_read_b128 a[176:179], v244 offset:20480
    v_mfma_f32_16x16x32_bf16 v[76:79], a[128:131], a[172:175], v[76:79]
    ds_read_b128 a[180:183], v244 offset:21504
    v_mfma_f32_16x16x32_bf16 v[88:91], a[132:135], a[168:171], v[88:91]
    ds_read_b128 a[184:187], v244 offset:22528
    v_mfma_f32_16x16x32_bf16 v[92:95], a[132:135], a[172:175], v[92:95]
    s_add_u32 m0, s55, 8192
    ds_read_b128 a[188:191], v244 offset:23552
    v_mfma_f32_16x16x32_bf16 v[104:107], a[136:139], a[168:171], v[104:107]
    buffer_load_dwordx4 v232, s[32:35], s56 offen lds
    v_mfma_f32_16x16x32_bf16 v[108:111], a[136:139], a[172:175], v[108:111]
    buffer_load_dwordx4 v233, s[32:35], s56 offen offset:1024 lds
    v_mfma_f32_16x16x32_bf16 v[120:123], a[140:143], a[168:171], v[120:123]
    buffer_load_dwordx4 v232, s[32:35], s57 offen offset:2048 lds
    v_mfma_f32_16x16x32_bf16 v[124:127], a[140:143], a[172:175], v[124:127]
    buffer_load_dwordx4 v233, s[32:35], s57 offen offset:3072 lds
    s_waitcnt vmcnt(16) lgkmcnt(0)
    v_mfma_f32_16x16x32_bf16 v[64:67], a[144:147], a[176:179], v[64:67]
    s_add_u32 s56, s56, 32768
    ds_read_b64_tr_b16 a[128:129], v240 offset:16384
    v_mfma_f32_16x16x32_bf16 v[68:71], a[144:147], a[180:183], v[68:71]
    s_add_u32 s57, s57, 32768
    ds_read_b64_tr_b16 a[130:131], v240 offset:18432
    v_mfma_f32_16x16x32_bf16 v[80:83], a[148:151], a[176:179], v[80:83]
    ds_read_b64_tr_b16 a[132:133], v241 offset:16384
    v_mfma_f32_16x16x32_bf16 v[84:87], a[148:151], a[180:183], v[84:87]
    ds_read_b64_tr_b16 a[134:135], v241 offset:18432
    v_mfma_f32_16x16x32_bf16 v[96:99], a[152:155], a[176:179], v[96:99]
    ds_read_b64_tr_b16 a[136:137], v242 offset:16384
    v_mfma_f32_16x16x32_bf16 v[100:103], a[152:155], a[180:183], v[100:103]
    ds_read_b64_tr_b16 a[138:139], v242 offset:18432
    v_mfma_f32_16x16x32_bf16 v[112:115], a[156:159], a[176:179], v[112:115]
    ds_read_b64_tr_b16 a[140:141], v243 offset:16384
    v_mfma_f32_16x16x32_bf16 v[116:119], a[156:159], a[180:183], v[116:119]
    ds_read_b64_tr_b16 a[142:143], v243 offset:18432
    v_mfma_f32_16x16x32_bf16 v[72:75], a[144:147], a[184:187], v[72:75]
    ds_read_b128 a[160:163], v244 offset:24576
    v_mfma_f32_16x16x32_bf16 v[76:79], a[144:147], a[188:191], v[76:79]
    ds_read_b128 a[164:167], v244 offset:25600
    v_mfma_f32_16x16x32_bf16 v[88:91], a[148:151], a[184:187], v[88:91]
    ds_read_b128 a[168:171], v244 offset:26624
    v_mfma_f32_16x16x32_bf16 v[92:95], a[148:151], a[188:191], v[92:95]
    s_add_u32 m0, s55, 12288
    ds_read_b128 a[172:175], v244 offset:27648
    v_mfma_f32_16x16x32_bf16 v[104:107], a[152:155], a[184:187], v[104:107]
    buffer_load_dwordx4 v232, s[32:35], s56 offen lds
    v_mfma_f32_16x16x32_bf16 v[108:111], a[152:155], a[188:191], v[108:111]
    buffer_load_dwordx4 v233, s[32:35], s56 offen offset:1024 lds
    v_mfma_f32_16x16x32_bf16 v[120:123], a[156:159], a[184:187], v[120:123]
    buffer_load_dwordx4 v232, s[32:35], s57 offen offset:2048 lds
    v_mfma_f32_16x16x32_bf16 v[124:127], a[156:159], a[188:191], v[124:127]
    buffer_load_dwordx4 v233, s[32:35], s57 offen offset:3072 lds
    s_waitcnt vmcnt(16) lgkmcnt(0)
    v_mfma_f32_16x16x32_bf16 v[64:67], a[128:131], a[160:163], v[64:67]
    s_add_u32 s56, s56, 32768
    ds_read_b64_tr_b16 a[144:145], v240 offset:20480
    v_mfma_f32_16x16x32_bf16 v[68:71], a[128:131], a[164:167], v[68:71]
    s_add_u32 s57, s57, 32768
    ds_read_b64_tr_b16 a[146:147], v240 offset:22528
    v_mfma_f32_16x16x32_bf16 v[80:83], a[132:135], a[160:163], v[80:83]
    ds_read_b64_tr_b16 a[148:149], v241 offset:20480
    v_mfma_f32_16x16x32_bf16 v[84:87], a[132:135], a[164:167], v[84:87]
    ds_read_b64_tr_b16 a[150:151], v241 offset:22528
    v_mfma_f32_16x16x32_bf16 v[96:99], a[136:139], a[160:163], v[96:99]
    ds_read_b64_tr_b16 a[152:153], v242 offset:20480
    v_mfma_f32_16x16x32_bf16 v[100:103], a[136:139], a[164:167], v[100:103]
    ds_read_b64_tr_b16 a[154:155], v242 offset:22528
    v_mfma_f32_16x16x32_bf16 v[112:115], a[140:143], a[160:163], v[112:115]
    ds_read_b64_tr_b16 a[156:157], v243 offset:20480
    v_mfma_f32_16x16x32_bf16 v[116:119], a[140:143], a[164:167], v[116:119]
    ds_read_b64_tr_b16 a[158:159], v243 offset:22528
    v_mfma_f32_16x16x32_bf16 v[72:75], a[128:131], a[168:171], v[72:75]
    ds_read_b128 a[176:179], v244 offset:28672
    v_mfma_f32_16x16x32_bf16 v[76:79], a[128:131], a[172:175], v[76:79]
    ds_read_b128 a[180:183], v244 offset:29696
    v_mfma_f32_16x16x32_bf16 v[88:91], a[132:135], a[168:171], v[88:91]
    ds_read_b128 a[184:187], v244 offset:30720
    v_mfma_f32_16x16x32_bf16 v[92:95], a[132:135], a[172:175], v[92:95]
    s_add_u32 m0, s55, 16384
    ds_read_b128 a[188:191], v244 offset:31744
    v_mfma_f32_16x16x32_bf16 v[104:107], a[136:139], a[168:171], v[104:107]
    buffer_load_dwordx4 v232, s[32:35], s56 offen lds
    v_mfma_f32_16x16x32_bf16 v[108:111], a[136:139], a[172:175], v[108:111]
    buffer_load_dwordx4 v233, s[32:35], s56 offen offset:1024 lds
    v_mfma_f32_16x16x32_bf16 v[120:123], a[140:143], a[168:171], v[120:123]
    buffer_load_dwordx4 v232, s[32:35], s57 offen offset:2048 lds
    v_mfma_f32_16x16x32_bf16 v[124:127], a[140:143], a[172:175], v[124:127]
    buffer_load_dwordx4 v233, s[32:35], s57 offen offset:3072 lds
    s_waitcnt vmcnt(16) lgkmcnt(0)
    v_mfma_f32_16x16x32_bf16 v[64:67], a[144:147], a[176:179], v[64:67]
    s_add_u32 s56, s56, 32768
    ds_read_b64_tr_b16 a[128:129], v240 offset:0
    v_mfma_f32_16x16x32_bf16 v[68:71], a[144:147], a[180:183], v[68:71]
    s_add_u32 s57, s57, 32768
    ds_read_b64_tr_b16 a[130:131], v240 offset:2048
    v_mfma_f32_16x16x32_bf16 v[80:83], a[148:151], a[176:179], v[80:83]
    ds_read_b64_tr_b16 a[132:133], v241 offset:0
    v_mfma_f32_16x16x32_bf16 v[84:87], a[148:151], a[180:183], v[84:87]
    ds_read_b64_tr_b16 a[134:135], v241 offset:2048
    v_mfma_f32_16x16x32_bf16 v[96:99], a[152:155], a[176:179], v[96:99]
    ds_read_b64_tr_b16 a[136:137], v242 offset:0
    v_mfma_f32_16x16x32_bf16 v[100:103], a[152:155], a[180:183], v[100:103]
    ds_read_b64_tr_b16 a[138:139], v242 offset:2048
    v_mfma_f32_16x16x32_bf16 v[112:115], a[156:159], a[176:179], v[112:115]
    ds_read_b64_tr_b16 a[140:141], v243 offset:0
    v_mfma_f32_16x16x32_bf16 v[116:119], a[156:159], a[180:183], v[116:119]
    ds_read_b64_tr_b16 a[142:143], v243 offset:2048
    v_mfma_f32_16x16x32_bf16 v[72:75], a[144:147], a[184:187], v[72:75]
    ds_read_b128 a[160:163], v244 offset:32768
    v_mfma_f32_16x16x32_bf16 v[76:79], a[144:147], a[188:191], v[76:79]
    ds_read_b128 a[164:167], v244 offset:33792
    v_mfma_f32_16x16x32_bf16 v[88:91], a[148:151], a[184:187], v[88:91]
    ds_read_b128 a[168:171], v244 offset:34816
    v_mfma_f32_16x16x32_bf16 v[92:95], a[148:151], a[188:191], v[92:95]
    s_add_u32 m0, s55, 20480
    ds_read_b128 a[172:175], v244 offset:35840
    v_mfma_f32_16x16x32_bf16 v[104:107], a[152:155], a[184:187], v[104:107]
    buffer_load_dwordx4 v232, s[32:35], s56 offen lds
    v_mfma_f32_16x16x32_bf16 v[108:111], a[152:155], a[188:191], v[108:111]
    buffer_load_dwordx4 v233, s[32:35], s56 offen offset:1024 lds
    v_mfma_f32_16x16x32_bf16 v[120:123], a[156:159], a[184:187], v[120:123]
    buffer_load_dwordx4 v232, s[32:35], s57 offen offset:2048 lds
    v_mfma_f32_16x16x32_bf16 v[124:127], a[156:159], a[188:191], v[124:127]
    buffer_load_dwordx4 v233, s[32:35], s57 offen offset:3072 lds
    s_waitcnt vmcnt(16) lgkmcnt(0)
    v_mfma_f32_16x16x32_bf16 v[64:67], a[128:131], a[160:163], v[64:67]
    s_add_u32 s56, s56, 32768
    ds_read_b64_tr_b16 a[144:145], v240 offset:4096
    v_cvt_pk_bf16_f32 v128, v0, v1
    v_mfma_f32_16x16x32_bf16 v[68:71], a[128:131], a[164:167], v[68:71]
    s_add_u32 s57, s57, 32768
    ds_read_b64_tr_b16 a[146:147], v240 offset:6144
    v_cvt_pk_bf16_f32 v129, v2, v3
    v_mfma_f32_16x16x32_bf16 v[80:83], a[132:135], a[160:163], v[80:83]
    ds_read_b64_tr_b16 a[148:149], v241 offset:4096
    v_cvt_pk_bf16_f32 v130, v16, v17
    v_mfma_f32_16x16x32_bf16 v[84:87], a[132:135], a[164:167], v[84:87]
    ds_read_b64_tr_b16 a[150:151], v241 offset:6144
    v_cvt_pk_bf16_f32 v131, v18, v19
    v_mfma_f32_16x16x32_bf16 v[96:99], a[136:139], a[160:163], v[96:99]
    ds_read_b64_tr_b16 a[152:153], v242 offset:4096
    v_mfma_f32_16x16x32_bf16 v[100:103], a[136:139], a[164:167], v[100:103]
    ds_read_b64_tr_b16 a[154:155], v242 offset:6144
    v_mfma_f32_16x16x32_bf16 v[112:115], a[140:143], a[160:163], v[112:115]
    ds_read_b64_tr_b16 a[156:157], v243 offset:4096
    buffer_store_dwordx4 v[128:131], v245, s[48:51], s68 offen offset:0 sc1
    v_mfma_f32_16x16x32_bf16 v[116:119], a[140:143], a[164:167], v[116:119]
    ds_read_b64_tr_b16 a[158:159], v243 offset:6144
    v_mfma_f32_16x16x32_bf16 v[72:75], a[128:131], a[168:171], v[72:75]
    ds_read_b128 a[176:179], v244 offset:36864
    v_mfma_f32_16x16x32_bf16 v[76:79], a[128:131], a[172:175], v[76:79]
    ds_read_b128 a[180:183], v244 offset:37888
    v_mfma_f32_16x16x32_bf16 v[88:91], a[132:135], a[168:171], v[88:91]
    ds_read_b128 a[184:187], v244 offset:38912
    v_mfma_f32_16x16x32_bf16 v[92:95], a[132:135], a[172:175], v[92:95]
    s_add_u32 m0, s55, 0
    ds_read_b128 a[188:191], v244 offset:39936
    v_mfma_f32_16x16x32_bf16 v[104:107], a[136:139], a[168:171], v[104:107]
    buffer_load_dwordx4 v232, s[32:35], s56 offen lds
    v_mfma_f32_16x16x32_bf16 v[108:111], a[136:139], a[172:175], v[108:111]
    buffer_load_dwordx4 v233, s[32:35], s56 offen offset:1024 lds
    v_mfma_f32_16x16x32_bf16 v[120:123], a[140:143], a[168:171], v[120:123]
    buffer_load_dwordx4 v232, s[32:35], s57 offen offset:2048 lds
    v_mfma_f32_16x16x32_bf16 v[124:127], a[140:143], a[172:175], v[124:127]
    buffer_load_dwordx4 v233, s[32:35], s57 offen offset:3072 lds
    s_waitcnt vmcnt(17) lgkmcnt(0)
    v_mfma_f32_16x16x32_bf16 v[64:67], a[144:147], a[176:179], v[64:67]
    s_add_u32 s56, s56, 32768
    ds_read_b64_tr_b16 a[128:129], v240 offset:8192
    v_cvt_pk_bf16_f32 v132, v4, v5
    v_mfma_f32_16x16x32_bf16 v[68:71], a[144:147], a[180:183], v[68:71]
    s_add_u32 s57, s57, 32768
    ds_read_b64_tr_b16 a[130:131], v240 offset:10240
    v_cvt_pk_bf16_f32 v133, v6, v7
    v_mfma_f32_16x16x32_bf16 v[80:83], a[148:151], a[176:179], v[80:83]
    ds_read_b64_tr_b16 a[132:133], v241 offset:8192
    v_cvt_pk_bf16_f32 v134, v20, v21
    v_mfma_f32_16x16x32_bf16 v[84:87], a[148:151], a[180:183], v[84:87]
    ds_read_b64_tr_b16 a[134:135], v241 offset:10240
    v_cvt_pk_bf16_f32 v135, v22, v23
    v_mfma_f32_16x16x32_bf16 v[96:99], a[152:155], a[176:179], v[96:99]
    ds_read_b64_tr_b16 a[136:137], v242 offset:8192
    v_mfma_f32_16x16x32_bf16 v[100:103], a[152:155], a[180:183], v[100:103]
    ds_read_b64_tr_b16 a[138:139], v242 offset:10240
    v_mfma_f32_16x16x32_bf16 v[112:115], a[156:159], a[176:179], v[112:115]
    ds_read_b64_tr_b16 a[140:141], v243 offset:8192
    buffer_store_dwordx4 v[132:135], v245, s[48:51], s68 offen offset:2048 sc1
    v_mfma_f32_16x16x32_bf16 v[116:119], a[156:159], a[180:183], v[116:119]
    ds_read_b64_tr_b16 a[142:143], v243 offset:10240
    v_mfma_f32_16x16x32_bf16 v[72:75], a[144:147], a[184:187], v[72:75]
    ds_read_b128 a[160:163], v244 offset:40960
    v_mfma_f32_16x16x32_bf16 v[76:79], a[144:147], a[188:191], v[76:79]
    ds_read_b128 a[164:167], v244 offset:41984
    v_mfma_f32_16x16x32_bf16 v[88:91], a[148:151], a[184:187], v[88:91]
    ds_read_b128 a[168:171], v244 offset:43008
    v_mfma_f32_16x16x32_bf16 v[92:95], a[148:151], a[188:191], v[92:95]
    s_add_u32 m0, s55, 4096
    ds_read_b128 a[172:175], v244 offset:44032
    v_mfma_f32_16x16x32_bf16 v[104:107], a[152:155], a[184:187], v[104:107]
    buffer_load_dwordx4 v232, s[32:35], s56 offen lds
    v_mfma_f32_16x16x32_bf16 v[108:111], a[152:155], a[188:191], v[108:111]
    buffer_load_dwordx4 v233, s[32:35], s56 offen offset:1024 lds
    v_mfma_f32_16x16x32_bf16 v[120:123], a[156:159], a[184:187], v[120:123]
    buffer_load_dwordx4 v232, s[32:35], s57 offen offset:2048 lds
    v_mfma_f32_16x16x32_bf16 v[124:127], a[156:159], a[188:191], v[124:127]
    buffer_load_dwordx4 v233, s[32:35], s57 offen offset:3072 lds
    s_waitcnt vmcnt(18) lgkmcnt(0)
    v_mfma_f32_16x16x32_bf16 v[64:67], a[128:131], a[160:163], v[64:67]
    s_add_u32 s56, s56, 32768
    ds_read_b64_tr_b16 a[144:145], v240 offset:12288
    v_cvt_pk_bf16_f32 v136, v8, v9
    v_mfma_f32_16x16x32_bf16 v[68:71], a[128:131], a[164:167], v[68:71]
    s_add_u32 s57, s57, 32768
    ds_read_b64_tr_b16 a[146:147], v240 offset:14336
    v_cvt_pk_bf16_f32 v137, v10, v11
    v_mfma_f32_16x16x32_bf16 v[80:83], a[132:135], a[160:163], v[80:83]
    ds_read_b64_tr_b16 a[148:149], v241 offset:12288
    v_cvt_pk_bf16_f32 v138, v24, v25
    v_mfma_f32_16x16x32_bf16 v[84:87], a[132:135], a[164:167], v[84:87]
    ds_read_b64_tr_b16 a[150:151], v241 offset:14336
    v_cvt_pk_bf16_f32 v139, v26, v27
    v_mfma_f32_16x16x32_bf16 v[96:99], a[136:139], a[160:163], v[96:99]
    ds_read_b64_tr_b16 a[152:153], v242 offset:12288
    v_mfma_f32_16x16x32_bf16 v[100:103], a[136:139], a[164:167], v[100:103]
    ds_read_b64_tr_b16 a[154:155], v242 offset:14336
    v_mfma_f32_16x16x32_bf16 v[112:115], a[140:143], a[160:163], v[112:115]
    ds_read_b64_tr_b16 a[156:157], v243 offset:12288
    v_mfma_f32_16x16x32_bf16 v[116:119], a[140:143], a[164:167], v[116:119]
    ds_read_b64_tr_b16 a[158:159], v243 offset:14336
    v_mfma_f32_16x16x32_bf16 v[72:75], a[128:131], a[168:171], v[72:75]
    ds_read_b128 a[176:179], v244 offset:45056
    v_mfma_f32_16x16x32_bf16 v[76:79], a[128:131], a[172:175], v[76:79]
    ds_read_b128 a[180:183], v244 offset:46080
    v_mfma_f32_16x16x32_bf16 v[88:91], a[132:135], a[168:171], v[88:91]
    ds_read_b128 a[184:187], v244 offset:47104
    v_mfma_f32_16x16x32_bf16 v[92:95], a[132:135], a[172:175], v[92:95]
    ds_read_b128 a[188:191], v244 offset:48128
    v_mfma_f32_16x16x32_bf16 v[104:107], a[136:139], a[168:171], v[104:107]
    buffer_store_dwordx4 v[136:139], v245, s[48:51], s69 offen offset:0 sc1
    v_mfma_f32_16x16x32_bf16 v[108:111], a[136:139], a[172:175], v[108:111]
    buffer_load_dwordx4 v[192:195], v200, s[28:31], s65 offen
    v_mfma_f32_16x16x32_bf16 v[120:123], a[140:143], a[168:171], v[120:123]
    buffer_load_dwordx4 v[196:199], v200, s[28:31], s75 offen
    v_mfma_f32_16x16x32_bf16 v[124:127], a[140:143], a[172:175], v[124:127]
    s_waitcnt vmcnt(17) lgkmcnt(0)
    v_mfma_f32_16x16x32_bf16 v[64:67], a[144:147], a[176:179], v[64:67]
    ds_read_b64_tr_b16 a[128:129], v240 offset:16384
    v_cvt_pk_bf16_f32 v140, v12, v13
    v_mfma_f32_16x16x32_bf16 v[68:71], a[144:147], a[180:183], v[68:71]
    ds_read_b64_tr_b16 a[130:131], v240 offset:18432
    v_cvt_pk_bf16_f32 v141, v14, v15
    v_mfma_f32_16x16x32_bf16 v[80:83], a[148:151], a[176:179], v[80:83]
    ds_read_b64_tr_b16 a[132:133], v241 offset:16384
    v_cvt_pk_bf16_f32 v142, v28, v29
    v_mfma_f32_16x16x32_bf16 v[84:87], a[148:151], a[180:183], v[84:87]
    ds_read_b64_tr_b16 a[134:135], v241 offset:18432
    v_cvt_pk_bf16_f32 v143, v30, v31
    v_mfma_f32_16x16x32_bf16 v[96:99], a[152:155], a[176:179], v[96:99]
    ds_read_b64_tr_b16 a[136:137], v242 offset:16384
    v_mfma_f32_16x16x32_bf16 v[100:103], a[152:155], a[180:183], v[100:103]
    ds_read_b64_tr_b16 a[138:139], v242 offset:18432
    v_mfma_f32_16x16x32_bf16 v[112:115], a[156:159], a[176:179], v[112:115]
    ds_read_b64_tr_b16 a[140:141], v243 offset:16384
    v_mfma_f32_16x16x32_bf16 v[116:119], a[156:159], a[180:183], v[116:119]
    ds_read_b64_tr_b16 a[142:143], v243 offset:18432
    v_mfma_f32_16x16x32_bf16 v[72:75], a[144:147], a[184:187], v[72:75]
    ds_read_b128 a[160:163], v244 offset:49152
    v_mfma_f32_16x16x32_bf16 v[76:79], a[144:147], a[188:191], v[76:79]
    ds_read_b128 a[164:167], v244 offset:50176
    v_mfma_f32_16x16x32_bf16 v[88:91], a[148:151], a[184:187], v[88:91]
    ds_read_b128 a[168:171], v244 offset:51200
    v_mfma_f32_16x16x32_bf16 v[92:95], a[148:151], a[188:191], v[92:95]
    ds_read_b128 a[172:175], v244 offset:52224
    v_mfma_f32_16x16x32_bf16 v[104:107], a[152:155], a[184:187], v[104:107]
    buffer_store_dwordx4 v[140:143], v245, s[48:51], s69 offen offset:2048 sc1
    v_mfma_f32_16x16x32_bf16 v[108:111], a[152:155], a[188:191], v[108:111]
    v_mfma_f32_16x16x32_bf16 v[120:123], a[156:159], a[184:187], v[120:123]
    v_mfma_f32_16x16x32_bf16 v[124:127], a[156:159], a[188:191], v[124:127]
    s_waitcnt vmcnt(14) lgkmcnt(0)
    v_mfma_f32_16x16x32_bf16 v[64:67], a[128:131], a[160:163], v[64:67]
    ds_read_b64_tr_b16 a[144:145], v240 offset:20480
    v_cvt_pk_bf16_f32 v144, v32, v33
    v_mfma_f32_16x16x32_bf16 v[68:71], a[128:131], a[164:167], v[68:71]
    ds_read_b64_tr_b16 a[146:147], v240 offset:22528
    v_cvt_pk_bf16_f32 v145, v34, v35
    v_mfma_f32_16x16x32_bf16 v[80:83], a[132:135], a[160:163], v[80:83]
    ds_read_b64_tr_b16 a[148:149], v241 offset:20480
    v_cvt_pk_bf16_f32 v146, v48, v49
    v_mfma_f32_16x16x32_bf16 v[84:87], a[132:135], a[164:167], v[84:87]
    ds_read_b64_tr_b16 a[150:151], v241 offset:22528
    v_cvt_pk_bf16_f32 v147, v50, v51
    v_mfma_f32_16x16x32_bf16 v[96:99], a[136:139], a[160:163], v[96:99]
    ds_read_b64_tr_b16 a[152:153], v242 offset:20480
    v_mfma_f32_16x16x32_bf16 v[100:103], a[136:139], a[164:167], v[100:103]
    ds_read_b64_tr_b16 a[154:155], v242 offset:22528
    v_mfma_f32_16x16x32_bf16 v[112:115], a[140:143], a[160:163], v[112:115]
    ds_read_b64_tr_b16 a[156:157], v243 offset:20480
    v_mfma_f32_16x16x32_bf16 v[116:119], a[140:143], a[164:167], v[116:119]
    ds_read_b64_tr_b16 a[158:159], v243 offset:22528
    v_mfma_f32_16x16x32_bf16 v[72:75], a[128:131], a[168:171], v[72:75]
    ds_read_b128 a[176:179], v244 offset:53248
    v_mfma_f32_16x16x32_bf16 v[76:79], a[128:131], a[172:175], v[76:79]
    ds_read_b128 a[180:183], v244 offset:54272
    v_mfma_f32_16x16x32_bf16 v[88:91], a[132:135], a[168:171], v[88:91]
    ds_read_b128 a[184:187], v244 offset:55296
    v_mfma_f32_16x16x32_bf16 v[92:95], a[132:135], a[172:175], v[92:95]
    ds_read_b128 a[188:191], v244 offset:56320
    v_mfma_f32_16x16x32_bf16 v[104:107], a[136:139], a[168:171], v[104:107]
    buffer_store_dwordx4 v[144:147], v245, s[48:51], s68 offen offset:1024 sc1
    v_mfma_f32_16x16x32_bf16 v[108:111], a[136:139], a[172:175], v[108:111]
    v_mfma_f32_16x16x32_bf16 v[120:123], a[140:143], a[168:171], v[120:123]
    v_mfma_f32_16x16x32_bf16 v[124:127], a[140:143], a[172:175], v[124:127]
    s_waitcnt vmcnt(10) lgkmcnt(0)
    v_mfma_f32_16x16x32_bf16 v[64:67], a[144:147], a[176:179], v[64:67]
    ds_read_b64_tr_b16 a[128:129], v240 offset:0
    v_cvt_pk_bf16_f32 v148, v36, v37
    v_mfma_f32_16x16x32_bf16 v[68:71], a[144:147], a[180:183], v[68:71]
    ds_read_b64_tr_b16 a[130:131], v240 offset:2048
    v_cvt_pk_bf16_f32 v149, v38, v39
    v_mfma_f32_16x16x32_bf16 v[80:83], a[148:151], a[176:179], v[80:83]
    ds_read_b64_tr_b16 a[132:133], v241 offset:0
    v_cvt_pk_bf16_f32 v150, v52, v53
    v_mfma_f32_16x16x32_bf16 v[84:87], a[148:151], a[180:183], v[84:87]
    ds_read_b64_tr_b16 a[134:135], v241 offset:2048
    v_cvt_pk_bf16_f32 v151, v54, v55
    v_mfma_f32_16x16x32_bf16 v[96:99], a[152:155], a[176:179], v[96:99]
    ds_read_b64_tr_b16 a[136:137], v242 offset:0
    v_mfma_f32_16x16x32_bf16 v[100:103], a[152:155], a[180:183], v[100:103]
    ds_read_b64_tr_b16 a[138:139], v242 offset:2048
    v_mfma_f32_16x16x32_bf16 v[112:115], a[156:159], a[176:179], v[112:115]
    ds_read_b64_tr_b16 a[140:141], v243 offset:0
    v_mfma_f32_16x16x32_bf16 v[116:119], a[156:159], a[180:183], v[116:119]
    ds_read_b64_tr_b16 a[142:143], v243 offset:2048
    v_mfma_f32_16x16x32_bf16 v[72:75], a[144:147], a[184:187], v[72:75]
    ds_read_b128 a[160:163], v244 offset:57344
    v_mfma_f32_16x16x32_bf16 v[76:79], a[144:147], a[188:191], v[76:79]
    ds_read_b128 a[164:167], v244 offset:58368
    v_mfma_f32_16x16x32_bf16 v[88:91], a[148:151], a[184:187], v[88:91]
    ds_read_b128 a[168:171], v244 offset:59392
    v_mfma_f32_16x16x32_bf16 v[92:95], a[148:151], a[188:191], v[92:95]
    ds_read_b128 a[172:175], v244 offset:60416
    v_mfma_f32_16x16x32_bf16 v[104:107], a[152:155], a[184:187], v[104:107]
    buffer_store_dwordx4 v[148:151], v245, s[48:51], s68 offen offset:3072 sc1
    v_mfma_f32_16x16x32_bf16 v[108:111], a[152:155], a[188:191], v[108:111]
    v_mfma_f32_16x16x32_bf16 v[120:123], a[156:159], a[184:187], v[120:123]
    v_mfma_f32_16x16x32_bf16 v[124:127], a[156:159], a[188:191], v[124:127]
    s_waitcnt vmcnt(6) lgkmcnt(0)
    v_mfma_f32_16x16x32_bf16 v[64:67], a[128:131], a[160:163], v[64:67]
    ds_read_b64_tr_b16 a[144:145], v240 offset:4096
    v_cvt_pk_bf16_f32 v152, v40, v41
    v_mfma_f32_16x16x32_bf16 v[68:71], a[128:131], a[164:167], v[68:71]
    ds_read_b64_tr_b16 a[146:147], v240 offset:6144
    v_cvt_pk_bf16_f32 v153, v42, v43
    v_mfma_f32_16x16x32_bf16 v[80:83], a[132:135], a[160:163], v[80:83]
    ds_read_b64_tr_b16 a[148:149], v241 offset:4096
    v_cvt_pk_bf16_f32 v154, v56, v57
    v_mfma_f32_16x16x32_bf16 v[84:87], a[132:135], a[164:167], v[84:87]
    ds_read_b64_tr_b16 a[150:151], v241 offset:6144
    v_cvt_pk_bf16_f32 v155, v58, v59
    v_mfma_f32_16x16x32_bf16 v[96:99], a[136:139], a[160:163], v[96:99]
    ds_read_b64_tr_b16 a[152:153], v242 offset:4096
    v_mfma_f32_16x16x32_bf16 v[100:103], a[136:139], a[164:167], v[100:103]
    ds_read_b64_tr_b16 a[154:155], v242 offset:6144
    v_mfma_f32_16x16x32_bf16 v[112:115], a[140:143], a[160:163], v[112:115]
    ds_read_b64_tr_b16 a[156:157], v243 offset:4096
    v_mfma_f32_16x16x32_bf16 v[116:119], a[140:143], a[164:167], v[116:119]
    ds_read_b64_tr_b16 a[158:159], v243 offset:6144
    v_mfma_f32_16x16x32_bf16 v[72:75], a[128:131], a[168:171], v[72:75]
    ds_read_b128 a[176:179], v244 offset:61440
    v_mfma_f32_16x16x32_bf16 v[76:79], a[128:131], a[172:175], v[76:79]
    ds_read_b128 a[180:183], v244 offset:62464
    v_mfma_f32_16x16x32_bf16 v[88:91], a[132:135], a[168:171], v[88:91]
    ds_read_b128 a[184:187], v244 offset:63488
    v_mfma_f32_16x16x32_bf16 v[92:95], a[132:135], a[172:175], v[92:95]
    ds_read_b128 a[188:191], v244 offset:64512
    v_mfma_f32_16x16x32_bf16 v[104:107], a[136:139], a[168:171], v[104:107]
    buffer_store_dwordx4 v[152:155], v245, s[48:51], s69 offen offset:1024 sc1
    v_mfma_f32_16x16x32_bf16 v[108:111], a[136:139], a[172:175], v[108:111]
    v_mfma_f32_16x16x32_bf16 v[120:123], a[140:143], a[168:171], v[120:123]
    v_mfma_f32_16x16x32_bf16 v[124:127], a[140:143], a[172:175], v[124:127]
    s_waitcnt lgkmcnt(0)
    v_mfma_f32_16x16x32_bf16 v[64:67], a[144:147], a[176:179], v[64:67]
    v_cvt_pk_bf16_f32 v156, v44, v45
    v_mfma_f32_16x16x32_bf16 v[68:71], a[144:147], a[180:183], v[68:71]
    v_cvt_pk_bf16_f32 v157, v46, v47
    v_mfma_f32_16x16x32_bf16 v[80:83], a[148:151], a[176:179], v[80:83]
    v_cvt_pk_bf16_f32 v158, v60, v61
    v_mfma_f32_16x16x32_bf16 v[84:87], a[148:151], a[180:183], v[84:87]
    v_cvt_pk_bf16_f32 v159, v62, v63
    v_mfma_f32_16x16x32_bf16 v[96:99], a[152:155], a[176:179], v[96:99]
    v_mfma_f32_16x16x32_bf16 v[100:103], a[152:155], a[180:183], v[100:103]
    v_mfma_f32_16x16x32_bf16 v[112:115], a[156:159], a[176:179], v[112:115]
    v_mfma_f32_16x16x32_bf16 v[116:119], a[156:159], a[180:183], v[116:119]
    v_mfma_f32_16x16x32_bf16 v[72:75], a[144:147], a[184:187], v[72:75]
    v_mfma_f32_16x16x32_bf16 v[76:79], a[144:147], a[188:191], v[76:79]
    v_mfma_f32_16x16x32_bf16 v[88:91], a[148:151], a[184:187], v[88:91]
    v_mfma_f32_16x16x32_bf16 v[92:95], a[148:151], a[188:191], v[92:95]
    v_mfma_f32_16x16x32_bf16 v[104:107], a[152:155], a[184:187], v[104:107]
    buffer_store_dwordx4 v[156:159], v245, s[48:51], s69 offen offset:3072 sc1
    v_mfma_f32_16x16x32_bf16 v[108:111], a[152:155], a[188:191], v[108:111]
    buffer_load_dword v202, v201, s[48:51], s66 offen sc1
    v_mfma_f32_16x16x32_bf16 v[120:123], a[156:159], a[184:187], v[120:123]
    v_mfma_f32_16x16x32_bf16 v[124:127], a[156:159], a[188:191], v[124:127]
    v_cvt_pk_bf16_f32 v160, v64, v65
    v_cvt_pk_bf16_f32 v161, v66, v67
    v_cvt_pk_bf16_f32 v162, v80, v81
    v_cvt_pk_bf16_f32 v163, v82, v83
    buffer_store_dwordx4 v[160:163], v245, s[48:51], s70 offen offset:0 sc1
    v_cvt_pk_bf16_f32 v164, v68, v69
    v_cvt_pk_bf16_f32 v165, v70, v71
    v_cvt_pk_bf16_f32 v166, v84, v85
    v_cvt_pk_bf16_f32 v167, v86, v87
    buffer_store_dwordx4 v[164:167], v245, s[48:51], s70 offen offset:2048 sc1
    v_cvt_pk_bf16_f32 v168, v72, v73
    v_cvt_pk_bf16_f32 v169, v74, v75
    v_cvt_pk_bf16_f32 v170, v88, v89
    v_cvt_pk_bf16_f32 v171, v90, v91
    buffer_store_dwordx4 v[168:171], v245, s[48:51], s71 offen offset:0 sc1
    v_cvt_pk_bf16_f32 v172, v76, v77
    v_cvt_pk_bf16_f32 v173, v78, v79
    v_cvt_pk_bf16_f32 v174, v92, v93
    v_cvt_pk_bf16_f32 v175, v94, v95
    buffer_store_dwordx4 v[172:175], v245, s[48:51], s71 offen offset:2048 sc1
    v_cvt_pk_bf16_f32 v176, v96, v97
    v_cvt_pk_bf16_f32 v177, v98, v99
    v_cvt_pk_bf16_f32 v178, v112, v113
    v_cvt_pk_bf16_f32 v179, v114, v115
    buffer_store_dwordx4 v[176:179], v245, s[48:51], s70 offen offset:1024 sc1
    v_cvt_pk_bf16_f32 v180, v100, v101
    v_cvt_pk_bf16_f32 v181, v102, v103
    v_cvt_pk_bf16_f32 v182, v116, v117
    v_cvt_pk_bf16_f32 v183, v118, v119
    buffer_store_dwordx4 v[180:183], v245, s[48:51], s70 offen offset:3072 sc1
    v_cvt_pk_bf16_f32 v184, v104, v105
    v_cvt_pk_bf16_f32 v185, v106, v107
    v_cvt_pk_bf16_f32 v186, v120, v121
    v_cvt_pk_bf16_f32 v187, v122, v123
    buffer_store_dwordx4 v[184:187], v245, s[48:51], s71 offen offset:1024 sc1
    v_cvt_pk_bf16_f32 v188, v108, v109
    v_cvt_pk_bf16_f32 v189, v110, v111
    v_cvt_pk_bf16_f32 v190, v124, v125
    v_cvt_pk_bf16_f32 v191, v126, v127
    buffer_store_dwordx4 v[188:191], v245, s[48:51], s71 offen offset:3072 sc1
    s_barrier
    ds_write_b128 v203, a[192:195] offset:0
    ds_write_b128 v203, a[208:211] offset:1024
    ds_write_b128 v203, a[224:227] offset:2048
    ds_write_b128 v203, a[240:243] offset:3072
    ds_write_b128 v203, a[196:199] offset:16384
    ds_write_b128 v203, a[212:215] offset:17408
    ds_write_b128 v203, a[228:231] offset:18432
    ds_write_b128 v203, a[244:247] offset:19456
    ds_write_b128 v203, a[200:203] offset:32768
    ds_write_b128 v203, a[216:219] offset:33792
    ds_write_b128 v203, a[232:235] offset:34816
    ds_write_b128 v203, a[248:251] offset:35840
    ds_write_b128 v203, a[204:207] offset:49152
    ds_write_b128 v203, a[220:223] offset:50176
    ds_write_b128 v203, a[236:239] offset:51200
    ds_write_b128 v203, a[252:255] offset:52224
    v_mov_b32 v0, 0
    v_mov_b32 v1, 0
    v_mov_b32 v2, 0
    v_mov_b32 v3, 0
    v_mov_b32 v4, 0
    v_mov_b32 v5, 0
    v_mov_b32 v6, 0
    v_mov_b32 v7, 0
    v_mov_b32 v8, 0
    v_mov_b32 v9, 0
    v_mov_b32 v10, 0
    v_mov_b32 v11, 0
    v_mov_b32 v12, 0
    v_mov_b32 v13, 0
    v_mov_b32 v14, 0
    v_mov_b32 v15, 0
    s_waitcnt lgkmcnt(0)
    s_barrier
    ds_read_b128 v[64:67], v204 offset:0
    ds_read_b128 v[68:71], v204 offset:1024
    ds_read_b128 v[72:75], v204 offset:2048
    ds_read_b128 v[76:79], v204 offset:3072
    ds_read_b128 v[80:83], v204 offset:4096
    ds_read_b128 v[84:87], v204 offset:5120
    ds_read_b128 v[88:91], v204 offset:6144
    ds_read_b128 v[92:95], v204 offset:7168
    ds_read_b128 v[96:99], v204 offset:8192
    ds_read_b128 v[100:103], v204 offset:9216
    ds_read_b128 v[104:107], v204 offset:10240
    ds_read_b128 v[108:111], v204 offset:11264
    ds_read_b128 v[112:115], v204 offset:12288
    ds_read_b128 v[116:119], v204 offset:13312
    ds_read_b128 v[120:123], v204 offset:14336
    ds_read_b128 v[124:127], v204 offset:15360
    v_mov_b32 v205, 1
    s_waitcnt vmcnt(0)
    s_mov_b64 exec, 1
    buffer_store_dword v205, off, s[48:51], s90 sc1
    s_mov_b64 exec, -1
    v_cmp_eq_u32 vcc, 1, v202
    s_mov_b32 s73, 0
    s_nop 0
    s_lshr_b32 s64, vcc_lo, 1
    s_and_b32 s74, vcc_lo, s64
    s_lshr_b32 s64, s74, 2
    s_and_b32 s74, s74, s64
    s_and_b32 s74, s74, 0x11111111
    s_andn2_b32 s74, s74, s73
    s_or_b32 s73, s73, s74
    s_bcnt1_i32_b32 s70, s74
    s_cmp_eq_u32 s70, 0
    s_cbranch_scc1 M_ASKED1
    s_ff1_i32_b32 s64, s74
    s_bitset0_b32 s74, s64
    s_lshl_b32 s64, s64, 11
    s_add_u32 s64, s64, s72
    buffer_load_dwordx4 v[16:19], v245, s[48:51], s64 offen offset:0 sc1
    buffer_load_dwordx4 v[20:23], v245, s[48:51], s64 offen offset:1024 sc1
    s_cmp_eq_u32 s70, 1
    s_cbranch_scc1 M_ASKED1
    s_ff1_i32_b32 s64, s74
    s_bitset0_b32 s74, s64
    s_lshl_b32 s64, s64, 11
    s_add_u32 s64, s64, s72
    buffer_load_dwordx4 v[24:27], v245, s[48:51], s64 offen offset:0 sc1
    buffer_load_dwordx4 v[28:31], v245, s[48:51], s64 offen offset:1024 sc1
    s_cmp_eq_u32 s70, 2
    s_cbranch_scc1 M_ASKED1
    s_ff1_i32_b32 s64, s74
    s_bitset0_b32 s74, s64
    s_lshl_b32 s64, s64, 11
    s_add_u32 s64, s64, s72
    buffer_load_dwordx4 v[32:35], v245, s[48:51], s64 offen offset:0 sc1
    buffer_load_dwordx4 v[36:39], v245, s[48:51], s64 offen offset:1024 sc1
    s_cmp_eq_u32 s70, 3
    s_cbranch_scc1 M_ASKED1
    s_ff1_i32_b32 s64, s74
    s_bitset0_b32 s74, s64
    s_lshl_b32 s64, s64, 11
    s_add_u32 s64, s64, s72
    buffer_load_dwordx4 v[40:43], v245, s[48:51], s64 offen offset:0 sc1
    buffer_load_dwordx4 v[44:47], v245, s[48:51], s64 offen offset:1024 sc1
    s_cmp_eq_u32 s70, 4
    s_cbranch_scc1 M_ASKED1
    s_ff1_i32_b32 s64, s74
    s_bitset0_b32 s74, s64
    s_lshl_b32 s64, s64, 11
    s_add_u32 s64, s64, s72
    buffer_load_dwordx4 v[48:51], v245, s[48:51], s64 offen offset:0 sc1
    buffer_load_dwordx4 v[52:55], v245, s[48:51], s64 offen offset:1024 sc1
    s_cmp_eq_u32 s70, 5
    s_cbranch_scc1 M_ASKED1
    s_ff1_i32_b32 s64, s74
    s_bitset0_b32 s74, s64
    s_lshl_b32 s64, s64, 11
    s_add_u32 s64, s64, s72
    buffer_load_dwordx4 v[56:59], v245, s[48:51], s64 offen offset:0 sc1
    buffer_load_dwordx4 v[60:63], v245, s[48:51], s64 offen offset:1024 sc1
    s_cmp_eq_u32 s70, 6
    s_cbranch_scc1 M_ASKED1
    s_ff1_i32_b32 s64, s74
    s_bitset0_b32 s74, s64
    s_lshl_b32 s64, s64, 11
    s_add_u32 s64, s64, s72
    buffer_load_dwordx4 v[208:211], v245, s[48:51], s64 offen offset:0 sc1
    buffer_load_dwordx4 v[212:215], v245, s[48:51], s64 offen offset:1024 sc1
    s_cmp_eq_u32 s70, 7
    s_cbranch_scc1 M_ASKED1
    s_ff1_i32_b32 s64, s74
    s_bitset0_b32 s74, s64
    s_lshl_b32 s64, s64, 11
    s_add_u32 s64, s64, s72
    buffer_load_dwordx4 v[216:219], v245, s[48:51], s64 offen offset:0 sc1
    buffer_load_dwordx4 v[220:223], v245, s[48:51], s64 offen offset:1024 sc1
M_ASKED1:
    s_waitcnt lgkmcnt(8)
    v_pk_add_f32 v[64:65], v[64:65], v[80:81]
    v_pk_add_f32 v[66:67], v[66:67], v[82:83]
    v_pk_add_f32 v[68:69], v[68:69], v[84:85]
    v_pk_add_f32 v[70:71], v[70:71], v[86:87]
    v_pk_add_f32 v[72:73], v[72:73], v[88:89]
    v_pk_add_f32 v[74:75], v[74:75], v[90:91]
    v_pk_add_f32 v[76:77], v[76:77], v[92:93]
    v_pk_add_f32 v[78:79], v[78:79], v[94:95]
    s_waitcnt lgkmcnt(0)
    v_pk_add_f32 v[96:97], v[96:97], v[112:113]
    v_pk_add_f32 v[98:99], v[98:99], v[114:115]
    v_pk_add_f32 v[100:101], v[100:101], v[116:117]
    v_pk_add_f32 v[102:103], v[102:103], v[118:119]
    v_pk_add_f32 v[104:105], v[104:105], v[120:121]
    v_pk_add_f32 v[106:107], v[106:107], v[122:123]
    v_pk_add_f32 v[108:109], v[108:109], v[124:125]
    v_pk_add_f32 v[110:111], v[110:111], v[126:127]
    s_mov_b32 s68, 0x4275fdf0
    s_mov_b32 s69, s68
    v_pk_add_f32 v[64:65], v[64:65], v[96:97]
    v_pk_add_f32 v[66:67], v[66:67], v[98:99]
    v_pk_add_f32 v[68:69], v[68:69], v[100:101]
    v_pk_add_f32 v[70:71], v[70:71], v[102:103]
    v_pk_add_f32 v[72:73], v[72:73], v[104:105]
    v_pk_add_f32 v[74:75], v[74:75], v[106:107]
    v_pk_add_f32 v[76:77], v[76:77], v[108:109]
    v_pk_add_f32 v[78:79], v[78:79], v[110:111]
    v_pk_mul_f32 v[64:65], v[64:65], s[68:69]
    v_pk_mul_f32 v[66:67], v[66:67], s[68:69]
    v_pk_mul_f32 v[68:69], v[68:69], s[68:69]
    v_pk_mul_f32 v[70:71], v[70:71], s[68:69]
    v_pk_mul_f32 v[72:73], v[72:73], s[68:69]
    v_pk_mul_f32 v[74:75], v[74:75], s[68:69]
    v_pk_mul_f32 v[76:77], v[76:77], s[68:69]
    v_pk_mul_f32 v[78:79], v[78:79], s[68:69]
    v_mul_f32 v80, 0xbfb8aa3b, v64
    v_mul_f32 v81, 0xbfb8aa3b, v65
    v_mul_f32 v82, 0xbfb8aa3b, v66
    v_mul_f32 v83, 0xbfb8aa3b, v67
    v_mul_f32 v84, 0xbfb8aa3b, v68
    v_mul_f32 v85, 0xbfb8aa3b, v69
    v_mul_f32 v86, 0xbfb8aa3b, v70
    v_mul_f32 v87, 0xbfb8aa3b, v71
    v_mul_f32 v88, 0xbfb8aa3b, v72
    v_mul_f32 v89, 0xbfb8aa3b, v73
    v_mul_f32 v90, 0xbfb8aa3b, v74
    v_mul_f32 v91, 0xbfb8aa3b, v75
    v_mul_f32 v92, 0xbfb8aa3b, v76
    v_mul_f32 v93, 0xbfb8aa3b, v77
    v_mul_f32 v94, 0xbfb8aa3b, v78
    v_mul_f32 v95, 0xbfb8aa3b, v79
    v_exp_f32 v80, v80
    v_exp_f32 v81, v81
    v_exp_f32 v82, v82
    v_exp_f32 v83, v83
    v_exp_f32 v84, v84
    v_exp_f32 v85, v85
    v_exp_f32 v86, v86
    v_exp_f32 v87, v87
    v_exp_f32 v88, v88
    v_exp_f32 v89, v89
    v_exp_f32 v90, v90
    v_exp_f32 v91, v91
    v_exp_f32 v92, v92
    v_exp_f32 v93, v93
    v_exp_f32 v94, v94
    v_exp_f32 v95, v95
    v_add_f32 v80, 1.0, v80
    v_add_f32 v81, 1.0, v81
    v_add_f32 v82, 1.0, v82
    v_add_f32 v83, 1.0, v83
    v_add_f32 v84, 1.0, v84
    v_add_f32 v85, 1.0, v85
    v_add_f32 v86, 1.0, v86
    v_add_f32 v87, 1.0, v87
    v_add_f32 v88, 1.0, v88
    v_add_f32 v89, 1.0, v89
    v_add_f32 v90, 1.0, v90
    v_add_f32 v91, 1.0, v91
    v_add_f32 v92, 1.0, v92
    v_add_f32 v93, 1.0, v93
    v_add_f32 v94, 1.0, v94
    v_add_f32 v95, 1.0, v95
    v_rcp_f32 v80, v80
    v_rcp_f32 v81, v81
    v_rcp_f32 v82, v82
    v_rcp_f32 v83, v83
    v_rcp_f32 v84, v84
    v_rcp_f32 v85, v85
    v_rcp_f32 v86, v86
    v_rcp_f32 v87, v87
    v_rcp_f32 v88, v88
    v_rcp_f32 v89, v89
    v_rcp_f32 v90, v90
    v_rcp_f32 v91, v91
    v_rcp_f32 v92, v92
    v_rcp_f32 v93, v93
    v_rcp_f32 v94, v94
    v_rcp_f32 v95, v95
    s_nop 0
    v_pk_mul_f32 v[80:81], v[80:81], v[64:65]
    v_pk_mul_f32 v[82:83], v[82:83], v[66:67]
    v_pk_mul_f32 v[84:85], v[84:85], v[68:69]
    v_pk_mul_f32 v[86:87], v[86:87], v[70:71]
    v_pk_mul_f32 v[88:89], v[88:89], v[72:73]
    v_pk_mul_f32 v[90:91], v[90:91], v[74:75]
    v_pk_mul_f32 v[92:93], v[92:93], v[76:77]
    v_pk_mul_f32 v[94:95], v[94:95], v[78:79]
    v_lshlrev_b32 v104, 16, v192
    v_and_b32 v105, s67, v192
    v_lshlrev_b32 v106, 16, v193
    v_and_b32 v107, s67, v193
    v_lshlrev_b32 v108, 16, v194
    v_and_b32 v109, s67, v194
    v_lshlrev_b32 v110, 16, v195
    v_and_b32 v111, s67, v195
    v_lshlrev_b32 v112, 16, v196
    v_and_b32 v113, s67, v196
    v_lshlrev_b32 v114, 16, v197
    v_and_b32 v115, s67, v197
    v_lshlrev_b32 v116, 16, v198
    v_and_b32 v117, s67, v198
    v_lshlrev_b32 v118, 16, v199
    v_and_b32 v119, s67, v199
    s_mov_b32 s59, 131072
    s_waitcnt vmcnt(0)
L_COLLECT:
    buffer_load_dword v202, v201, s[48:51], s66 offen sc1
    s_cmp_eq_u32 s70, 0
    s_cbranch_scc1 M_ADDED
    v_lshlrev_b32 v96, 16, v16
    v_and_b32 v97, s67, v16
    v_pk_add_f32 v[0:1], v[0:1], v[96:97]
    v_lshlrev_b32 v98, 16, v17
    v_and_b32 v99, s67, v17
    v_pk_add_f32 v[2:3], v[2:3], v[98:99]
    v_lshlrev_b32 v100, 16, v18
    v_and_b32 v101, s67, v18
    v_pk_add_f32 v[4:5], v[4:5], v[100:101]
    v_lshlrev_b32 v102, 16, v19
    v_and_b32 v103, s67, v19
    v_pk_add_f32 v[6:7], v[6:7], v[102:103]
    v_lshlrev_b32 v96, 16, v20
    v_and_b32 v97, s67, v20
    v_pk_add_f32 v[8:9], v[8:9], v[96:97]
    v_lshlrev_b32 v98, 16, v21
    v_and_b32 v99, s67, v21
    v_pk_add_f32 v[10:11], v[10:11], v[98:99]
    v_lshlrev_b32 v100, 16, v22
    v_and_b32 v101, s67, v22
    v_pk_add_f32 v[12:13], v[12:13], v[100:101]
    v_lshlrev_b32 v102, 16, v23
    v_and_b32 v103, s67, v23
    v_pk_add_f32 v[14:15], v[14:15], v[102:103]
    s_cmp_eq_u32 s70, 1
    s_cbranch_scc1 M_ADDED
    v_lshlrev_b32 v96, 16, v24
    v_and_b32 v97, s67, v24
    v_pk_add_f32 v[0:1], v[0:1], v[96:97]
    v_lshlrev_b32 v98, 16, v25
    v_and_b32 v99, s67, v25
    v_pk_add_f32 v[2:3], v[2:3], v[98:99]
    v_lshlrev_b32 v100, 16, v26
    v_and_b32 v101, s67, v26
    v_pk_add_f32 v[4:5], v[4:5], v[100:101]
    v_lshlrev_b32 v102, 16, v27
    v_and_b32 v103, s67, v27
    v_pk_add_f32 v[6:7], v[6:7], v[102:103]
    v_lshlrev_b32 v96, 16, v28
    v_and_b32 v97, s67, v28
    v_pk_add_f32 v[8:9], v[8:9], v[96:97]
    v_lshlrev_b32 v98, 16, v29
    v_and_b32 v99, s67, v29
    v_pk_add_f32 v[10:11], v[10:11], v[98:99]
    v_lshlrev_b32 v100, 16, v30
    v_and_b32 v101, s67, v30
    v_pk_add_f32 v[12:13], v[12:13], v[100:101]
    v_lshlrev_b32 v102, 16, v31
    v_and_b32 v103, s67, v31
    v_pk_add_f32 v[14:15], v[14:15], v[102:103]
    s_cmp_eq_u32 s70, 2
    s_cbranch_scc1 M_ADDED
    v_lshlrev_b32 v96, 16, v32
    v_and_b32 v97, s67, v32
    v_pk_add_f32 v[0:1], v[0:1], v[96:97]
    v_lshlrev_b32 v98, 16, v33
    v_and_b32 v99, s67, v33
    v_pk_add_f32 v[2:3], v[2:3], v[98:99]
    v_lshlrev_b32 v100, 16, v34
    v_and_b32 v101, s67, v34
    v_pk_add_f32 v[4:5], v[4:5], v[100:101]
    v_lshlrev_b32 v102, 16, v35
    v_and_b32 v103, s67, v35
    v_pk_add_f32 v[6:7], v[6:7], v[102:103]
    v_lshlrev_b32 v96, 16, v36
    v_and_b32 v97, s67, v36
    v_pk_add_f32 v[8:9], v[8:9], v[96:97]
    v_lshlrev_b32 v98, 16, v37
    v_and_b32 v99, s67, v37
    v_pk_add_f32 v[10:11], v[10:11], v[98:99]
    v_lshlrev_b32 v100, 16, v38
    v_and_b32 v101, s67, v38
    v_pk_add_f32 v[12:13], v[12:13], v[100:101]
    v_lshlrev_b32 v102, 16, v39
    v_and_b32 v103, s67, v39
    v_pk_add_f32 v[14:15], v[14:15], v[102:103]
    s_cmp_eq_u32 s70, 3
    s_cbranch_scc1 M_ADDED
    v_lshlrev_b32 v96, 16, v40
    v_and_b32 v97, s67, v40
    v_pk_add_f32 v[0:1], v[0:1], v[96:97]
    v_lshlrev_b32 v98, 16, v41
    v_and_b32 v99, s67, v41
    v_pk_add_f32 v[2:3], v[2:3], v[98:99]
    v_lshlrev_b32 v100, 16, v42
    v_and_b32 v101, s67, v42
    v_pk_add_f32 v[4:5], v[4:5], v[100:101]
    v_lshlrev_b32 v102, 16, v43
    v_and_b32 v103, s67, v43
    v_pk_add_f32 v[6:7], v[6:7], v[102:103]
    v_lshlrev_b32 v96, 16, v44
    v_and_b32 v97, s67, v44
    v_pk_add_f32 v[8:9], v[8:9], v[96:97]
    v_lshlrev_b32 v98, 16, v45
    v_and_b32 v99, s67, v45
    v_pk_add_f32 v[10:11], v[10:11], v[98:99]
    v_lshlrev_b32 v100, 16, v46
    v_and_b32 v101, s67, v46
    v_pk_add_f32 v[12:13], v[12:13], v[100:101]
    v_lshlrev_b32 v102, 16, v47
    v_and_b32 v103, s67, v47
    v_pk_add_f32 v[14:15], v[14:15], v[102:103]
    s_cmp_eq_u32 s70, 4
    s_cbranch_scc1 M_ADDED
    v_lshlrev_b32 v96, 16, v48
    v_and_b32 v97, s67, v48
    v_pk_add_f32 v[0:1], v[0:1], v[96:97]
    v_lshlrev_b32 v98, 16, v49
    v_and_b32 v99, s67, v49
    v_pk_add_f32 v[2:3], v[2:3], v[98:99]
    v_lshlrev_b32 v100, 16, v50
    v_and_b32 v101, s67, v50
    v_pk_add_f32 v[4:5], v[4:5], v[100:101]
    v_lshlrev_b32 v102, 16, v51
    v_and_b32 v103, s67, v51
    v_pk_add_f32 v[6:7], v[6:7], v[102:103]
    v_lshlrev_b32 v96, 16, v52
    v_and_b32 v97, s67, v52
    v_pk_add_f32 v[8:9], v[8:9], v[96:97]
    v_lshlrev_b32 v98, 16, v53
    v_and_b32 v99, s67, v53
    v_pk_add_f32 v[10:11], v[10:11], v[98:99]
    v_lshlrev_b32 v100, 16, v54
    v_and_b32 v101, s67, v54
    v_pk_add_f32 v[12:13], v[12:13], v[100:101]
    v_lshlrev_b32 v102, 16, v55
    v_and_b32 v103, s67, v55
    v_pk_add_f32 v[14:15], v[14:15], v[102:103]
    s_cmp_eq_u32 s70, 5
    s_cbranch_scc1 M_ADDED
    v_lshlrev_b32 v96, 16, v56
    v_and_b32 v97, s67, v56
    v_pk_add_f32 v[0:1], v[0:1], v[96:97]
    v_lshlrev_b32 v98, 16, v57
    v_and_b32 v99, s67, v57
    v_pk_add_f32 v[2:3], v[2:3], v[98:99]
    v_lshlrev_b32 v100, 16, v58
    v_and_b32 v101, s67, v58
    v_pk_add_f32 v[4:5], v[4:5], v[100:101]
    v_lshlrev_b32 v102, 16, v59
    v_and_b32 v103, s67, v59
    v_pk_add_f32 v[6:7], v[6:7], v[102:103]
    v_lshlrev_b32 v96, 16, v60
    v_and_b32 v97, s67, v60
    v_pk_add_f32 v[8:9], v[8:9], v[96:97]
    v_lshlrev_b32 v98, 16, v61
    v_and_b32 v99, s67, v61
    v_pk_add_f32 v[10:11], v[10:11], v[98:99]
    v_lshlrev_b32 v100, 16, v62
    v_and_b32 v101, s67, v62
    v_pk_add_f32 v[12:13], v[12:13], v[100:101]
    v_lshlrev_b32 v102, 16, v63
    v_and_b32 v103, s67, v63
    v_pk_add_f32 v[14:15], v[14:15], v[102:103]
    s_cmp_eq_u32 s70, 6
    s_cbranch_scc1 M_ADDED
    v_lshlrev_b32 v96, 16, v208
    v_and_b32 v97, s67, v208
    v_pk_add_f32 v[0:1], v[0:1], v[96:97]
    v_lshlrev_b32 v98, 16, v209
    v_and_b32 v99, s67, v209
    v_pk_add_f32 v[2:3], v[2:3], v[98:99]
    v_lshlrev_b32 v100, 16, v210
    v_and_b32 v101, s67, v210
    v_pk_add_f32 v[4:5], v[4:5], v[100:101]
    v_lshlrev_b32 v102, 16, v211
    v_and_b32 v103, s67, v211
    v_pk_add_f32 v[6:7], v[6:7], v[102:103]
    v_lshlrev_b32 v96, 16, v212
    v_and_b32 v97, s67, v212
    v_pk_add_f32 v[8:9], v[8:9], v[96:97]
    v_lshlrev_b32 v98, 16, v213
    v_and_b32 v99, s67, v213
    v_pk_add_f32 v[10:11], v[10:11], v[98:99]
    v_lshlrev_b32 v100, 16, v214
    v_and_b32 v101, s67, v214
    v_pk_add_f32 v[12:13], v[12:13], v[100:101]
    v_lshlrev_b32 v102, 16, v215
    v_and_b32 v103, s67, v215
    v_pk_add_f32 v[14:15], v[14:15], v[102:103]
    s_cmp_eq_u32 s70, 7
    s_cbranch_scc1 M_ADDED
    v_lshlrev_b32 v96, 16, v216
    v_and_b32 v97, s67, v216
    v_pk_add_f32 v[0:1], v[0:1], v[96:97]
    v_lshlrev_b32 v98, 16, v217
    v_and_b32 v99, s67, v217
    v_pk_add_f32 v[2:3], v[2:3], v[98:99]
    v_lshlrev_b32 v100, 16, v218
    v_and_b32 v101, s67, v218
    v_pk_add_f32 v[4:5], v[4:5], v[100:101]
    v_lshlrev_b32 v102, 16, v219
    v_and_b32 v103, s67, v219
    v_pk_add_f32 v[6:7], v[6:7], v[102:103]
    v_lshlrev_b32 v96, 16, v220
    v_and_b32 v97, s67, v220
    v_pk_add_f32 v[8:9], v[8:9], v[96:97]
    v_lshlrev_b32 v98, 16, v221
    v_and_b32 v99, s67, v221
    v_pk_add_f32 v[10:11], v[10:11], v[98:99]
    v_lshlrev_b32 v100, 16, v222
    v_and_b32 v101, s67, v222
    v_pk_add_f32 v[12:13], v[12:13], v[100:101]
    v_lshlrev_b32 v102, 16, v223
    v_and_b32 v103, s67, v223
    v_pk_add_f32 v[14:15], v[14:15], v[102:103]
M_ADDED:
    s_cmp_eq_u32 s73, 0x11111111
    s_cbranch_scc1 M_HAVE
    s_waitcnt vmcnt(0)
    v_cmp_eq_u32 vcc, 1, v202
    s_sub_u32 s59, s59, 1
    s_cbranch_scc1 M_HAVE
    s_lshr_b32 s64, vcc_lo, 1
    s_and_b32 s74, vcc_lo, s64
    s_lshr_b32 s64, s74, 2
    s_and_b32 s74, s74, s64
    s_and_b32 s74, s74, 0x11111111
    s_andn2_b32 s74, s74, s73
    s_or_b32 s73, s73, s74
    s_bcnt1_i32_b32 s70, s74
    s_cmp_eq_u32 s70, 0
    s_cbranch_scc1 M_ASKED
    s_ff1_i32_b32 s64, s74
    s_bitset0_b32 s74, s64
    s_lshl_b32 s64, s64, 11
    s_add_u32 s64, s64, s72
    buffer_load_dwordx4 v[16:19], v245, s[48:51], s64 offen offset:0 sc1
    buffer_load_dwordx4 v[20:23], v245, s[48:51], s64 offen offset:1024 sc1
    s_cmp_eq_u32 s70, 1
    s_cbranch_scc1 M_ASKED
    s_ff1_i32_b32 s64, s74
    s_bitset0_b32 s74, s64
    s_lshl_b32 s64, s64, 11
    s_add_u32 s64, s64, s72
    buffer_load_dwordx4 v[24:27], v245, s[48:51], s64 offen offset:0 sc1
    buffer_load_dwordx4 v[28:31], v245, s[48:51], s64 offen offset:1024 sc1
    s_cmp_eq_u32 s70, 2
    s_cbranch_scc1 M_ASKED
    s_ff1_i32_b32 s64, s74
    s_bitset0_b32 s74, s64
    s_lshl_b32 s64, s64, 11
    s_add_u32 s64, s64, s72
    buffer_load_dwordx4 v[32:35], v245, s[48:51], s64 offen offset:0 sc1
    buffer_load_dwordx4 v[36:39], v245, s[48:51], s64 offen offset:1024 sc1
    s_cmp_eq_u32 s70, 3
    s_cbranch_scc1 M_ASKED
    s_ff1_i32_b32 s64, s74
    s_bitset0_b32 s74, s64
    s_lshl_b32 s64, s64, 11
    s_add_u32 s64, s64, s72
    buffer_load_dwordx4 v[40:43], v245, s[48:51], s64 offen offset:0 sc1
    buffer_load_dwordx4 v[44:47], v245, s[48:51], s64 offen offset:1024 sc1
    s_cmp_eq_u32 s70, 4
    s_cbranch_scc1 M_ASKED
    s_ff1_i32_b32 s64, s74
    s_bitset0_b32 s74, s64
    s_lshl_b32 s64, s64, 11
    s_add_u32 s64, s64, s72
    buffer_load_dwordx4 v[48:51], v245, s[48:51], s64 offen offset:0 sc1
    buffer_load_dwordx4 v[52:55], v245, s[48:51], s64 offen offset:1024 sc1
    s_cmp_eq_u32 s70, 5
    s_cbranch_scc1 M_ASKED
    s_ff1_i32_b32 s64, s74
    s_bitset0_b32 s74, s64
    s_lshl_b32 s64, s64, 11
    s_add_u32 s64, s64, s72
    buffer_load_dwordx4 v[56:59], v245, s[48:51], s64 offen offset:0 sc1
    buffer_load_dwordx4 v[60:63], v245, s[48:51], s64 offen offset:1024 sc1
    s_cmp_eq_u32 s70, 6
    s_cbranch_scc1 M_ASKED
    s_ff1_i32_b32 s64, s74
    s_bitset0_b32 s74, s64
    s_lshl_b32 s64, s64, 11
    s_add_u32 s64, s64, s72
    buffer_load_dwordx4 v[208:211], v245, s[48:51], s64 offen offset:0 sc1
    buffer_load_dwordx4 v[212:215], v245, s[48:51], s64 offen offset:1024 sc1
    s_cmp_eq_u32 s70, 7
    s_cbranch_scc1 M_ASKED
    s_ff1_i32_b32 s64, s74
    s_bitset0_b32 s74, s64
    s_lshl_b32 s64, s64, 11
    s_add_u32 s64, s64, s72
    buffer_load_dwordx4 v[216:219], v245, s[48:51], s64 offen offset:0 sc1
    buffer_load_dwordx4 v[220:223], v245, s[48:51], s64 offen offset:1024 sc1
M_ASKED:
    s_waitcnt vmcnt(0)
    s_branch L_COLLECT
M_HAVE:
    v_pk_mul_f32 v[80:81], v[80:81], v[0:1]
    v_pk_mul_f32 v[82:83], v[82:83], v[2:3]
    ds_write_b128 v206, v[80:83] offset:0
    v_pk_mul_f32 v[84:85], v[84:85], v[4:5]
    v_pk_mul_f32 v[86:87], v[86:87], v[6:7]
    ds_write_b128 v206, v[84:87] offset:64
    v_pk_mul_f32 v[88:89], v[88:89], v[8:9]
    v_pk_mul_f32 v[90:91], v[90:91], v[10:11]
    ds_write_b128 v206, v[88:91] offset:128
    v_pk_mul_f32 v[92:93], v[92:93], v[12:13]
    v_pk_mul_f32 v[94:95], v[94:95], v[14:15]
    ds_write_b128 v206, v[92:95] offset:192
    ds_read_b128 v[0:3], v224 offset:0
    ds_read_b128 v[4:7], v224 offset:16
    ds_read_b128 v[8:11], v224 offset:2176
    ds_read_b128 v[12:15], v224 offset:2192
    s_waitcnt lgkmcnt(2)
    v_pk_add_f32 v[0:1], v[0:1], v[104:105]
    v_pk_add_f32 v[2:3], v[2:3], v[106:107]
    v_pk_add_f32 v[4:5], v[4:5], v[108:109]
    v_pk_add_f32 v[6:7], v[6:7], v[110:111]
    v_cvt_pk_bf16_f32 v64, v0, v1
    v_cvt_pk_bf16_f32 v65, v2, v3
    v_cvt_pk_bf16_f32 v66, v4, v5
    v_cvt_pk_bf16_f32 v67, v6, v7
    buffer_store_dwordx4 v[64:67], v200, s[36:39], s65 offen
    s_waitcnt lgkmcnt(0)
    v_pk_add_f32 v[8:9], v[8:9], v[112:113]
    v_pk_add_f32 v[10:11], v[10:11], v[114:115]
    v_pk_add_f32 v[12:13], v[12:13], v[116:117]
    v_pk_add_f32 v[14:15], v[14:15], v[118:119]
    v_cvt_pk_bf16_f32 v68, v8, v9
    v_cvt_pk_bf16_f32 v69, v10, v11
    v_cvt_pk_bf16_f32 v70, v12, v13
    v_cvt_pk_bf16_f32 v71, v14, v15
    buffer_store_dwordx4 v[68:71], v200, s[36:39], s75 offen
M_END:
    s_endpgm
M_SLOW:
    s_waitcnt vmcnt(0) lgkmcnt(0)
    s_lshl_b32 s64, s53, 19
    s_add_u32 s40, s6, s64
    s_addc_u32 s41, s7, 0
    s_mov_b32 s42, 524288
    s_mov_b32 s43, 0x20000
    s_add_u32 s44, s8, s64
    s_addc_u32 s45, s9, 0
    s_mov_b32 s46, 524288
    s_mov_b32 s47, 0x20000
    s_lshl_b32 s65, s52, 14
    v_and_b32 v247, 15, v246
    v_lshrrev_b32 v248, 4, v246
    v_xor_b32 v249, v248, v247
    v_lshlrev_b32 v250, 8, v248
    v_lshl_add_u32 v234, v249, 4, v250
    v_xor_b32 v235, 64, v234
    v_xor_b32 v236, 128, v234
    v_xor_b32 v237, 192, v234
    v_lshl_add_u32 v250, v247, 8, s65
    v_xor_b32 v212, 0, v249
    v_lshl_add_u32 v212, v212, 4, v250
    v_xor_b32 v213, 4, v249
    v_lshl_add_u32 v213, v213, 4, v250
    v_xor_b32 v214, 8, v249
    v_lshl_add_u32 v214, v214, 4, v250
    v_xor_b32 v215, 12, v249
    v_lshl_add_u32 v215, v215, 4, v250
    v_lshlrev_b32 v249, 1, v248
    v_xor_b32 v249, v249, v247
    v_lshlrev_b32 v250, 8, v248
    v_lshl_add_u32 v238, v249, 4, v250
    v_xor_b32 v239, 128, v238
    v_lshrrev_b32 v249, 2, v247
    v_lshl_add_u32 v249, v248, 2, v249
    v_and_b32 v247, 3, v247
    v_lshl_add_u32 v247, v247, 3, s65
    v_lshl_add_u32 v247, v249, 8, v247
    v_and_b32 v249, 7, v249
    v_xor_b32 v216, 0, v249
    v_lshl_add_u32 v216, v216, 5, v247
    v_xor_b32 v217, 1, v249
    v_lshl_add_u32 v217, v217, 5, v247
    v_xor_b32 v218, 2, v249
    v_lshl_add_u32 v218, v218, 5, v247
    v_xor_b32 v219, 3, v249
    v_lshl_add_u32 v219, v219, 5, v247
    v_xor_b32 v220, 4, v249
    v_lshl_add_u32 v220, v220, 5, v247
    v_xor_b32 v221, 5, v249
    v_lshl_add_u32 v221, v221, 5, v247
    v_xor_b32 v222, 6, v249
    v_lshl_add_u32 v222, v222, 5, v247
    v_xor_b32 v223, 7, v249
    v_lshl_add_u32 v223, v223, 5, v247
    v_mov_b32 v0, 0
    v_mov_b32 v1, 0
    v_mov_b32 v2, 0
    v_mov_b32 v3, 0
    v_mov_b32 v4, 0
    v_mov_b32 v5, 0
    v_mov_b32 v6, 0
    v_mov_b32 v7, 0
    v_mov_b32 v8, 0
    v_mov_b32 v9, 0
    v_mov_b32 v10, 0
    v_mov_b32 v11, 0
    v_mov_b32 v12, 0
    v_mov_b32 v13, 0
    v_mov_b32 v14, 0
    v_mov_b32 v15, 0
    v_mov_b32 v16, 0
    v_mov_b32 v17, 0
    v_mov_b32 v18, 0
    v_mov_b32 v19, 0
    v_mov_b32 v20, 0
    v_mov_b32 v21, 0
    v_mov_b32 v22, 0
    v_mov_b32 v23, 0
    v_mov_b32 v24, 0
    v_mov_b32 v25, 0
    v_mov_b32 v26, 0
    v_mov_b32 v27, 0
    v_mov_b32 v28, 0
    v_mov_b32 v29, 0
    v_mov_b32 v30, 0
    v_mov_b32 v31, 0
    v_mov_b32 v32, 0
    v_mov_b32 v33, 0
    v_mov_b32 v34, 0
    v_mov_b32 v35, 0
    v_mov_b32 v36, 0
    v_mov_b32 v37, 0
    v_mov_b32 v38, 0
    v_mov_b32 v39, 0
    v_mov_b32 v40, 0
    v_mov_b32 v41, 0
    v_mov_b32 v42, 0
    v_mov_b32 v43, 0
    v_mov_b32 v44, 0
    v_mov_b32 v45, 0
    v_mov_b32 v46, 0
    v_mov_b32 v47, 0
    v_mov_b32 v48, 0
    v_mov_b32 v49, 0
    v_mov_b32 v50, 0
    v_mov_b32 v51, 0
    v_mov_b32 v52, 0
    v_mov_b32 v53, 0
    v_mov_b32 v54, 0
    v_mov_b32 v55, 0
    v_mov_b32 v56, 0
    v_mov_b32 v57, 0
    v_mov_b32 v58, 0
    v_mov_b32 v59, 0
    v_mov_b32 v60, 0
    v_mov_b32 v61, 0
    v_mov_b32 v62, 0
    v_mov_b32 v63, 0
    v_mov_b32 v64, 0
    v_mov_b32 v65, 0
    v_mov_b32 v66, 0
    v_mov_b32 v67, 0
    v_mov_b32 v68, 0
    v_mov_b32 v69, 0
    v_mov_b32 v70, 0
    v_mov_b32 v71, 0
    v_mov_b32 v72, 0
    v_mov_b32 v73, 0
    v_mov_b32 v74, 0
    v_mov_b32 v75, 0
    v_mov_b32 v76, 0
    v_mov_b32 v77, 0
    v_mov_b32 v78, 0
    v_mov_b32 v79, 0
    v_mov_b32 v80, 0
    v_mov_b32 v81, 0
    v_mov_b32 v82, 0
    v_mov_b32 v83, 0
    v_mov_b32 v84, 0
    v_mov_b32 v85, 0
    v_mov_b32 v86, 0
    v_mov_b32 v87, 0
    v_mov_b32 v88, 0
    v_mov_b32 v89, 0
    v_mov_b32 v90, 0
    v_mov_b32 v91, 0
    v_mov_b32 v92, 0
    v_mov_b32 v93, 0
    v_mov_b32 v94, 0
    v_mov_b32 v95, 0
    v_mov_b32 v96, 0
    v_mov_b32 v97, 0
    v_mov_b32 v98, 0
    v_mov_b32 v99, 0
    v_mov_b32 v100, 0
    v_mov_b32 v101, 0
    v_mov_b32 v102, 0
    v_mov_b32 v103, 0
    v_mov_b32 v104, 0
    v_mov_b32 v105, 0
    v_mov_b32 v106, 0
    v_mov_b32 v107, 0
    v_mov_b32 v108, 0
    v_mov_b32 v109, 0
    v_mov_b32 v110, 0
    v_mov_b32 v111, 0
    v_mov_b32 v112, 0
    v_mov_b32 v113, 0
    v_mov_b32 v114, 0
    v_mov_b32 v115, 0
    v_mov_b32 v116, 0
    v_mov_b32 v117, 0
    v_mov_b32 v118, 0
    v_mov_b32 v119, 0
    v_mov_b32 v120, 0
    v_mov_b32 v121, 0
    v_mov_b32 v122, 0
    v_mov_b32 v123, 0
    v_mov_b32 v124, 0
    v_mov_b32 v125, 0
    v_mov_b32 v126, 0
    v_mov_b32 v127, 0
    v_mov_b32 v192, 0
    v_mov_b32 v193, 0
    v_mov_b32 v194, 0
    v_mov_b32 v195, 0
    v_mov_b32 v196, 0
    v_mov_b32 v197, 0
    v_mov_b32 v198, 0
    v_mov_b32 v199, 0
    v_mov_b32 v160, 0xff800000
    v_mov_b32 v161, 0xff800000
    v_mov_b32 v162, 0xff800000
    v_mov_b32 v163, 0xff800000
    s_mov_b32 s60, 0
L_SLOW:
    s_add_u32 m0, s65, 0
    s_nop 0
    buffer_load_dwordx4 v234, s[40:43], s60 offen offset:0 lds
    buffer_load_dwordx4 v235, s[40:43], s60 offen offset:1024 lds
    buffer_load_dwordx4 v236, s[40:43], s60 offen offset:2048 lds
    buffer_load_dwordx4 v237, s[40:43], s60 offen offset:3072 lds
    s_add_u32 m0, s65, 8192
    s_nop 0
    buffer_load_dwordx4 v238, s[44:47], s60 offen offset:0 lds
    buffer_load_dwordx4 v239, s[44:47], s60 offen offset:1024 lds
    buffer_load_dwordx4 v238, s[44:47], s60 offen offset:2048 lds
    buffer_load_dwordx4 v239, s[44:47], s60 offen offset:3072 lds
    s_add_u32 s60, s60, 4096
    s_add_u32 m0, s65, 4096
    s_nop 0
    buffer_load_dwordx4 v234, s[40:43], s60 offen offset:0 lds
    buffer_load_dwordx4 v235, s[40:43], s60 offen offset:1024 lds
    buffer_load_dwordx4 v236, s[40:43], s60 offen offset:2048 lds
    buffer_load_dwordx4 v237, s[40:43], s60 offen offset:3072 lds
    s_add_u32 m0, s65, 12288
    s_nop 0
    buffer_load_dwordx4 v238, s[44:47], s60 offen offset:0 lds
    buffer_load_dwordx4 v239, s[44:47], s60 offen offset:1024 lds
    buffer_load_dwordx4 v238, s[44:47], s60 offen offset:2048 lds
    buffer_load_dwordx4 v239, s[44:47], s60 offen offset:3072 lds
    s_add_u32 s60, s60, 4096
    s_waitcnt vmcnt(0)
    ds_read_b128 a[64:67], v212 offset:0
    ds_read_b128 a[68:71], v213 offset:0
    ds_read_b128 a[72:75], v214 offset:0
    ds_read_b128 a[76:79], v215 offset:0
    ds_read_b128 a[80:83], v212 offset:4096
    ds_read_b128 a[84:87], v213 offset:4096
    ds_read_b128 a[88:91], v214 offset:4096
    ds_read_b128 a[92:95], v215 offset:4096
    s_waitcnt lgkmcnt(0)
    ds_read_b64_tr_b16 a[96:97], v216 offset:8192
    ds_read_b64_tr_b16 a[98:99], v216 offset:12288
    ds_read_b64_tr_b16 a[100:101], v217 offset:8192
    ds_read_b64_tr_b16 a[102:103], v217 offset:12288
    ds_read_b64_tr_b16 a[104:105], v218 offset:8192
    ds_read_b64_tr_b16 a[106:107], v218 offset:12288
    ds_read_b64_tr_b16 a[108:109], v219 offset:8192
    ds_read_b64_tr_b16 a[110:111], v219 offset:12288
    s_waitcnt lgkmcnt(0)
    ds_read_b64_tr_b16 a[112:113], v220 offset:8192
    ds_read_b64_tr_b16 a[114:115], v220 offset:12288
    ds_read_b64_tr_b16 a[116:117], v221 offset:8192
    ds_read_b64_tr_b16 a[118:119], v221 offset:12288
    ds_read_b64_tr_b16 a[120:121], v222 offset:8192
    ds_read_b64_tr_b16 a[122:123], v222 offset:12288
    ds_read_b64_tr_b16 a[124:125], v223 offset:8192
    ds_read_b64_tr_b16 a[126:127], v223 offset:12288
    v_mfma_f32_16x16x32_bf16 v[128:131], a[64:67], a[0:3], 0
    v_mfma_f32_16x16x32_bf16 v[128:131], a[68:71], a[4:7], v[128:131]
    v_mfma_f32_16x16x32_bf16 v[128:131], a[72:75], a[8:11], v[128:131]
    v_mfma_f32_16x16x32_bf16 v[128:131], a[76:79], a[12:15], v[128:131]
    v_mfma_f32_16x16x32_bf16 v[132:135], a[80:83], a[0:3], 0
    v_mfma_f32_16x16x32_bf16 v[132:135], a[84:87], a[4:7], v[132:135]
    v_mfma_f32_16x16x32_bf16 v[132:135], a[88:91], a[8:11], v[132:135]
    v_mfma_f32_16x16x32_bf16 v[132:135], a[92:95], a[12:15], v[132:135]
    v_mfma_f32_16x16x32_bf16 v[136:139], a[64:67], a[16:19], 0
    v_mfma_f32_16x16x32_bf16 v[136:139], a[68:71], a[20:23], v[136:139]
    v_mfma_f32_16x16x32_bf16 v[136:139], a[72:75], a[24:27], v[136:139]
    v_mfma_f32_16x16x32_bf16 v[136:139], a[76:79], a[28:31], v[136:139]
    v_mfma_f32_16x16x32_bf16 v[140:143], a[80:83], a[16:19], 0
    v_mfma_f32_16x16x32_bf16 v[140:143], a[84:87], a[20:23], v[140:143]
    v_mfma_f32_16x16x32_bf16 v[140:143], a[88:91], a[24:27], v[140:143]
    v_mfma_f32_16x16x32_bf16 v[140:143], a[92:95], a[28:31], v[140:143]
    v_mfma_f32_16x16x32_bf16 v[144:147], a[64:67], a[32:35], 0
    v_mfma_f32_16x16x32_bf16 v[144:147], a[68:71], a[36:39], v[144:147]
    v_mfma_f32_16x16x32_bf16 v[144:147], a[72:75], a[40:43], v[144:147]
    v_mfma_f32_16x16x32_bf16 v[144:147], a[76:79], a[44:47], v[144:147]
    v_mfma_f32_16x16x32_bf16 v[148:151], a[80:83], a[32:35], 0
    v_mfma_f32_16x16x32_bf16 v[148:151], a[84:87], a[36:39], v[148:151]
    v_mfma_f32_16x16x32_bf16 v[148:151], a[88:91], a[40:43], v[148:151]
    v_mfma_f32_16x16x32_bf16 v[148:151], a[92:95], a[44:47], v[148:151]
    v_mfma_f32_16x16x32_bf16 v[152:155], a[64:67], a[48:51], 0
    v_mfma_f32_16x16x32_bf16 v[152:155], a[68:71], a[52:55], v[152:155]
    v_mfma_f32_16x16x32_bf16 v[152:155], a[72:75], a[56:59], v[152:155]
    v_mfma_f32_16x16x32_bf16 v[152:155], a[76:79], a[60:63], v[152:155]
    v_mfma_f32_16x16x32_bf16 v[156:159], a[80:83], a[48:51], 0
    v_mfma_f32_16x16x32_bf16 v[156:159], a[84:87], a[52:55], v[156:159]
    v_mfma_f32_16x16x32_bf16 v[156:159], a[88:91], a[56:59], v[156:159]
    v_mfma_f32_16x16x32_bf16 v[156:159], a[92:95], a[60:63], v[156:159]
    s_nop 15
    v_max3_f32 v164, v128, v129, v130
    v_max3_f32 v165, v136, v137, v138
    v_max3_f32 v166, v144, v145, v146
    v_max3_f32 v167, v152, v153, v154
    v_max3_f32 v164, v164, v131, v132
    v_max3_f32 v165, v165, v139, v140
    v_max3_f32 v166, v166, v147, v148
    v_max3_f32 v167, v167, v155, v156
    v_max3_f32 v164, v164, v133, v134
    v_max3_f32 v165, v165, v141, v142
    v_max3_f32 v166, v166, v149, v150
    v_max3_f32 v167, v167, v157, v158
    v_max_f32 v164, v164, v135
    v_max_f32 v165, v165, v143
    v_max_f32 v166, v166, v151
    v_max_f32 v167, v167, v159
    v_mov_b32 v176, v164
    v_mov_b32 v177, v165
    v_mov_b32 v178, v166
    v_mov_b32 v179, v167
    v_permlane16_swap_b32 v176, v164
    v_permlane16_swap_b32 v177, v165
    v_permlane16_swap_b32 v178, v166
    v_permlane16_swap_b32 v179, v167
    v_max_f32 v164, v164, v176
    v_max_f32 v165, v165, v177
    v_max_f32 v166, v166, v178
    v_max_f32 v167, v167, v179
    v_mov_b32 v176, v164
    v_mov_b32 v177, v165
    v_mov_b32 v178, v166
    v_mov_b32 v179, v167
    v_permlane32_swap_b32 v176, v164
    v_permlane32_swap_b32 v177, v165
    v_permlane32_swap_b32 v178, v166
    v_permlane32_swap_b32 v179, v167
    v_max_f32 v164, v164, v176
    v_max_f32 v165, v165, v177
    v_max_f32 v166, v166, v178
    v_max_f32 v167, v167, v179
    v_max_f32 v164, v164, v160
    v_sub_f32 v168, v160, v164
    v_exp_f32 v168, v168
    v_mov_b32 v160, v164
    v_mul_f32 v192, v192, v168
    v_mul_f32 v193, v193, v168
    v_pk_mul_f32 v[0:1], v[0:1], v[168:169] op_sel_hi:[1,0]
    v_pk_mul_f32 v[2:3], v[2:3], v[168:169] op_sel_hi:[1,0]
    v_pk_mul_f32 v[16:17], v[16:17], v[168:169] op_sel_hi:[1,0]
    v_pk_mul_f32 v[18:19], v[18:19], v[168:169] op_sel_hi:[1,0]
    v_pk_mul_f32 v[32:33], v[32:33], v[168:169] op_sel_hi:[1,0]
    v_pk_mul_f32 v[34:35], v[34:35], v[168:169] op_sel_hi:[1,0]
    v_pk_mul_f32 v[48:49], v[48:49], v[168:169] op_sel_hi:[1,0]
    v_pk_mul_f32 v[50:51], v[50:51], v[168:169] op_sel_hi:[1,0]
    v_pk_mul_f32 v[64:65], v[64:65], v[168:169] op_sel_hi:[1,0]
    v_pk_mul_f32 v[66:67], v[66:67], v[168:169] op_sel_hi:[1,0]
    v_pk_mul_f32 v[80:81], v[80:81], v[168:169] op_sel_hi:[1,0]
    v_pk_mul_f32 v[82:83], v[82:83], v[168:169] op_sel_hi:[1,0]
    v_pk_mul_f32 v[96:97], v[96:97], v[168:169] op_sel_hi:[1,0]
    v_pk_mul_f32 v[98:99], v[98:99], v[168:169] op_sel_hi:[1,0]
    v_pk_mul_f32 v[112:113], v[112:113], v[168:169] op_sel_hi:[1,0]
    v_pk_mul_f32 v[114:115], v[114:115], v[168:169] op_sel_hi:[1,0]
    v_sub_f32 v128, v128, v164
    v_sub_f32 v129, v129, v164
    v_sub_f32 v130, v130, v164
    v_sub_f32 v131, v131, v164
    v_sub_f32 v132, v132, v164
    v_sub_f32 v133, v133, v164
    v_sub_f32 v134, v134, v164
    v_sub_f32 v135, v135, v164
    v_exp_f32 v128, v128
    v_exp_f32 v129, v129
    v_exp_f32 v130, v130
    v_exp_f32 v131, v131
    v_exp_f32 v132, v132
    v_exp_f32 v133, v133
    v_exp_f32 v134, v134
    v_exp_f32 v135, v135
    s_nop 0
    v_cvt_pk_bf16_f32 v176, v128, v129
    v_cvt_pk_bf16_f32 v177, v130, v131
    v_cvt_pk_bf16_f32 v178, v132, v133
    v_cvt_pk_bf16_f32 v179, v134, v135
    v_max_f32 v165, v165, v161
    v_sub_f32 v170, v161, v165
    v_exp_f32 v170, v170
    v_mov_b32 v161, v165
    v_mul_f32 v194, v194, v170
    v_mul_f32 v195, v195, v170
    v_pk_mul_f32 v[4:5], v[4:5], v[170:171] op_sel_hi:[1,0]
    v_pk_mul_f32 v[6:7], v[6:7], v[170:171] op_sel_hi:[1,0]
    v_pk_mul_f32 v[20:21], v[20:21], v[170:171] op_sel_hi:[1,0]
    v_pk_mul_f32 v[22:23], v[22:23], v[170:171] op_sel_hi:[1,0]
    v_pk_mul_f32 v[36:37], v[36:37], v[170:171] op_sel_hi:[1,0]
    v_pk_mul_f32 v[38:39], v[38:39], v[170:171] op_sel_hi:[1,0]
    v_pk_mul_f32 v[52:53], v[52:53], v[170:171] op_sel_hi:[1,0]
    v_pk_mul_f32 v[54:55], v[54:55], v[170:171] op_sel_hi:[1,0]
    v_pk_mul_f32 v[68:69], v[68:69], v[170:171] op_sel_hi:[1,0]
    v_pk_mul_f32 v[70:71], v[70:71], v[170:171] op_sel_hi:[1,0]
    v_pk_mul_f32 v[84:85], v[84:85], v[170:171] op_sel_hi:[1,0]
    v_pk_mul_f32 v[86:87], v[86:87], v[170:171] op_sel_hi:[1,0]
    v_pk_mul_f32 v[100:101], v[100:101], v[170:171] op_sel_hi:[1,0]
    v_pk_mul_f32 v[102:103], v[102:103], v[170:171] op_sel_hi:[1,0]
    v_pk_mul_f32 v[116:117], v[116:117], v[170:171] op_sel_hi:[1,0]
    v_pk_mul_f32 v[118:119], v[118:119], v[170:171] op_sel_hi:[1,0]
    v_sub_f32 v136, v136, v165
    v_sub_f32 v137, v137, v165
    v_sub_f32 v138, v138, v165
    v_sub_f32 v139, v139, v165
    v_sub_f32 v140, v140, v165
    v_sub_f32 v141, v141, v165
    v_sub_f32 v142, v142, v165
    v_sub_f32 v143, v143, v165
    v_exp_f32 v136, v136
    v_exp_f32 v137, v137
    v_exp_f32 v138, v138
    v_exp_f32 v139, v139
    v_exp_f32 v140, v140
    v_exp_f32 v141, v141
    v_exp_f32 v142, v142
    v_exp_f32 v143, v143
    s_nop 0
    v_cvt_pk_bf16_f32 v180, v136, v137
    v_cvt_pk_bf16_f32 v181, v138, v139
    v_cvt_pk_bf16_f32 v182, v140, v141
    v_cvt_pk_bf16_f32 v183, v142, v143
    v_max_f32 v166, v166, v162
    v_sub_f32 v172, v162, v166
    v_exp_f32 v172, v172
    v_mov_b32 v162, v166
    v_mul_f32 v196, v196, v172
    v_mul_f32 v197, v197, v172
    v_pk_mul_f32 v[8:9], v[8:9], v[172:173] op_sel_hi:[1,0]
    v_pk_mul_f32 v[10:11], v[10:11], v[172:173] op_sel_hi:[1,0]
    v_pk_mul_f32 v[24:25], v[24:25], v[172:173] op_sel_hi:[1,0]
    v_pk_mul_f32 v[26:27], v[26:27], v[172:173] op_sel_hi:[1,0]
    v_pk_mul_f32 v[40:41], v[40:41], v[172:173] op_sel_hi:[1,0]
    v_pk_mul_f32 v[42:43], v[42:43], v[172:173] op_sel_hi:[1,0]
    v_pk_mul_f32 v[56:57], v[56:57], v[172:173] op_sel_hi:[1,0]
    v_pk_mul_f32 v[58:59], v[58:59], v[172:173] op_sel_hi:[1,0]
    v_pk_mul_f32 v[72:73], v[72:73], v[172:173] op_sel_hi:[1,0]
    v_pk_mul_f32 v[74:75], v[74:75], v[172:173] op_sel_hi:[1,0]
    v_pk_mul_f32 v[88:89], v[88:89], v[172:173] op_sel_hi:[1,0]
    v_pk_mul_f32 v[90:91], v[90:91], v[172:173] op_sel_hi:[1,0]
    v_pk_mul_f32 v[104:105], v[104:105], v[172:173] op_sel_hi:[1,0]
    v_pk_mul_f32 v[106:107], v[106:107], v[172:173] op_sel_hi:[1,0]
    v_pk_mul_f32 v[120:121], v[120:121], v[172:173] op_sel_hi:[1,0]
    v_pk_mul_f32 v[122:123], v[122:123], v[172:173] op_sel_hi:[1,0]
    v_sub_f32 v144, v144, v166
    v_sub_f32 v145, v145, v166
    v_sub_f32 v146, v146, v166
    v_sub_f32 v147, v147, v166
    v_sub_f32 v148, v148, v166
    v_sub_f32 v149, v149, v166
    v_sub_f32 v150, v150, v166
    v_sub_f32 v151, v151, v166
    v_exp_f32 v144, v144
    v_exp_f32 v145, v145
    v_exp_f32 v146, v146
    v_exp_f32 v147, v147
    v_exp_f32 v148, v148
    v_exp_f32 v149, v149
    v_exp_f32 v150, v150
    v_exp_f32 v151, v151
    s_nop 0
    v_cvt_pk_bf16_f32 v184, v144, v145
    v_cvt_pk_bf16_f32 v185, v146, v147
    v_cvt_pk_bf16_f32 v186, v148, v149
    v_cvt_pk_bf16_f32 v187, v150, v151
    v_max_f32 v167, v167, v163
    v_sub_f32 v174, v163, v167
    v_exp_f32 v174, v174
    v_mov_b32 v163, v167
    v_mul_f32 v198, v198, v174
    v_mul_f32 v199, v199, v174
    v_pk_mul_f32 v[12:13], v[12:13], v[174:175] op_sel_hi:[1,0]
    v_pk_mul_f32 v[14:15], v[14:15], v[174:175] op_sel_hi:[1,0]
    v_pk_mul_f32 v[28:29], v[28:29], v[174:175] op_sel_hi:[1,0]
    v_pk_mul_f32 v[30:31], v[30:31], v[174:175] op_sel_hi:[1,0]
    v_pk_mul_f32 v[44:45], v[44:45], v[174:175] op_sel_hi:[1,0]
    v_pk_mul_f32 v[46:47], v[46:47], v[174:175] op_sel_hi:[1,0]
    v_pk_mul_f32 v[60:61], v[60:61], v[174:175] op_sel_hi:[1,0]
    v_pk_mul_f32 v[62:63], v[62:63], v[174:175] op_sel_hi:[1,0]
    v_pk_mul_f32 v[76:77], v[76:77], v[174:175] op_sel_hi:[1,0]
    v_pk_mul_f32 v[78:79], v[78:79], v[174:175] op_sel_hi:[1,0]
    v_pk_mul_f32 v[92:93], v[92:93], v[174:175] op_sel_hi:[1,0]
    v_pk_mul_f32 v[94:95], v[94:95], v[174:175] op_sel_hi:[1,0]
    v_pk_mul_f32 v[108:109], v[108:109], v[174:175] op_sel_hi:[1,0]
    v_pk_mul_f32 v[110:111], v[110:111], v[174:175] op_sel_hi:[1,0]
    v_pk_mul_f32 v[124:125], v[124:125], v[174:175] op_sel_hi:[1,0]
    v_pk_mul_f32 v[126:127], v[126:127], v[174:175] op_sel_hi:[1,0]
    v_sub_f32 v152, v152, v167
    v_sub_f32 v153, v153, v167
    v_sub_f32 v154, v154, v167
    v_sub_f32 v155, v155, v167
    v_sub_f32 v156, v156, v167
    v_sub_f32 v157, v157, v167
    v_sub_f32 v158, v158, v167
    v_sub_f32 v159, v159, v167
    v_exp_f32 v152, v152
    v_exp_f32 v153, v153
    v_exp_f32 v154, v154
    v_exp_f32 v155, v155
    v_exp_f32 v156, v156
    v_exp_f32 v157, v157
    v_exp_f32 v158, v158
    v_exp_f32 v159, v159
    s_nop 0
    v_cvt_pk_bf16_f32 v188, v152, v153
    v_cvt_pk_bf16_f32 v189, v154, v155
    v_cvt_pk_bf16_f32 v190, v156, v157
    v_cvt_pk_bf16_f32 v191, v158, v159
    s_waitcnt lgkmcnt(0)
    s_nop 1
    v_smfmac_f32_16x16x64_bf16 v[192:195], v[208:211], v[176:183], v207
    v_mfma_f32_16x16x32_bf16 v[0:3], a[96:99], v[176:179], v[0:3]
    v_mfma_f32_16x16x32_bf16 v[16:19], a[100:103], v[176:179], v[16:19]
    v_mfma_f32_16x16x32_bf16 v[32:35], a[104:107], v[176:179], v[32:35]
    v_mfma_f32_16x16x32_bf16 v[48:51], a[108:111], v[176:179], v[48:51]
    v_mfma_f32_16x16x32_bf16 v[64:67], a[112:115], v[176:179], v[64:67]
    v_mfma_f32_16x16x32_bf16 v[80:83], a[116:119], v[176:179], v[80:83]
    v_mfma_f32_16x16x32_bf16 v[96:99], a[120:123], v[176:179], v[96:99]
    v_mfma_f32_16x16x32_bf16 v[112:115], a[124:127], v[176:179], v[112:115]
    v_mfma_f32_16x16x32_bf16 v[4:7], a[96:99], v[180:183], v[4:7]
    v_mfma_f32_16x16x32_bf16 v[20:23], a[100:103], v[180:183], v[20:23]
    v_mfma_f32_16x16x32_bf16 v[36:39], a[104:107], v[180:183], v[36:39]
    v_mfma_f32_16x16x32_bf16 v[52:55], a[108:111], v[180:183], v[52:55]
    v_mfma_f32_16x16x32_bf16 v[68:71], a[112:115], v[180:183], v[68:71]
    v_mfma_f32_16x16x32_bf16 v[84:87], a[116:119], v[180:183], v[84:87]
    v_mfma_f32_16x16x32_bf16 v[100:103], a[120:123], v[180:183], v[100:103]
    v_mfma_f32_16x16x32_bf16 v[116:119], a[124:127], v[180:183], v[116:119]
    v_smfmac_f32_16x16x64_bf16 v[196:199], v[208:211], v[184:191], v207
    v_mfma_f32_16x16x32_bf16 v[8:11], a[96:99], v[184:187], v[8:11]
    v_mfma_f32_16x16x32_bf16 v[24:27], a[100:103], v[184:187], v[24:27]
    v_mfma_f32_16x16x32_bf16 v[40:43], a[104:107], v[184:187], v[40:43]
    v_mfma_f32_16x16x32_bf16 v[56:59], a[108:111], v[184:187], v[56:59]
    v_mfma_f32_16x16x32_bf16 v[72:75], a[112:115], v[184:187], v[72:75]
    v_mfma_f32_16x16x32_bf16 v[88:91], a[116:119], v[184:187], v[88:91]
    v_mfma_f32_16x16x32_bf16 v[104:107], a[120:123], v[184:187], v[104:107]
    v_mfma_f32_16x16x32_bf16 v[120:123], a[124:127], v[184:187], v[120:123]
    v_mfma_f32_16x16x32_bf16 v[12:15], a[96:99], v[188:191], v[12:15]
    v_mfma_f32_16x16x32_bf16 v[28:31], a[100:103], v[188:191], v[28:31]
    v_mfma_f32_16x16x32_bf16 v[44:47], a[104:107], v[188:191], v[44:47]
    v_mfma_f32_16x16x32_bf16 v[60:63], a[108:111], v[188:191], v[60:63]
    v_mfma_f32_16x16x32_bf16 v[76:79], a[112:115], v[188:191], v[76:79]
    v_mfma_f32_16x16x32_bf16 v[92:95], a[116:119], v[188:191], v[92:95]
    v_mfma_f32_16x16x32_bf16 v[108:111], a[120:123], v[188:191], v[108:111]
    v_mfma_f32_16x16x32_bf16 v[124:127], a[124:127], v[188:191], v[124:127]
    s_nop 15
    s_cmp_lt_u32 s60, 524288
    s_cbranch_scc1 L_SLOW
    v_add_f32 v192, v192, v193
    v_add_f32 v194, v194, v195
    v_add_f32 v196, v196, v197
    v_add_f32 v198, v198, v199
    v_mov_b32 v128, v192
    v_mov_b32 v129, v194
    v_mov_b32 v130, v196
    v_mov_b32 v131, v198
    v_permlane16_swap_b32 v128, v192
    v_permlane16_swap_b32 v129, v194
    v_permlane16_swap_b32 v130, v196
    v_permlane16_swap_b32 v131, v198
    v_add_f32 v192, v192, v128
    v_add_f32 v194, v194, v129
    v_add_f32 v196, v196, v130
    v_add_f32 v198, v198, v131
    v_mov_b32 v128, v192
    v_mov_b32 v129, v194
    v_mov_b32 v130, v196
    v_mov_b32 v131, v198
    v_permlane32_swap_b32 v128, v192
    v_permlane32_swap_b32 v129, v194
    v_permlane32_swap_b32 v130, v196
    v_permlane32_swap_b32 v131, v198
    v_add_f32 v192, v192, v128
    v_add_f32 v194, v194, v129
    v_add_f32 v196, v196, v130
    v_add_f32 v198, v198, v131
    s_branch M_NORM
.p2align 8
.fill 64, 4, 0xbf800000
.section .rodata,"a"
.p2align 6
.amdhsa_kernel recurrent_scan__gqa_block_cached__glu_gated_bilinear__prompt_kernel
.amdhsa_next_free_vgpr 512
.amdhsa_next_free_sgpr 102
.amdhsa_accum_offset 256
.amdhsa_group_segment_fixed_size 0
.amdhsa_kernarg_size 96
.amdhsa_user_sgpr_count 2
.amdhsa_user_sgpr_kernarg_segment_ptr 1
.amdhsa_system_sgpr_workgroup_id_x 1
.amdhsa_float_denorm_mode_32 3
.end_amdhsa_kernel
```
